```python
import torch

def _softmax(x, axis=-1):
    return torch.softmax(x, dim=axis)
def _gelu(x):
    return torch.nn.functional.gelu(x, approximate="tanh")
def _silu(x):
    return torch.nn.functional.silu(x)
def _sigmoid(x):
    return torch.sigmoid(x)
def _layernorm(x, axis=-1, eps=1e-5):
    m = x.mean(dim=axis, keepdim=True)
    v = x.var(dim=axis, keepdim=True, unbiased=False)
    return (x - m) / torch.sqrt(v + eps)
def _scatter_add(tgt, idx, src, axis=0):
    return tgt.clone().index_add_(axis, idx, src)
def _segment_sum(src, seg, n):
    out = torch.zeros((n,) + src.shape[1:], dtype=src.dtype)
    return out.index_add_(0, seg, src)
def _pad(x, pw):
    flat = tuple(v for pair in reversed(pw) for v in pair)
    return torch.nn.functional.pad(x, flat)

kernel_name = 'standalone__mha_softmax__near_ridge'

def setup_inputs():

    _w = (lambda a: (lambda t: t.to(torch.bfloat16) if t.is_floating_point() else t)(torch.as_tensor(a)))
    B, H, Sq, Sk, D = 16, 32, 384, 1024, 128
    return {
        "q": _w((lambda *s: torch.randn(*s, dtype=torch.bfloat16) * 0.8)(B, H, Sq, D)),
        "k": _w((lambda *s: torch.randn(*s, dtype=torch.bfloat16) * 0.8)(B, H, Sk, D)),
        "v": _w((lambda *s: torch.randn(*s, dtype=torch.bfloat16) * 0.05)(B, H, Sk, D)),
    }

def reference(q, k, v):
    scale = q.shape[-1] ** -0.5
    scores = torch.einsum("bhqd,bhkd->bhqk", q, k) * scale
    p = _softmax(scores, axis=-1)
    return torch.einsum("bhqk,bhkd->bhqd", p, v)
```

```asm
; @launch grid=(256,1,1) block=(256,1,1) lds=163840
.amdgcn_target "amdgcn-amd-amdhsa--gfx950"
.text
.globl standalone__mha_softmax__near_ridge_kernel
.p2align 8
.type standalone__mha_softmax__near_ridge_kernel,@function
standalone__mha_softmax__near_ridge_kernel:
    s_cmp_ge_u32 s2, 0x100
    s_cbranch_scc1 L_end
    s_load_dwordx4 s[4:7], s[0:1], 0
    s_load_dwordx4 s[24:27], s[0:1], 16
    v_and_b32 v64, 63, v0
    v_lshrrev_b32 v65, 6, v0
    v_and_b32 v66, 15, v64
    v_lshrrev_b32 v67, 4, v64
    v_readfirstlane_b32 s46, v65
    v_lshlrev_b32 v68, 8, v67
    v_xor_b32 v69, v66, v67
    v_xor_b32 v70, 0, v69
    v_lshl_add_u32 v13, v70, 4, v68
    v_xor_b32 v70, 4, v69
    v_lshl_add_u32 v14, v70, 4, v68
    v_xor_b32 v70, 8, v69
    v_lshl_add_u32 v15, v70, 4, v68
    v_xor_b32 v70, 12, v69
    v_lshl_add_u32 v16, v70, 4, v68
    v_lshlrev_b32 v70, 1, v67
    v_xor_b32 v70, v70, v66
    v_lshl_add_u32 v17, v70, 4, v68
    v_xor_b32 v70, 8, v70
    v_lshl_add_u32 v18, v70, 4, v68
    s_mov_b32 s28, 0x3e0293ee
    s_mov_b32 s29, 0x5d800000
    s_mov_b32 s59, 0xffff0000
    s_mov_b32 s56, 0x3e0293ee
    s_mov_b32 s57, 0x3e0293ee
    s_mov_b32 s36, 0x3d800000
    s_lshl_b32 s30, s46, 12
    s_mov_b32 s31, s30
    s_mov_b32 s32, 0
    s_mov_b64 s[42:43], 0
    s_mov_b64 s[44:45], 0
    s_mul_i32 s47, s46, 0x6000
    s_lshl_b32 s48, s46, 13
    s_add_u32 s48, s48, 0x20000
    s_mov_b32 s52, s30
    s_mov_b32 s37, 0
    s_add_u32 s38, s47, 0x18000
    s_mov_b32 s39, 0x7ff8
    s_mov_b32 s51, 0x5b4
    s_lshl_b32 s3, s2, 19
    s_mul_i32 s35, s2, 0x30000
    s_waitcnt lgkmcnt(0)
    s_add_u32 s8, s6, s3
    s_addc_u32 s9, s7, 0
    s_mov_b32 s10, 0x80000
    s_mov_b32 s11, 0x20000
    s_add_u32 s16, s4, s35
    s_addc_u32 s17, s5, 0
    s_mov_b32 s18, 0x30000
    s_mov_b32 s19, 0x20000
    s_add_u32 s12, s24, s3
    s_addc_u32 s13, s25, 0
    s_mov_b32 s14, 0x80000
    s_mov_b32 s15, 0x20000
    s_add_u32 s20, s26, s35
    s_addc_u32 s21, s27, 0
    s_mov_b32 s22, 0x30000
    s_mov_b32 s23, 0x20000
    s_mov_b32 m0, s31
    s_nop 0
    buffer_load_dwordx4 v13, s[8:11], s30 offen offset:0 nt lds
    buffer_load_dwordx4 v14, s[8:11], s30 offen offset:1024 nt lds
    buffer_load_dwordx4 v15, s[8:11], s30 offen offset:2048 nt lds
    buffer_load_dwordx4 v16, s[8:11], s30 offen offset:3072 nt lds
    s_add_u32 m0, s48, 0
    s_add_u32 s49, s47, 0x0
    buffer_load_dwordx4 v13, s[16:19], s49 offen offset:0 nt lds
    buffer_load_dwordx4 v14, s[16:19], s49 offen offset:1024 nt lds
    buffer_load_dwordx4 v15, s[16:19], s49 offen offset:2048 nt lds
    buffer_load_dwordx4 v16, s[16:19], s49 offen offset:3072 nt lds
    s_add_u32 m0, s48, 4096
    s_add_u32 s49, s47, 0x1000
    buffer_load_dwordx4 v13, s[16:19], s49 offen offset:0 nt lds
    buffer_load_dwordx4 v14, s[16:19], s49 offen offset:1024 nt lds
    buffer_load_dwordx4 v15, s[16:19], s49 offen offset:2048 nt lds
    buffer_load_dwordx4 v16, s[16:19], s49 offen offset:3072 nt lds
    s_add_u32 m0, s31, 65536
    s_nop 0
    buffer_load_dwordx4 v17, s[12:15], s30 offen offset:0 nt lds
    buffer_load_dwordx4 v18, s[12:15], s30 offen offset:1024 nt lds
    buffer_load_dwordx4 v17, s[12:15], s30 offen offset:2048 nt lds
    buffer_load_dwordx4 v18, s[12:15], s30 offen offset:3072 nt lds
    s_add_u32 s31, s31, 0x4000
    s_and_b32 s31, s31, 0xffff
    s_add_u32 s30, s30, 0x4000
    v_lshlrev_b32 v27, 4, v64
    s_getpc_b64 s[92:93]
L_pc:
    s_sub_u32 s92, s92, L_pc-standalone__mha_softmax__near_ridge_kernel
    s_subb_u32 s93, s93, 0
    s_mov_b32 s94, L_fast_end-standalone__mha_softmax__near_ridge_kernel
    s_mov_b32 s95, 0x20000
    buffer_load_dwordx4 v[128:131], v27, s[92:95], s52 offen offset:0
    buffer_load_dwordx4 v[132:135], v27, s[92:95], s52 offen offset:1024
    buffer_load_dwordx4 v[136:139], v27, s[92:95], s52 offen offset:2048
    buffer_load_dwordx4 v[140:143], v27, s[92:95], s52 offen offset:3072
    s_lshr_b32 s49, s52, 1
    s_add_u32 s49, s49, L_hookd0-standalone__mha_softmax__near_ridge_kernel
    buffer_load_dwordx4 v[144:147], v27, s[92:95], s49 offen offset:0
    buffer_load_dwordx4 v[148:151], v27, s[92:95], s49 offen offset:1024
    v_lshlrev_b32 v70, 8, v66
    v_add_u32 v71, 0, v67
    v_xor_b32 v71, v71, v66
    v_lshl_add_u32 v1, v71, 4, v70
    v_add_u32 v71, 4, v67
    v_xor_b32 v71, v71, v66
    v_lshl_add_u32 v2, v71, 4, v70
    v_add_u32 v71, 8, v67
    v_xor_b32 v71, v71, v66
    v_lshl_add_u32 v3, v71, 4, v70
    v_add_u32 v71, 12, v67
    v_xor_b32 v71, v71, v66
    v_lshl_add_u32 v4, v71, 4, v70
    v_lshrrev_b32 v72, 2, v66
    v_and_b32 v73, 3, v66
    v_lshl_add_u32 v75, v67, 2, v72
    v_lshlrev_b32 v74, 8, v75
    v_lshl_add_u32 v74, v73, 3, v74
    v_add_u32 v74, 0x10000, v74
    v_and_b32 v75, 7, v75
    v_xor_b32 v71, 0, v75
    v_lshl_add_u32 v5, v71, 5, v74
    v_xor_b32 v71, 1, v75
    v_lshl_add_u32 v6, v71, 5, v74
    v_xor_b32 v71, 2, v75
    v_lshl_add_u32 v7, v71, 5, v74
    v_xor_b32 v71, 3, v75
    v_lshl_add_u32 v8, v71, 5, v74
    v_xor_b32 v71, 4, v75
    v_lshl_add_u32 v9, v71, 5, v74
    v_xor_b32 v71, 5, v75
    v_lshl_add_u32 v10, v71, 5, v74
    v_xor_b32 v71, 6, v75
    v_lshl_add_u32 v11, v71, 5, v74
    v_xor_b32 v71, 7, v75
    v_lshl_add_u32 v12, v71, 5, v74
    v_mul_u32_u24 v74, 0x110, v66
    v_lshl_add_u32 v74, v67, 3, v74
    v_add_u32 v20, s48, v74
    v_mul_u32_u24 v74, 0x110, v67
    v_lshl_add_u32 v74, v66, 4, v74
    v_add_u32 v19, s48, v74
    v_lshlrev_b32 v27, 4, v64
    s_waitcnt vmcnt(10)
    s_barrier
    s_sub_u32 s50, s48, s32
    v_add_u32 v31, s50, v1
    ds_read_b128 v[240:243], v31 offset:0
    v_add_u32 v30, s50, v2
    ds_read_b128 v[244:247], v30 offset:0
    v_add_u32 v31, s50, v3
    ds_read_b128 v[248:251], v31 offset:0
    v_add_u32 v30, s50, v4
    ds_read_b128 v[252:255], v30 offset:0
    ds_read_b128 a[192:195], v1 offset:0
    ds_read_b128 a[196:199], v2 offset:0
    ds_read_b128 a[200:203], v3 offset:0
    ds_read_b128 a[204:207], v4 offset:0
    ds_read_b128 a[208:211], v1 offset:4096
    ds_read_b128 a[212:215], v2 offset:4096
    ds_read_b128 a[216:219], v3 offset:4096
    ds_read_b128 a[220:223], v4 offset:4096
    s_add_u32 m0, s52, 0x8000
    s_add_u32 s49, s47, 0x2000
    buffer_load_dwordx4 v13, s[16:19], s49 offen offset:0 nt lds
    buffer_load_dwordx4 v14, s[16:19], s49 offen offset:1024 nt lds
    buffer_load_dwordx4 v15, s[16:19], s49 offen offset:2048 nt lds
    buffer_load_dwordx4 v16, s[16:19], s49 offen offset:3072 nt lds
    s_add_u32 m0, s52, 0x18000
    s_add_u32 s49, s47, 0x3000
    buffer_load_dwordx4 v13, s[16:19], s49 offen offset:0 nt lds
    buffer_load_dwordx4 v14, s[16:19], s49 offen offset:1024 nt lds
    buffer_load_dwordx4 v15, s[16:19], s49 offen offset:2048 nt lds
    buffer_load_dwordx4 v16, s[16:19], s49 offen offset:3072 nt lds
    s_waitcnt lgkmcnt(11)
    v_lshlrev_b32 v30, 16, v240
    v_and_b32 v31, s59, v240
    v_pk_mul_f32 v[30:31], v[30:31], s[56:57]
    v_cvt_pk_bf16_f32 v240, v30, v31
    v_accvgpr_write_b32 a0, v240
    v_lshlrev_b32 v28, 16, v241
    v_and_b32 v29, s59, v241
    v_pk_mul_f32 v[28:29], v[28:29], s[56:57]
    v_cvt_pk_bf16_f32 v241, v28, v29
    v_accvgpr_write_b32 a1, v241
    v_lshlrev_b32 v30, 16, v242
    v_and_b32 v31, s59, v242
    v_pk_mul_f32 v[30:31], v[30:31], s[56:57]
    v_cvt_pk_bf16_f32 v242, v30, v31
    v_accvgpr_write_b32 a2, v242
    v_lshlrev_b32 v28, 16, v243
    v_and_b32 v29, s59, v243
    v_pk_mul_f32 v[28:29], v[28:29], s[56:57]
    v_cvt_pk_bf16_f32 v243, v28, v29
    v_accvgpr_write_b32 a3, v243
    s_waitcnt lgkmcnt(10)
    v_lshlrev_b32 v30, 16, v244
    v_and_b32 v31, s59, v244
    v_pk_mul_f32 v[30:31], v[30:31], s[56:57]
    v_cvt_pk_bf16_f32 v244, v30, v31
    v_accvgpr_write_b32 a4, v244
    v_lshlrev_b32 v28, 16, v245
    v_and_b32 v29, s59, v245
    v_pk_mul_f32 v[28:29], v[28:29], s[56:57]
    v_cvt_pk_bf16_f32 v245, v28, v29
    v_accvgpr_write_b32 a5, v245
    v_lshlrev_b32 v30, 16, v246
    v_and_b32 v31, s59, v246
    v_pk_mul_f32 v[30:31], v[30:31], s[56:57]
    v_cvt_pk_bf16_f32 v246, v30, v31
    v_accvgpr_write_b32 a6, v246
    v_lshlrev_b32 v28, 16, v247
    v_and_b32 v29, s59, v247
    v_pk_mul_f32 v[28:29], v[28:29], s[56:57]
    v_cvt_pk_bf16_f32 v247, v28, v29
    v_accvgpr_write_b32 a7, v247
    s_waitcnt lgkmcnt(9)
    v_lshlrev_b32 v30, 16, v248
    v_and_b32 v31, s59, v248
    v_pk_mul_f32 v[30:31], v[30:31], s[56:57]
    v_cvt_pk_bf16_f32 v248, v30, v31
    v_accvgpr_write_b32 a8, v248
    v_lshlrev_b32 v28, 16, v249
    v_and_b32 v29, s59, v249
    v_pk_mul_f32 v[28:29], v[28:29], s[56:57]
    v_cvt_pk_bf16_f32 v249, v28, v29
    v_accvgpr_write_b32 a9, v249
    v_lshlrev_b32 v30, 16, v250
    v_and_b32 v31, s59, v250
    v_pk_mul_f32 v[30:31], v[30:31], s[56:57]
    v_cvt_pk_bf16_f32 v250, v30, v31
    v_accvgpr_write_b32 a10, v250
    v_lshlrev_b32 v28, 16, v251
    v_and_b32 v29, s59, v251
    v_pk_mul_f32 v[28:29], v[28:29], s[56:57]
    v_cvt_pk_bf16_f32 v251, v28, v29
    v_accvgpr_write_b32 a11, v251
    s_waitcnt lgkmcnt(8)
    v_lshlrev_b32 v30, 16, v252
    v_and_b32 v31, s59, v252
    v_pk_mul_f32 v[30:31], v[30:31], s[56:57]
    v_cvt_pk_bf16_f32 v252, v30, v31
    v_accvgpr_write_b32 a12, v252
    v_lshlrev_b32 v28, 16, v253
    v_and_b32 v29, s59, v253
    v_pk_mul_f32 v[28:29], v[28:29], s[56:57]
    v_cvt_pk_bf16_f32 v253, v28, v29
    v_accvgpr_write_b32 a13, v253
    v_lshlrev_b32 v30, 16, v254
    v_and_b32 v31, s59, v254
    v_pk_mul_f32 v[30:31], v[30:31], s[56:57]
    v_cvt_pk_bf16_f32 v254, v30, v31
    v_accvgpr_write_b32 a14, v254
    v_lshlrev_b32 v28, 16, v255
    v_and_b32 v29, s59, v255
    v_pk_mul_f32 v[28:29], v[28:29], s[56:57]
    v_cvt_pk_bf16_f32 v255, v28, v29
    v_accvgpr_write_b32 a15, v255
    s_waitcnt lgkmcnt(4)
    v_mfma_f32_16x16x32_bf16 v[32:35], a[192:195], a[0:3], 0
    s_sub_u32 s50, s48, s32
    v_add_u32 v31, s50, v1
    ds_read_b128 v[240:243], v31 offset:4096
    v_add_u32 v30, s50, v2
    ds_read_b128 v[244:247], v30 offset:4096
    v_add_u32 v31, s50, v3
    ds_read_b128 v[248:251], v31 offset:4096
    v_add_u32 v30, s50, v4
    v_mfma_f32_16x16x32_bf16 v[32:35], a[196:199], a[4:7], v[32:35]
    ds_read_b128 v[252:255], v30 offset:4096
    s_waitcnt lgkmcnt(3)
    v_lshlrev_b32 v28, 16, v240
    v_and_b32 v29, s59, v240
    v_mul_f32 v28, s28, v28
    v_mul_f32 v29, s28, v29
    v_cvt_pk_bf16_f32 v240, v28, v29
    v_accvgpr_write_b32 a16, v240
    v_mfma_f32_16x16x32_bf16 v[32:35], a[200:203], a[8:11], v[32:35]
    v_lshlrev_b32 v28, 16, v241
    v_and_b32 v29, s59, v241
    v_mul_f32 v28, s28, v28
    v_mul_f32 v29, s28, v29
    v_cvt_pk_bf16_f32 v241, v28, v29
    v_accvgpr_write_b32 a17, v241
    v_lshlrev_b32 v28, 16, v242
    v_and_b32 v29, s59, v242
    v_mfma_f32_16x16x32_bf16 v[32:35], a[204:207], a[12:15], v[32:35]
    v_mul_f32 v28, s28, v28
    v_mul_f32 v29, s28, v29
    v_cvt_pk_bf16_f32 v242, v28, v29
    v_accvgpr_write_b32 a18, v242
    v_lshlrev_b32 v28, 16, v243
    v_and_b32 v29, s59, v243
    v_mul_f32 v28, s28, v28
    v_mfma_f32_16x16x32_bf16 v[36:39], a[208:211], a[0:3], 0
    v_mul_f32 v29, s28, v29
    v_cvt_pk_bf16_f32 v243, v28, v29
    v_accvgpr_write_b32 a19, v243
    s_waitcnt lgkmcnt(2)
    v_lshlrev_b32 v28, 16, v244
    v_and_b32 v29, s59, v244
    v_mul_f32 v28, s28, v28
    v_mul_f32 v29, s28, v29
    v_cvt_pk_bf16_f32 v244, v28, v29
    v_mfma_f32_16x16x32_bf16 v[36:39], a[212:215], a[4:7], v[36:39]
    s_waitcnt vmcnt(14)
    s_barrier
    v_accvgpr_write_b32 a20, v244
    v_lshlrev_b32 v28, 16, v245
    v_and_b32 v29, s59, v245
    v_mul_f32 v28, s28, v28
    v_mul_f32 v29, s28, v29
    v_cvt_pk_bf16_f32 v245, v28, v29
    v_accvgpr_write_b32 a21, v245
    v_mfma_f32_16x16x32_bf16 v[36:39], a[216:219], a[8:11], v[36:39]
    ds_read_b64_tr_b16 v[48:49], v5 offset:0
    ds_read_b64_tr_b16 v[50:51], v5 offset:4096
    v_lshlrev_b32 v28, 16, v246
    v_and_b32 v29, s59, v246
    v_mul_f32 v28, s28, v28
    v_mul_f32 v29, s28, v29
    v_cvt_pk_bf16_f32 v246, v28, v29
    v_accvgpr_write_b32 a22, v246
    v_lshlrev_b32 v28, 16, v247
    v_and_b32 v29, s59, v247
    v_mfma_f32_16x16x32_bf16 v[36:39], a[220:223], a[12:15], v[36:39]
    ds_read_b64_tr_b16 v[52:53], v6 offset:0
    ds_read_b64_tr_b16 v[54:55], v6 offset:4096
    v_mul_f32 v28, s28, v28
    v_mul_f32 v29, s28, v29
    v_cvt_pk_bf16_f32 v247, v28, v29
    v_accvgpr_write_b32 a23, v247
    s_waitcnt lgkmcnt(5)
    v_lshlrev_b32 v28, 16, v248
    v_and_b32 v29, s59, v248
    v_mul_f32 v28, s28, v28
    ds_read_b64_tr_b16 v[56:57], v7 offset:0
    ds_read_b64_tr_b16 v[58:59], v7 offset:4096
    v_mul_f32 v29, s28, v29
    v_cvt_pk_bf16_f32 v248, v28, v29
    v_accvgpr_write_b32 a24, v248
    v_lshlrev_b32 v28, 16, v249
    v_and_b32 v29, s59, v249
    v_mul_f32 v28, s28, v28
    v_mul_f32 v29, s28, v29
    v_cvt_pk_bf16_f32 v249, v28, v29
    ds_read_b64_tr_b16 v[60:61], v8 offset:0
    ds_read_b64_tr_b16 v[62:63], v8 offset:4096
    v_accvgpr_write_b32 a25, v249
    v_lshlrev_b32 v28, 16, v250
    v_and_b32 v29, s59, v250
    v_mul_f32 v28, s28, v28
    v_mul_f32 v29, s28, v29
    v_cvt_pk_bf16_f32 v250, v28, v29
    v_accvgpr_write_b32 a26, v250
    ds_read_b64_tr_b16 a[240:241], v9 offset:0
    ds_read_b64_tr_b16 a[242:243], v9 offset:4096
    v_lshlrev_b32 v28, 16, v251
    v_and_b32 v29, s59, v251
    v_mul_f32 v28, s28, v28
    v_mul_f32 v29, s28, v29
    v_cvt_pk_bf16_f32 v251, v28, v29
    v_accvgpr_write_b32 a27, v251
    s_waitcnt lgkmcnt(10)
    v_lshlrev_b32 v28, 16, v252
    v_and_b32 v29, s59, v252
    ds_read_b64_tr_b16 a[244:245], v10 offset:0
    ds_read_b64_tr_b16 a[246:247], v10 offset:4096
    v_mul_f32 v28, s28, v28
    v_mul_f32 v29, s28, v29
    v_cvt_pk_bf16_f32 v252, v28, v29
    v_accvgpr_write_b32 a28, v252
    v_lshlrev_b32 v28, 16, v253
    v_and_b32 v29, s59, v253
    v_mul_f32 v28, s28, v28
    s_add_u32 s35, s32, 0x4000
    ds_read_b64_tr_b16 a[248:249], v11 offset:0
    ds_read_b64_tr_b16 a[250:251], v11 offset:4096
    v_mul_f32 v29, s28, v29
    v_cvt_pk_bf16_f32 v253, v28, v29
    v_accvgpr_write_b32 a29, v253
    v_lshlrev_b32 v28, 16, v254
    v_and_b32 v29, s59, v254
    v_mul_f32 v28, s28, v28
    v_mul_f32 v29, s28, v29
    v_cvt_pk_bf16_f32 v254, v28, v29
    s_and_b32 s35, s35, 0xffff
    ds_read_b64_tr_b16 a[252:253], v12 offset:0
    ds_read_b64_tr_b16 a[254:255], v12 offset:4096
    v_accvgpr_write_b32 a30, v254
    v_lshlrev_b32 v28, 16, v255
    v_and_b32 v29, s59, v255
    v_mul_f32 v28, s28, v28
    v_mul_f32 v29, s28, v29
    v_cvt_pk_bf16_f32 v255, v28, v29
    v_accvgpr_write_b32 a31, v255
    s_sub_u32 s33, s35, s32
    ds_read_b64_tr_b16 a[224:225], v5 offset:8192
    ds_read_b64_tr_b16 a[226:227], v5 offset:12288
    v_add_u32 v5, s33, v5
    v_mfma_f32_16x16x32_bf16 v[40:43], a[192:195], a[16:19], 0
    ds_read_b128 a[192:195], v1 offset:8192
    ds_read_b64_tr_b16 a[228:229], v6 offset:8192
    s_add_u32 m0, s52, 0xc000
    v_mfma_f32_16x16x32_bf16 v[40:43], a[196:199], a[20:23], v[40:43]
    ds_read_b128 a[196:199], v2 offset:8192
    ds_read_b64_tr_b16 a[230:231], v6 offset:12288
    v_mfma_f32_16x16x32_bf16 v[40:43], a[200:203], a[24:27], v[40:43]
    s_add_u32 s49, s47, 0x4000
    v_exp_f32 v32, v32
    v_exp_f32 v33, v33
    v_mfma_f32_16x16x32_bf16 v[40:43], a[204:207], a[28:31], v[40:43]
    v_exp_f32 v34, v34
    v_exp_f32 v35, v35
    v_mov_b32 v21, v32
    v_add_f32 v21, v21, v33
    v_cvt_pk_bf16_f32 v32, v32, v33
    v_mfma_f32_16x16x32_bf16 v[44:47], a[208:211], a[16:19], 0
    buffer_load_dwordx4 v13, s[16:19], s49 offen offset:0 nt lds
    v_cvt_pk_bf16_f32 v33, v34, v35
    v_exp_f32 v36, v36
    v_exp_f32 v37, v37
    v_add_f32 v21, v21, v34
    v_add_f32 v21, v21, v35
    v_mfma_f32_16x16x32_bf16 v[44:47], a[212:215], a[20:23], v[44:47]
    v_cvt_pk_bf16_f32 v34, v36, v37
    v_exp_f32 v38, v38
    v_exp_f32 v39, v39
    v_add_f32 v21, v21, v36
    v_add_f32 v21, v21, v37
    v_mfma_f32_16x16x32_bf16 v[44:47], a[216:219], a[24:27], v[44:47]
    buffer_load_dwordx4 v14, s[16:19], s49 offen offset:1024 nt lds
    v_cvt_pk_bf16_f32 v35, v38, v39
    v_add_f32 v21, v21, v38
    v_add_f32 v21, v21, v39
    v_mfma_f32_16x16x32_bf16 v[44:47], a[220:223], a[28:31], v[44:47]
    s_waitcnt lgkmcnt(14)
    v_exp_f32 v40, v40
    v_mfma_f32_16x16x32_bf16 v[64:67], v[48:51], v[32:35], 0
    ds_read_b128 a[200:203], v3 offset:8192
    ds_read_b128 a[204:207], v4 offset:8192
    buffer_load_dwordx4 v15, s[16:19], s49 offen offset:2048 nt lds
    v_mov_b32 v22, v40
    v_mfma_f32_16x16x32_bf16 v[68:71], v[52:55], v[32:35], 0
    ds_read_b128 a[212:215], v2 offset:12288
    v_exp_f32 v41, v41
    v_mfma_f32_16x16x32_bf16 v[72:75], v[56:59], v[32:35], 0
    ds_read_b128 a[216:219], v3 offset:12288
    buffer_load_dwordx4 v16, s[16:19], s49 offen offset:3072 nt lds
    v_cvt_pk_bf16_f32 v40, v40, v41
    v_add_f32 v22, v22, v41
    v_mfma_f32_16x16x32_bf16 v[76:79], v[60:63], v[32:35], 0
    s_waitcnt lgkmcnt(10)
    v_exp_f32 v42, v42
    v_mfma_f32_16x16x32_bf16 v[80:83], a[240:243], v[32:35], 0
    ds_read_b128 a[208:211], v1 offset:12288
    ds_read_b128 a[220:223], v4 offset:12288
    s_add_u32 m0, s52, 0x1c000
    v_add_f32 v22, v22, v42
    v_mfma_f32_16x16x32_bf16 v[84:87], a[244:247], v[32:35], 0
    v_exp_f32 v43, v43
    v_mfma_f32_16x16x32_bf16 v[88:91], a[248:251], v[32:35], 0
    s_add_u32 s49, s47, 0x5000
    v_cvt_pk_bf16_f32 v41, v42, v43
    v_add_f32 v22, v22, v43
    v_mfma_f32_16x16x32_bf16 v[92:95], a[252:255], v[32:35], 0
    s_waitcnt lgkmcnt(4)
    v_exp_f32 v44, v44
    v_mfma_f32_16x16x32_bf16 v[32:35], a[192:195], a[0:3], 0
    ds_read_b64_tr_b16 a[232:233], v7 offset:8192
    buffer_load_dwordx4 v13, s[16:19], s49 offen offset:0 nt lds
    v_add_f32 v22, v22, v44
    v_mfma_f32_16x16x32_bf16 v[32:35], a[196:199], a[4:7], v[32:35]
    v_exp_f32 v45, v45
    v_mfma_f32_16x16x32_bf16 v[32:35], a[200:203], a[8:11], v[32:35]
    buffer_load_dwordx4 v14, s[16:19], s49 offen offset:1024 nt lds
    v_cvt_pk_bf16_f32 v42, v44, v45
    v_add_f32 v22, v22, v45
    v_mfma_f32_16x16x32_bf16 v[32:35], a[204:207], a[12:15], v[32:35]
    s_waitcnt lgkmcnt(1)
    v_exp_f32 v46, v46
    v_mfma_f32_16x16x32_bf16 v[36:39], a[208:211], a[0:3], 0
    ds_read_b64_tr_b16 a[234:235], v7 offset:12288
    buffer_load_dwordx4 v15, s[16:19], s49 offen offset:2048 nt lds
    v_add_f32 v22, v22, v46
    v_mfma_f32_16x16x32_bf16 v[36:39], a[212:215], a[4:7], v[36:39]
    v_exp_f32 v47, v47
    v_mfma_f32_16x16x32_bf16 v[36:39], a[216:219], a[8:11], v[36:39]
    buffer_load_dwordx4 v16, s[16:19], s49 offen offset:3072 nt lds
    v_cvt_pk_bf16_f32 v43, v46, v47
    v_add_f32 v22, v22, v47
    v_mfma_f32_16x16x32_bf16 v[36:39], a[220:223], a[12:15], v[36:39]
    v_exp_f32 v32, v32
    v_mfma_f32_16x16x32_bf16 v[96:99], v[48:51], v[40:43], 0
    ds_read_b64_tr_b16 a[236:237], v8 offset:8192
    s_mov_b32 m0, s31
    v_add_f32 v21, v21, v32
    v_mfma_f32_16x16x32_bf16 v[100:103], v[52:55], v[40:43], 0
    buffer_load_dwordx4 v13, s[8:11], s30 offen offset:0 nt lds
    v_exp_f32 v33, v33
    v_mfma_f32_16x16x32_bf16 v[104:107], v[56:59], v[40:43], 0
    v_cvt_pk_bf16_f32 v32, v32, v33
    v_add_f32 v21, v21, v33
    v_mfma_f32_16x16x32_bf16 v[108:111], v[60:63], v[40:43], 0
    buffer_load_dwordx4 v14, s[8:11], s30 offen offset:1024 nt lds
    v_exp_f32 v34, v34
    v_mfma_f32_16x16x32_bf16 v[112:115], a[240:243], v[40:43], 0
    ds_read_b64_tr_b16 a[238:239], v8 offset:12288
    v_add_f32 v21, v21, v34
    v_mfma_f32_16x16x32_bf16 v[116:119], a[244:247], v[40:43], 0
    ds_read_b64_tr_b16 a[244:245], v10 offset:8192
    buffer_load_dwordx4 v15, s[8:11], s30 offen offset:2048 nt lds
    v_exp_f32 v35, v35
    v_mfma_f32_16x16x32_bf16 v[120:123], a[248:251], v[40:43], 0
    ds_read_b64_tr_b16 a[246:247], v10 offset:12288
    v_cvt_pk_bf16_f32 v33, v34, v35
    v_add_f32 v21, v21, v35
    v_mfma_f32_16x16x32_bf16 v[124:127], a[252:255], v[40:43], 0
    ds_read_b64_tr_b16 a[248:249], v11 offset:8192
    buffer_load_dwordx4 v16, s[8:11], s30 offen offset:3072 nt lds
    v_exp_f32 v36, v36
    v_mfma_f32_16x16x32_bf16 v[40:43], a[192:195], a[16:19], 0
    ds_read_b64_tr_b16 a[240:241], v9 offset:8192
    ds_read_b64_tr_b16 a[250:251], v11 offset:12288
    v_add_f32 v21, v21, v36
    s_waitcnt vmcnt(12)
    s_add_u32 s50, s52, 0x8000
    s_sub_u32 s50, s50, s32
    v_add_u32 v31, s50, v1
    ds_read_b128 v[240:243], v31 offset:0
    v_add_u32 v30, s50, v2
    ds_read_b128 v[244:247], v30 offset:0
    v_add_u32 v31, s50, v3
    ds_read_b128 v[248:251], v31 offset:0
    v_add_u32 v30, s50, v4
    ds_read_b128 v[252:255], v30 offset:0
    s_waitcnt lgkmcnt(3)
    v_lshlrev_b32 v28, 16, v240
    v_and_b32 v29, s59, v240
    v_mul_f32 v28, s28, v28
    v_mul_f32 v29, s28, v29
    v_cvt_pk_bf16_f32 v240, v28, v29
    v_mfma_f32_16x16x32_bf16 v[40:43], a[196:199], a[20:23], v[40:43]
    ds_read_b64_tr_b16 a[252:253], v12 offset:8192
    s_add_u32 m0, s31, 65536
    v_exp_f32 v37, v37
    v_accvgpr_write_b32 a32, v240
    v_lshlrev_b32 v28, 16, v241
    v_and_b32 v29, s59, v241
    v_mul_f32 v28, s28, v28
    v_mul_f32 v29, s28, v29
    v_cvt_pk_bf16_f32 v241, v28, v29
    v_accvgpr_write_b32 a33, v241
    v_lshlrev_b32 v28, 16, v242
    v_and_b32 v29, s59, v242
    v_mul_f32 v28, s28, v28
    v_mul_f32 v29, s28, v29
    v_cvt_pk_bf16_f32 v242, v28, v29
    v_accvgpr_write_b32 a34, v242
    v_lshlrev_b32 v28, 16, v243
    v_and_b32 v29, s59, v243
    v_mfma_f32_16x16x32_bf16 v[40:43], a[200:203], a[24:27], v[40:43]
    ds_read_b64_tr_b16 a[254:255], v12 offset:12288
    v_cvt_pk_bf16_f32 v34, v36, v37
    v_add_f32 v21, v21, v37
    v_mul_f32 v28, s28, v28
    v_mul_f32 v29, s28, v29
    v_cvt_pk_bf16_f32 v243, v28, v29
    v_accvgpr_write_b32 a35, v243
    s_waitcnt lgkmcnt(4)
    v_lshlrev_b32 v28, 16, v244
    v_and_b32 v29, s59, v244
    v_mul_f32 v28, s28, v28
    v_mul_f32 v29, s28, v29
    v_cvt_pk_bf16_f32 v244, v28, v29
    v_accvgpr_write_b32 a36, v244
    v_lshlrev_b32 v28, 16, v245
    v_and_b32 v29, s59, v245
    v_mul_f32 v28, s28, v28
    v_mul_f32 v29, s28, v29
    v_cvt_pk_bf16_f32 v245, v28, v29
    v_mfma_f32_16x16x32_bf16 v[40:43], a[204:207], a[28:31], v[40:43]
    ds_read_b128 a[196:199], v2 offset:0
    buffer_load_dwordx4 v17, s[12:15], s30 offen offset:0 nt lds
    v_exp_f32 v38, v38
    v_accvgpr_write_b32 a37, v245
    v_lshlrev_b32 v28, 16, v246
    v_and_b32 v29, s59, v246
    v_mul_f32 v28, s28, v28
    v_mul_f32 v29, s28, v29
    v_cvt_pk_bf16_f32 v246, v28, v29
    v_accvgpr_write_b32 a38, v246
    v_lshlrev_b32 v28, 16, v247
    v_and_b32 v29, s59, v247
    v_mul_f32 v28, s28, v28
    v_mul_f32 v29, s28, v29
    v_cvt_pk_bf16_f32 v247, v28, v29
    v_accvgpr_write_b32 a39, v247
    s_waitcnt lgkmcnt(4)
    v_lshlrev_b32 v28, 16, v248
    v_and_b32 v29, s59, v248
    v_mfma_f32_16x16x32_bf16 v[44:47], a[208:211], a[16:19], 0
    ds_read_b64_tr_b16 a[242:243], v9 offset:12288
    ds_read_b128 a[200:203], v3 offset:0
    buffer_load_dwordx4 v18, s[12:15], s30 offen offset:1024 nt lds
    v_add_f32 v21, v21, v38
    v_mul_f32 v28, s28, v28
    v_mul_f32 v29, s28, v29
    v_cvt_pk_bf16_f32 v248, v28, v29
    v_accvgpr_write_b32 a40, v248
    v_lshlrev_b32 v28, 16, v249
    v_and_b32 v29, s59, v249
    v_mul_f32 v28, s28, v28
    v_mul_f32 v29, s28, v29
    v_cvt_pk_bf16_f32 v249, v28, v29
    v_accvgpr_write_b32 a41, v249
    v_lshlrev_b32 v28, 16, v250
    v_and_b32 v29, s59, v250
    v_mul_f32 v28, s28, v28
    v_mul_f32 v29, s28, v29
    v_cvt_pk_bf16_f32 v250, v28, v29
    v_accvgpr_write_b32 a42, v250
    v_mfma_f32_16x16x32_bf16 v[44:47], a[212:215], a[20:23], v[44:47]
    ds_read_b128 a[204:207], v4 offset:0
    v_exp_f32 v39, v39
    v_lshlrev_b32 v28, 16, v251
    v_and_b32 v29, s59, v251
    v_mul_f32 v28, s28, v28
    v_mul_f32 v29, s28, v29
    v_cvt_pk_bf16_f32 v251, v28, v29
    v_accvgpr_write_b32 a43, v251
    s_waitcnt lgkmcnt(6)
    v_lshlrev_b32 v28, 16, v252
    v_and_b32 v29, s59, v252
    v_mul_f32 v28, s28, v28
    v_mul_f32 v29, s28, v29
    v_cvt_pk_bf16_f32 v252, v28, v29
    v_accvgpr_write_b32 a44, v252
    v_lshlrev_b32 v28, 16, v253
    v_and_b32 v29, s59, v253
    v_mul_f32 v28, s28, v28
    v_mfma_f32_16x16x32_bf16 v[44:47], a[216:219], a[24:27], v[44:47]
    ds_read_b128 a[212:215], v2 offset:4096
    buffer_load_dwordx4 v17, s[12:15], s30 offen offset:2048 nt lds
    v_cvt_pk_bf16_f32 v35, v38, v39
    v_add_f32 v21, v21, v39
    v_mul_f32 v29, s28, v29
    v_cvt_pk_bf16_f32 v253, v28, v29
    v_accvgpr_write_b32 a45, v253
    v_lshlrev_b32 v28, 16, v254
    v_and_b32 v29, s59, v254
    v_mul_f32 v28, s28, v28
    v_mul_f32 v29, s28, v29
    v_cvt_pk_bf16_f32 v254, v28, v29
    v_accvgpr_write_b32 a46, v254
    v_lshlrev_b32 v28, 16, v255
    v_and_b32 v29, s59, v255
    v_mul_f32 v28, s28, v28
    v_mul_f32 v29, s28, v29
    v_cvt_pk_bf16_f32 v255, v28, v29
    v_accvgpr_write_b32 a47, v255
    v_mfma_f32_16x16x32_bf16 v[44:47], a[220:223], a[28:31], v[44:47]
    v_exp_f32 v40, v40
    s_add_u32 s50, s52, 0x18000
    s_sub_u32 s50, s50, s32
    v_add_u32 v31, s50, v1
    ds_read_b128 v[240:243], v31 offset:0
    v_add_u32 v30, s50, v2
    ds_read_b128 v[244:247], v30 offset:0
    v_add_u32 v31, s50, v3
    ds_read_b128 v[248:251], v31 offset:0
    v_add_u32 v30, s50, v4
    ds_read_b128 v[252:255], v30 offset:0
    s_waitcnt lgkmcnt(3)
    v_lshlrev_b32 v28, 16, v240
    v_and_b32 v29, s59, v240
    v_mul_f32 v28, s28, v28
    v_mul_f32 v29, s28, v29
    v_cvt_pk_bf16_f32 v240, v28, v29
    v_mfma_f32_16x16x32_bf16 v[64:67], a[224:227], v[32:35], v[64:67]
    ds_read_b128 a[192:195], v1 offset:0
    ds_read_b128 a[216:219], v3 offset:4096
    buffer_load_dwordx4 v18, s[12:15], s30 offen offset:3072 nt lds
    v_add_f32 v22, v22, v40
    v_accvgpr_write_b32 a48, v240
    v_lshlrev_b32 v28, 16, v241
    v_and_b32 v29, s59, v241
    v_mul_f32 v28, s28, v28
    v_mul_f32 v29, s28, v29
    v_cvt_pk_bf16_f32 v241, v28, v29
    v_accvgpr_write_b32 a49, v241
    v_lshlrev_b32 v28, 16, v242
    v_and_b32 v29, s59, v242
    v_mul_f32 v28, s28, v28
    v_mul_f32 v29, s28, v29
    v_cvt_pk_bf16_f32 v242, v28, v29
    v_accvgpr_write_b32 a50, v242
    v_lshlrev_b32 v28, 16, v243
    v_and_b32 v29, s59, v243
    v_mfma_f32_16x16x32_bf16 v[68:71], a[228:231], v[32:35], v[68:71]
    ds_read_b128 a[220:223], v4 offset:4096
    v_exp_f32 v41, v41
    v_mul_f32 v28, s28, v28
    v_mul_f32 v29, s28, v29
    v_cvt_pk_bf16_f32 v243, v28, v29
    v_accvgpr_write_b32 a51, v243
    s_waitcnt lgkmcnt(5)
    v_lshlrev_b32 v28, 16, v244
    v_and_b32 v29, s59, v244
    v_mul_f32 v28, s28, v28
    v_mul_f32 v29, s28, v29
    v_cvt_pk_bf16_f32 v244, v28, v29
    v_accvgpr_write_b32 a52, v244
    v_lshlrev_b32 v28, 16, v245
    v_and_b32 v29, s59, v245
    v_mul_f32 v28, s28, v28
    v_mul_f32 v29, s28, v29
    v_cvt_pk_bf16_f32 v245, v28, v29
    v_accvgpr_write_b32 a53, v245
    v_mfma_f32_16x16x32_bf16 v[72:75], a[232:235], v[32:35], v[72:75]
    s_add_u32 s31, s31, 0x4000
    v_cvt_pk_bf16_f32 v40, v40, v41
    v_add_f32 v22, v22, v41
    v_lshlrev_b32 v28, 16, v246
    v_and_b32 v29, s59, v246
    v_mul_f32 v28, s28, v28
    v_mul_f32 v29, s28, v29
    v_cvt_pk_bf16_f32 v246, v28, v29
    v_accvgpr_write_b32 a54, v246
    v_lshlrev_b32 v28, 16, v247
    v_and_b32 v29, s59, v247
    v_mul_f32 v28, s28, v28
    v_mul_f32 v29, s28, v29
    v_cvt_pk_bf16_f32 v247, v28, v29
    v_accvgpr_write_b32 a55, v247
    s_waitcnt lgkmcnt(4)
    v_lshlrev_b32 v28, 16, v248
    v_and_b32 v29, s59, v248
    v_mul_f32 v28, s28, v28
    v_mfma_f32_16x16x32_bf16 v[76:79], a[236:239], v[32:35], v[76:79]
    v_exp_f32 v42, v42
    v_mul_f32 v29, s28, v29
    v_cvt_pk_bf16_f32 v248, v28, v29
    v_accvgpr_write_b32 a56, v248
    v_lshlrev_b32 v28, 16, v249
    v_and_b32 v29, s59, v249
    v_mul_f32 v28, s28, v28
    v_mul_f32 v29, s28, v29
    v_cvt_pk_bf16_f32 v249, v28, v29
    v_accvgpr_write_b32 a57, v249
    v_lshlrev_b32 v28, 16, v250
    v_and_b32 v29, s59, v250
    v_mul_f32 v28, s28, v28
    v_mul_f32 v29, s28, v29
    v_cvt_pk_bf16_f32 v250, v28, v29
    v_accvgpr_write_b32 a58, v250
    v_mfma_f32_16x16x32_bf16 v[80:83], a[240:243], v[32:35], v[80:83]
    ds_read_b128 a[208:211], v1 offset:4096
    s_and_b32 s31, s31, 0xffff
    v_add_f32 v22, v22, v42
    v_lshlrev_b32 v28, 16, v251
    v_and_b32 v29, s59, v251
    v_mul_f32 v28, s28, v28
    v_mul_f32 v29, s28, v29
    v_cvt_pk_bf16_f32 v251, v28, v29
    v_accvgpr_write_b32 a59, v251
    s_waitcnt lgkmcnt(4)
    v_lshlrev_b32 v28, 16, v252
    v_and_b32 v29, s59, v252
    v_mul_f32 v28, s28, v28
    v_mul_f32 v29, s28, v29
    v_cvt_pk_bf16_f32 v252, v28, v29
    v_accvgpr_write_b32 a60, v252
    v_lshlrev_b32 v28, 16, v253
    v_and_b32 v29, s59, v253
    v_mul_f32 v28, s28, v28
    v_mfma_f32_16x16x32_bf16 v[84:87], a[244:247], v[32:35], v[84:87]
    v_exp_f32 v43, v43
    v_mul_f32 v29, s28, v29
    v_cvt_pk_bf16_f32 v253, v28, v29
    v_accvgpr_write_b32 a61, v253
    v_lshlrev_b32 v28, 16, v254
    v_and_b32 v29, s59, v254
    v_mul_f32 v28, s28, v28
    v_mul_f32 v29, s28, v29
    v_cvt_pk_bf16_f32 v254, v28, v29
    v_accvgpr_write_b32 a62, v254
    v_lshlrev_b32 v28, 16, v255
    v_and_b32 v29, s59, v255
    v_mul_f32 v28, s28, v28
    v_mul_f32 v29, s28, v29
    v_cvt_pk_bf16_f32 v255, v28, v29
    v_accvgpr_write_b32 a63, v255
    v_mfma_f32_16x16x32_bf16 v[88:91], a[248:251], v[32:35], v[88:91]
    s_add_u32 s30, s30, 0x4000
    v_cvt_pk_bf16_f32 v41, v42, v43
    v_add_f32 v22, v22, v43
    v_mfma_f32_16x16x32_bf16 v[92:95], a[252:255], v[32:35], v[92:95]
    s_waitcnt lgkmcnt(3)
    v_exp_f32 v44, v44
    v_mfma_f32_16x16x32_bf16 v[32:35], a[192:195], a[32:35], 0
    s_mov_b32 m0, s31
    s_nop 0
    buffer_load_dwordx4 v13, s[8:11], s30 offen offset:0 nt lds
    v_add_f32 v22, v22, v44
    v_add_u32 v6, s33, v6
    v_mfma_f32_16x16x32_bf16 v[32:35], a[196:199], a[36:39], v[32:35]
    v_exp_f32 v45, v45
    v_mfma_f32_16x16x32_bf16 v[32:35], a[200:203], a[40:43], v[32:35]
    buffer_load_dwordx4 v14, s[8:11], s30 offen offset:1024 nt lds
    v_cvt_pk_bf16_f32 v42, v44, v45
    v_add_f32 v22, v22, v45
    v_mfma_f32_16x16x32_bf16 v[32:35], a[204:207], a[44:47], v[32:35]
    s_waitcnt lgkmcnt(0)
    v_exp_f32 v46, v46
    v_mfma_f32_16x16x32_bf16 v[36:39], a[208:211], a[32:35], 0
    buffer_load_dwordx4 v15, s[8:11], s30 offen offset:2048 nt lds
    v_add_f32 v22, v22, v46
    v_add_u32 v7, s33, v7
    v_mfma_f32_16x16x32_bf16 v[36:39], a[212:215], a[36:39], v[36:39]
    v_exp_f32 v47, v47
    v_mfma_f32_16x16x32_bf16 v[36:39], a[216:219], a[40:43], v[36:39]
    buffer_load_dwordx4 v16, s[8:11], s30 offen offset:3072 nt lds
    v_cvt_pk_bf16_f32 v43, v46, v47
    v_add_f32 v22, v22, v47
    v_mfma_f32_16x16x32_bf16 v[36:39], a[220:223], a[44:47], v[36:39]
    v_exp_f32 v32, v32
    v_mfma_f32_16x16x32_bf16 v[96:99], a[224:227], v[40:43], v[96:99]
    s_add_u32 m0, s31, 65536
    s_nop 0
    buffer_load_dwordx4 v17, s[12:15], s30 offen offset:0 nt lds
    v_mov_b32 v23, v32
    v_add_u32 v8, s33, v8
    v_mfma_f32_16x16x32_bf16 v[100:103], a[228:231], v[40:43], v[100:103]
    v_exp_f32 v33, v33
    v_mfma_f32_16x16x32_bf16 v[104:107], a[232:235], v[40:43], v[104:107]
    buffer_load_dwordx4 v18, s[12:15], s30 offen offset:1024 nt lds
    v_cvt_pk_bf16_f32 v32, v32, v33
    v_add_f32 v23, v23, v33
    v_mfma_f32_16x16x32_bf16 v[108:111], a[236:239], v[40:43], v[108:111]
    v_exp_f32 v34, v34
    v_mfma_f32_16x16x32_bf16 v[112:115], a[240:243], v[40:43], v[112:115]
    ds_read_b64_tr_b16 a[240:241], v9 offset:0
    buffer_load_dwordx4 v17, s[12:15], s30 offen offset:2048 nt lds
    v_add_f32 v23, v23, v34
    v_mfma_f32_16x16x32_bf16 v[116:119], a[244:247], v[40:43], v[116:119]
    ds_read_b64_tr_b16 a[246:247], v10 offset:4096
    v_exp_f32 v35, v35
    v_mfma_f32_16x16x32_bf16 v[120:123], a[248:251], v[40:43], v[120:123]
    ds_read_b64_tr_b16 a[248:249], v11 offset:0
    buffer_load_dwordx4 v18, s[12:15], s30 offen offset:3072 nt lds
    v_cvt_pk_bf16_f32 v33, v34, v35
    v_add_f32 v23, v23, v35
    v_mfma_f32_16x16x32_bf16 v[124:127], a[252:255], v[40:43], v[124:127]
    ds_read_b64_tr_b16 a[250:251], v11 offset:4096
    v_exp_f32 v36, v36
    v_mfma_f32_16x16x32_bf16 v[40:43], a[192:195], a[48:51], 0
    ds_read_b64_tr_b16 a[242:243], v9 offset:4096
    ds_read_b64_tr_b16 a[252:253], v12 offset:0
    s_add_u32 s31, s31, 0x4000
    s_and_b32 s31, s31, 0xffff
    s_add_u32 s30, s30, 0x4000
    v_add_f32 v23, v23, v36
    v_mfma_f32_16x16x32_bf16 v[40:43], a[196:199], a[52:55], v[40:43]
    ds_read_b64_tr_b16 a[254:255], v12 offset:4096
    v_exp_f32 v37, v37
    v_mfma_f32_16x16x32_bf16 v[40:43], a[200:203], a[56:59], v[40:43]
    ds_read_b128 a[196:199], v2 offset:8192
    v_cvt_pk_bf16_f32 v34, v36, v37
    v_add_f32 v23, v23, v37
    v_mfma_f32_16x16x32_bf16 v[40:43], a[204:207], a[60:63], v[40:43]
    ds_read_b128 a[200:203], v3 offset:8192
    v_exp_f32 v38, v38
    v_mfma_f32_16x16x32_bf16 v[44:47], a[208:211], a[48:51], 0
    ds_read_b64_tr_b16 a[244:245], v10 offset:0
    ds_read_b128 a[204:207], v4 offset:8192
    v_add_f32 v23, v23, v38
    v_mfma_f32_16x16x32_bf16 v[44:47], a[212:215], a[52:55], v[44:47]
    ds_read_b128 a[212:215], v2 offset:12288
    v_exp_f32 v39, v39
    v_mfma_f32_16x16x32_bf16 v[44:47], a[216:219], a[56:59], v[44:47]
    ds_read_b128 a[216:219], v3 offset:12288
    v_cvt_pk_bf16_f32 v35, v38, v39
    v_add_f32 v23, v23, v39
    v_mfma_f32_16x16x32_bf16 v[44:47], a[220:223], a[60:63], v[44:47]
    v_exp_f32 v40, v40
    v_mfma_f32_16x16x32_bf16 v[128:131], v[48:51], v[32:35], 0
    ds_read_b128 a[192:195], v1 offset:8192
    ds_read_b128 a[220:223], v4 offset:12288
    v_mov_b32 v24, v40
    v_mfma_f32_16x16x32_bf16 v[132:135], v[52:55], v[32:35], 0
    v_exp_f32 v41, v41
    v_mfma_f32_16x16x32_bf16 v[136:139], v[56:59], v[32:35], 0
    v_cvt_pk_bf16_f32 v40, v40, v41
    v_add_f32 v24, v24, v41
    v_mfma_f32_16x16x32_bf16 v[140:143], v[60:63], v[32:35], 0
    s_waitcnt lgkmcnt(5)
    v_exp_f32 v42, v42
    v_mfma_f32_16x16x32_bf16 v[144:147], a[240:243], v[32:35], 0
    ds_read_b128 a[208:211], v1 offset:12288
    v_add_f32 v24, v24, v42
    v_mfma_f32_16x16x32_bf16 v[148:151], a[244:247], v[32:35], 0
    v_exp_f32 v43, v43
    v_mfma_f32_16x16x32_bf16 v[152:155], a[248:251], v[32:35], 0
    v_cvt_pk_bf16_f32 v41, v42, v43
    v_add_f32 v24, v24, v43
    v_mfma_f32_16x16x32_bf16 v[156:159], a[252:255], v[32:35], 0
    s_waitcnt lgkmcnt(2)
    v_exp_f32 v44, v44
    v_mfma_f32_16x16x32_bf16 v[32:35], a[192:195], a[32:35], 0
    v_add_f32 v24, v24, v44
    v_mfma_f32_16x16x32_bf16 v[32:35], a[196:199], a[36:39], v[32:35]
    v_exp_f32 v45, v45
    v_mfma_f32_16x16x32_bf16 v[32:35], a[200:203], a[40:43], v[32:35]
    v_cvt_pk_bf16_f32 v42, v44, v45
    v_add_f32 v24, v24, v45
    v_mfma_f32_16x16x32_bf16 v[32:35], a[204:207], a[44:47], v[32:35]
    s_waitcnt lgkmcnt(0)
    v_exp_f32 v46, v46
    v_mfma_f32_16x16x32_bf16 v[36:39], a[208:211], a[32:35], 0
    v_add_f32 v24, v24, v46
    v_mfma_f32_16x16x32_bf16 v[36:39], a[212:215], a[36:39], v[36:39]
    v_exp_f32 v47, v47
    v_mfma_f32_16x16x32_bf16 v[36:39], a[216:219], a[40:43], v[36:39]
    v_cvt_pk_bf16_f32 v43, v46, v47
    v_add_f32 v24, v24, v47
    v_mfma_f32_16x16x32_bf16 v[36:39], a[220:223], a[44:47], v[36:39]
    v_exp_f32 v32, v32
    v_mfma_f32_16x16x32_bf16 v[160:163], v[48:51], v[40:43], 0
    v_add_f32 v23, v23, v32
    v_mfma_f32_16x16x32_bf16 v[164:167], v[52:55], v[40:43], 0
    v_exp_f32 v33, v33
    v_mfma_f32_16x16x32_bf16 v[168:171], v[56:59], v[40:43], 0
    v_cvt_pk_bf16_f32 v32, v32, v33
    v_add_f32 v23, v23, v33
    v_mfma_f32_16x16x32_bf16 v[172:175], v[60:63], v[40:43], 0
    v_exp_f32 v34, v34
    v_mfma_f32_16x16x32_bf16 v[176:179], a[240:243], v[40:43], 0
    ds_read_b64_tr_b16 a[240:241], v9 offset:8192
    v_add_f32 v23, v23, v34
    v_mfma_f32_16x16x32_bf16 v[180:183], a[244:247], v[40:43], 0
    ds_read_b64_tr_b16 a[246:247], v10 offset:12288
    v_exp_f32 v35, v35
    v_mfma_f32_16x16x32_bf16 v[184:187], a[248:251], v[40:43], 0
    ds_read_b64_tr_b16 a[248:249], v11 offset:8192
    v_cvt_pk_bf16_f32 v33, v34, v35
    v_add_f32 v23, v23, v35
    v_mfma_f32_16x16x32_bf16 v[188:191], a[252:255], v[40:43], 0
    ds_read_b64_tr_b16 a[250:251], v11 offset:12288
    v_exp_f32 v36, v36
    v_mfma_f32_16x16x32_bf16 v[40:43], a[192:195], a[48:51], 0
    ds_read_b64_tr_b16 a[242:243], v9 offset:12288
    ds_read_b64_tr_b16 a[252:253], v12 offset:8192
    v_add_f32 v23, v23, v36
    s_waitcnt vmcnt(16)
    s_add_u32 s50, s52, 0xc000
    s_sub_u32 s50, s50, s32
    v_add_u32 v31, s50, v1
    ds_read_b128 v[240:243], v31 offset:0
    v_add_u32 v30, s50, v2
    ds_read_b128 v[244:247], v30 offset:0
    v_add_u32 v31, s50, v3
    ds_read_b128 v[248:251], v31 offset:0
    v_add_u32 v30, s50, v4
    ds_read_b128 v[252:255], v30 offset:0
    s_waitcnt lgkmcnt(3)
    v_lshlrev_b32 v28, 16, v240
    v_and_b32 v29, s59, v240
    v_mul_f32 v28, s28, v28
    v_mul_f32 v29, s28, v29
    v_cvt_pk_bf16_f32 v240, v28, v29
    v_mfma_f32_16x16x32_bf16 v[40:43], a[196:199], a[52:55], v[40:43]
    ds_read_b64_tr_b16 a[254:255], v12 offset:12288
    v_exp_f32 v37, v37
    v_accvgpr_write_b32 a64, v240
    v_lshlrev_b32 v28, 16, v241
    v_and_b32 v29, s59, v241
    v_mul_f32 v28, s28, v28
    v_mul_f32 v29, s28, v29
    v_cvt_pk_bf16_f32 v241, v28, v29
    v_accvgpr_write_b32 a65, v241
    v_lshlrev_b32 v28, 16, v242
    v_and_b32 v29, s59, v242
    v_mul_f32 v28, s28, v28
    v_mul_f32 v29, s28, v29
    v_cvt_pk_bf16_f32 v242, v28, v29
    v_accvgpr_write_b32 a66, v242
    v_lshlrev_b32 v28, 16, v243
    v_and_b32 v29, s59, v243
    v_mfma_f32_16x16x32_bf16 v[40:43], a[200:203], a[56:59], v[40:43]
    ds_read_b128 a[196:199], v2 offset:0
    v_cvt_pk_bf16_f32 v34, v36, v37
    v_add_f32 v23, v23, v37
    v_mul_f32 v28, s28, v28
    v_mul_f32 v29, s28, v29
    v_cvt_pk_bf16_f32 v243, v28, v29
    v_accvgpr_write_b32 a67, v243
    s_waitcnt lgkmcnt(4)
    v_lshlrev_b32 v28, 16, v244
    v_and_b32 v29, s59, v244
    v_mul_f32 v28, s28, v28
    v_mul_f32 v29, s28, v29
    v_cvt_pk_bf16_f32 v244, v28, v29
    v_accvgpr_write_b32 a68, v244
    v_lshlrev_b32 v28, 16, v245
    v_and_b32 v29, s59, v245
    v_mul_f32 v28, s28, v28
    v_mul_f32 v29, s28, v29
    v_cvt_pk_bf16_f32 v245, v28, v29
    v_mfma_f32_16x16x32_bf16 v[40:43], a[204:207], a[60:63], v[40:43]
    ds_read_b128 a[200:203], v3 offset:0
    v_exp_f32 v38, v38
    v_accvgpr_write_b32 a69, v245
    v_lshlrev_b32 v28, 16, v246
    v_and_b32 v29, s59, v246
    v_mul_f32 v28, s28, v28
    v_mul_f32 v29, s28, v29
    v_cvt_pk_bf16_f32 v246, v28, v29
    v_accvgpr_write_b32 a70, v246
    v_lshlrev_b32 v28, 16, v247
    v_and_b32 v29, s59, v247
    v_mul_f32 v28, s28, v28
    v_mul_f32 v29, s28, v29
    v_cvt_pk_bf16_f32 v247, v28, v29
    v_accvgpr_write_b32 a71, v247
    s_waitcnt lgkmcnt(4)
    v_lshlrev_b32 v28, 16, v248
    v_and_b32 v29, s59, v248
    v_mfma_f32_16x16x32_bf16 v[44:47], a[208:211], a[48:51], 0
    ds_read_b64_tr_b16 a[244:245], v10 offset:8192
    ds_read_b128 a[204:207], v4 offset:0
    v_add_f32 v23, v23, v38
    v_mul_f32 v28, s28, v28
    v_mul_f32 v29, s28, v29
    v_cvt_pk_bf16_f32 v248, v28, v29
    v_accvgpr_write_b32 a72, v248
    v_lshlrev_b32 v28, 16, v249
    v_and_b32 v29, s59, v249
    v_mul_f32 v28, s28, v28
    v_mul_f32 v29, s28, v29
    v_cvt_pk_bf16_f32 v249, v28, v29
    v_accvgpr_write_b32 a73, v249
    v_lshlrev_b32 v28, 16, v250
    v_and_b32 v29, s59, v250
    v_mul_f32 v28, s28, v28
    v_mul_f32 v29, s28, v29
    v_cvt_pk_bf16_f32 v250, v28, v29
    v_accvgpr_write_b32 a74, v250
    v_mfma_f32_16x16x32_bf16 v[44:47], a[212:215], a[52:55], v[44:47]
    ds_read_b128 a[212:215], v2 offset:4096
    v_exp_f32 v39, v39
    v_lshlrev_b32 v28, 16, v251
    v_and_b32 v29, s59, v251
    v_mul_f32 v28, s28, v28
    v_mul_f32 v29, s28, v29
    v_cvt_pk_bf16_f32 v251, v28, v29
    v_accvgpr_write_b32 a75, v251
    s_waitcnt lgkmcnt(6)
    v_lshlrev_b32 v28, 16, v252
    v_and_b32 v29, s59, v252
    v_mul_f32 v28, s28, v28
    v_mul_f32 v29, s28, v29
    v_cvt_pk_bf16_f32 v252, v28, v29
    v_accvgpr_write_b32 a76, v252
    v_lshlrev_b32 v28, 16, v253
    v_and_b32 v29, s59, v253
    v_mul_f32 v28, s28, v28
    v_mfma_f32_16x16x32_bf16 v[44:47], a[216:219], a[56:59], v[44:47]
    ds_read_b128 a[216:219], v3 offset:4096
    v_cvt_pk_bf16_f32 v35, v38, v39
    v_add_f32 v23, v23, v39
    v_mul_f32 v29, s28, v29
    v_cvt_pk_bf16_f32 v253, v28, v29
    v_accvgpr_write_b32 a77, v253
    v_lshlrev_b32 v28, 16, v254
    v_and_b32 v29, s59, v254
    v_mul_f32 v28, s28, v28
    v_mul_f32 v29, s28, v29
    v_cvt_pk_bf16_f32 v254, v28, v29
    v_accvgpr_write_b32 a78, v254
    v_lshlrev_b32 v28, 16, v255
    v_and_b32 v29, s59, v255
    v_mul_f32 v28, s28, v28
    v_mul_f32 v29, s28, v29
    v_cvt_pk_bf16_f32 v255, v28, v29
    v_accvgpr_write_b32 a79, v255
    v_mfma_f32_16x16x32_bf16 v[44:47], a[220:223], a[60:63], v[44:47]
    v_exp_f32 v40, v40
    s_add_u32 s50, s52, 0x1c000
    s_sub_u32 s50, s50, s32
    v_add_u32 v31, s50, v1
    ds_read_b128 v[240:243], v31 offset:0
    v_add_u32 v30, s50, v2
    ds_read_b128 v[244:247], v30 offset:0
    v_add_u32 v31, s50, v3
    ds_read_b128 v[248:251], v31 offset:0
    v_add_u32 v30, s50, v4
    ds_read_b128 v[252:255], v30 offset:0
    s_waitcnt lgkmcnt(3)
    v_lshlrev_b32 v28, 16, v240
    v_and_b32 v29, s59, v240
    v_mul_f32 v28, s28, v28
    v_mul_f32 v29, s28, v29
    v_cvt_pk_bf16_f32 v240, v28, v29
    v_mfma_f32_16x16x32_bf16 v[128:131], a[224:227], v[32:35], v[128:131]
    ds_read_b128 a[192:195], v1 offset:0
    ds_read_b128 a[220:223], v4 offset:4096
    v_add_f32 v24, v24, v40
    v_accvgpr_write_b32 a80, v240
    v_lshlrev_b32 v28, 16, v241
    v_and_b32 v29, s59, v241
    v_mul_f32 v28, s28, v28
    v_mul_f32 v29, s28, v29
    v_cvt_pk_bf16_f32 v241, v28, v29
    v_accvgpr_write_b32 a81, v241
    v_lshlrev_b32 v28, 16, v242
    v_and_b32 v29, s59, v242
    v_mul_f32 v28, s28, v28
    v_mul_f32 v29, s28, v29
    v_cvt_pk_bf16_f32 v242, v28, v29
    v_accvgpr_write_b32 a82, v242
    v_lshlrev_b32 v28, 16, v243
    v_and_b32 v29, s59, v243
    v_mfma_f32_16x16x32_bf16 v[132:135], a[228:231], v[32:35], v[132:135]
    v_exp_f32 v41, v41
    v_mul_f32 v28, s28, v28
    v_mul_f32 v29, s28, v29
    v_cvt_pk_bf16_f32 v243, v28, v29
    v_accvgpr_write_b32 a83, v243
    s_waitcnt lgkmcnt(4)
    v_lshlrev_b32 v28, 16, v244
    v_and_b32 v29, s59, v244
    v_mul_f32 v28, s28, v28
    v_mul_f32 v29, s28, v29
    v_cvt_pk_bf16_f32 v244, v28, v29
    v_accvgpr_write_b32 a84, v244
    v_lshlrev_b32 v28, 16, v245
    v_and_b32 v29, s59, v245
    v_mul_f32 v28, s28, v28
    v_mul_f32 v29, s28, v29
    v_cvt_pk_bf16_f32 v245, v28, v29
    v_accvgpr_write_b32 a85, v245
    v_mfma_f32_16x16x32_bf16 v[136:139], a[232:235], v[32:35], v[136:139]
    v_cvt_pk_bf16_f32 v40, v40, v41
    v_add_f32 v24, v24, v41
    v_lshlrev_b32 v28, 16, v246
    v_and_b32 v29, s59, v246
    v_mul_f32 v28, s28, v28
    v_mul_f32 v29, s28, v29
    v_cvt_pk_bf16_f32 v246, v28, v29
    v_accvgpr_write_b32 a86, v246
    v_lshlrev_b32 v28, 16, v247
    v_and_b32 v29, s59, v247
    v_mul_f32 v28, s28, v28
    v_mul_f32 v29, s28, v29
    v_cvt_pk_bf16_f32 v247, v28, v29
    v_accvgpr_write_b32 a87, v247
    s_waitcnt lgkmcnt(3)
    v_lshlrev_b32 v28, 16, v248
    v_and_b32 v29, s59, v248
    v_mul_f32 v28, s28, v28
    v_mfma_f32_16x16x32_bf16 v[140:143], a[236:239], v[32:35], v[140:143]
    v_exp_f32 v42, v42
    v_mul_f32 v29, s28, v29
    v_cvt_pk_bf16_f32 v248, v28, v29
    v_accvgpr_write_b32 a88, v248
    v_lshlrev_b32 v28, 16, v249
    v_and_b32 v29, s59, v249
    v_mul_f32 v28, s28, v28
    v_mul_f32 v29, s28, v29
    v_cvt_pk_bf16_f32 v249, v28, v29
    v_accvgpr_write_b32 a89, v249
    v_lshlrev_b32 v28, 16, v250
    v_and_b32 v29, s59, v250
    v_mul_f32 v28, s28, v28
    v_mul_f32 v29, s28, v29
    v_cvt_pk_bf16_f32 v250, v28, v29
    v_accvgpr_write_b32 a90, v250
    v_mfma_f32_16x16x32_bf16 v[144:147], a[240:243], v[32:35], v[144:147]
    ds_read_b128 a[208:211], v1 offset:4096
    v_add_f32 v24, v24, v42
    v_lshlrev_b32 v28, 16, v251
    v_and_b32 v29, s59, v251
    v_mul_f32 v28, s28, v28
    v_mul_f32 v29, s28, v29
    v_cvt_pk_bf16_f32 v251, v28, v29
    v_accvgpr_write_b32 a91, v251
    s_waitcnt lgkmcnt(3)
    v_lshlrev_b32 v28, 16, v252
    v_and_b32 v29, s59, v252
    v_mul_f32 v28, s28, v28
    v_mul_f32 v29, s28, v29
    v_cvt_pk_bf16_f32 v252, v28, v29
    v_accvgpr_write_b32 a92, v252
    v_lshlrev_b32 v28, 16, v253
    v_and_b32 v29, s59, v253
    v_mul_f32 v28, s28, v28
    v_mfma_f32_16x16x32_bf16 v[148:151], a[244:247], v[32:35], v[148:151]
    v_exp_f32 v43, v43
    v_mul_f32 v29, s28, v29
    v_cvt_pk_bf16_f32 v253, v28, v29
    v_accvgpr_write_b32 a93, v253
    v_lshlrev_b32 v28, 16, v254
    v_and_b32 v29, s59, v254
    v_mul_f32 v28, s28, v28
    v_mul_f32 v29, s28, v29
    v_cvt_pk_bf16_f32 v254, v28, v29
    v_accvgpr_write_b32 a94, v254
    v_lshlrev_b32 v28, 16, v255
    v_and_b32 v29, s59, v255
    v_mul_f32 v28, s28, v28
    v_mul_f32 v29, s28, v29
    v_cvt_pk_bf16_f32 v255, v28, v29
    v_accvgpr_write_b32 a95, v255
    v_mfma_f32_16x16x32_bf16 v[152:155], a[248:251], v[32:35], v[152:155]
    v_cvt_pk_bf16_f32 v41, v42, v43
    v_add_f32 v24, v24, v43
    v_mfma_f32_16x16x32_bf16 v[156:159], a[252:255], v[32:35], v[156:159]
    s_waitcnt lgkmcnt(2)
    v_exp_f32 v44, v44
    v_mfma_f32_16x16x32_bf16 v[32:35], a[192:195], a[64:67], 0
    s_mov_b32 s41, 0x40000000
    s_mov_b32 m0, 0x30000
    s_nop 0
    buffer_load_dwordx4 v13, s[16:19], s41 offen offset:0 nt lds
    v_add_f32 v24, v24, v44
    v_mfma_f32_16x16x32_bf16 v[32:35], a[196:199], a[68:71], v[32:35]
    v_exp_f32 v45, v45
    v_mfma_f32_16x16x32_bf16 v[32:35], a[200:203], a[72:75], v[32:35]
    buffer_load_dwordx4 v14, s[16:19], s41 offen offset:1024 nt lds
    v_cvt_pk_bf16_f32 v42, v44, v45
    v_add_f32 v24, v24, v45
    v_mfma_f32_16x16x32_bf16 v[32:35], a[204:207], a[76:79], v[32:35]
    s_waitcnt lgkmcnt(0)
    v_exp_f32 v46, v46
    v_mfma_f32_16x16x32_bf16 v[36:39], a[208:211], a[64:67], 0
    s_mov_b32 m0, s31
    s_nop 0
    buffer_load_dwordx4 v13, s[8:11], s30 offen offset:0 nt lds
    v_add_f32 v24, v24, v46
    v_mfma_f32_16x16x32_bf16 v[36:39], a[212:215], a[68:71], v[36:39]
    v_exp_f32 v47, v47
    v_mfma_f32_16x16x32_bf16 v[36:39], a[216:219], a[72:75], v[36:39]
    buffer_load_dwordx4 v14, s[8:11], s30 offen offset:1024 nt lds
    v_cvt_pk_bf16_f32 v43, v46, v47
    v_add_f32 v24, v24, v47
    v_mfma_f32_16x16x32_bf16 v[36:39], a[220:223], a[76:79], v[36:39]
    v_exp_f32 v32, v32
    v_mfma_f32_16x16x32_bf16 v[160:163], a[224:227], v[40:43], v[160:163]
    buffer_load_dwordx4 v15, s[8:11], s30 offen offset:2048 nt lds
    v_mov_b32 v25, v32
    v_mfma_f32_16x16x32_bf16 v[164:167], a[228:231], v[40:43], v[164:167]
    v_exp_f32 v33, v33
    v_mfma_f32_16x16x32_bf16 v[168:171], a[232:235], v[40:43], v[168:171]
    buffer_load_dwordx4 v16, s[8:11], s30 offen offset:3072 nt lds
    v_cvt_pk_bf16_f32 v32, v32, v33
    v_add_f32 v25, v25, v33
    v_mfma_f32_16x16x32_bf16 v[172:175], a[236:239], v[40:43], v[172:175]
    v_exp_f32 v34, v34
    v_mfma_f32_16x16x32_bf16 v[176:179], a[240:243], v[40:43], v[176:179]
    ds_read_b64_tr_b16 a[240:241], v9 offset:0
    s_add_u32 m0, s31, 65536
    s_nop 0
    buffer_load_dwordx4 v17, s[12:15], s30 offen offset:0 nt lds
    v_add_f32 v25, v25, v34
    v_mfma_f32_16x16x32_bf16 v[180:183], a[244:247], v[40:43], v[180:183]
    ds_read_b64_tr_b16 a[246:247], v10 offset:4096
    v_exp_f32 v35, v35
    v_mfma_f32_16x16x32_bf16 v[184:187], a[248:251], v[40:43], v[184:187]
    ds_read_b64_tr_b16 a[248:249], v11 offset:0
    buffer_load_dwordx4 v18, s[12:15], s30 offen offset:1024 nt lds
    v_cvt_pk_bf16_f32 v33, v34, v35
    v_add_f32 v25, v25, v35
    v_mfma_f32_16x16x32_bf16 v[188:191], a[252:255], v[40:43], v[188:191]
    ds_read_b64_tr_b16 a[250:251], v11 offset:4096
    v_exp_f32 v36, v36
    v_mfma_f32_16x16x32_bf16 v[40:43], a[192:195], a[80:83], 0
    ds_read_b64_tr_b16 a[242:243], v9 offset:4096
    ds_read_b64_tr_b16 a[252:253], v12 offset:0
    buffer_load_dwordx4 v17, s[12:15], s30 offen offset:2048 nt lds
    v_add_f32 v25, v25, v36
    v_mfma_f32_16x16x32_bf16 v[40:43], a[196:199], a[84:87], v[40:43]
    ds_read_b64_tr_b16 a[254:255], v12 offset:4096
    v_exp_f32 v37, v37
    v_mfma_f32_16x16x32_bf16 v[40:43], a[200:203], a[88:91], v[40:43]
    ds_read_b128 a[196:199], v2 offset:8192
    buffer_load_dwordx4 v18, s[12:15], s30 offen offset:3072 nt lds
    v_cvt_pk_bf16_f32 v34, v36, v37
    v_add_f32 v25, v25, v37
    v_mfma_f32_16x16x32_bf16 v[40:43], a[204:207], a[92:95], v[40:43]
    ds_read_b128 a[200:203], v3 offset:8192
    v_exp_f32 v38, v38
    v_mfma_f32_16x16x32_bf16 v[44:47], a[208:211], a[80:83], 0
    ds_read_b64_tr_b16 a[244:245], v10 offset:0
    ds_read_b128 a[204:207], v4 offset:8192
    s_add_u32 s31, s31, 0x4000
    s_and_b32 s31, s31, 0xffff
    s_add_u32 s30, s30, 0x4000
    v_add_f32 v25, v25, v38
    v_mfma_f32_16x16x32_bf16 v[44:47], a[212:215], a[84:87], v[44:47]
    s_mov_b32 s32, s35
    ds_read_b128 a[212:215], v2 offset:12288
    v_exp_f32 v39, v39
    v_mfma_f32_16x16x32_bf16 v[44:47], a[216:219], a[88:91], v[44:47]
    ds_read_b128 a[216:219], v3 offset:12288
    v_cvt_pk_bf16_f32 v35, v38, v39
    v_add_f32 v25, v25, v39
    v_mfma_f32_16x16x32_bf16 v[44:47], a[220:223], a[92:95], v[44:47]
    v_exp_f32 v40, v40
    v_mfma_f32_16x16x32_bf16 v[192:195], v[48:51], v[32:35], 0
    ds_read_b128 a[192:195], v1 offset:8192
    ds_read_b128 a[220:223], v4 offset:12288
    v_mov_b32 v26, v40
    v_mfma_f32_16x16x32_bf16 v[196:199], v[52:55], v[32:35], 0
    v_exp_f32 v41, v41
    v_add_u32 v3, s33, v3
    v_mfma_f32_16x16x32_bf16 v[200:203], v[56:59], v[32:35], 0
    v_cvt_pk_bf16_f32 v40, v40, v41
    v_add_f32 v26, v26, v41
    v_add_u32 v4, s33, v4
    v_mfma_f32_16x16x32_bf16 v[204:207], v[60:63], v[32:35], 0
    s_waitcnt lgkmcnt(5)
    v_exp_f32 v42, v42
    v_mfma_f32_16x16x32_bf16 v[208:211], a[240:243], v[32:35], 0
    ds_read_b128 a[208:211], v1 offset:12288
    v_add_f32 v26, v26, v42
    v_mfma_f32_16x16x32_bf16 v[212:215], a[244:247], v[32:35], 0
    v_exp_f32 v43, v43
    v_mfma_f32_16x16x32_bf16 v[216:219], a[248:251], v[32:35], 0
    v_cvt_pk_bf16_f32 v41, v42, v43
    v_add_f32 v26, v26, v43
    v_mfma_f32_16x16x32_bf16 v[220:223], a[252:255], v[32:35], 0
    s_waitcnt lgkmcnt(2)
    v_exp_f32 v44, v44
    v_mfma_f32_16x16x32_bf16 v[32:35], a[192:195], a[64:67], 0
    v_add_f32 v26, v26, v44
    v_add_u32 v1, s33, v1
    v_mfma_f32_16x16x32_bf16 v[32:35], a[196:199], a[68:71], v[32:35]
    v_exp_f32 v45, v45
    v_mfma_f32_16x16x32_bf16 v[32:35], a[200:203], a[72:75], v[32:35]
    v_cvt_pk_bf16_f32 v42, v44, v45
    v_add_f32 v26, v26, v45
    v_mfma_f32_16x16x32_bf16 v[32:35], a[204:207], a[76:79], v[32:35]
    s_waitcnt lgkmcnt(0)
    v_exp_f32 v46, v46
    v_mfma_f32_16x16x32_bf16 v[36:39], a[208:211], a[64:67], 0
    v_add_f32 v26, v26, v46
    v_add_u32 v2, s33, v2
    v_mfma_f32_16x16x32_bf16 v[36:39], a[212:215], a[68:71], v[36:39]
    v_exp_f32 v47, v47
    v_mfma_f32_16x16x32_bf16 v[36:39], a[216:219], a[72:75], v[36:39]
    v_cvt_pk_bf16_f32 v43, v46, v47
    v_add_f32 v26, v26, v47
    v_mfma_f32_16x16x32_bf16 v[36:39], a[220:223], a[76:79], v[36:39]
    v_exp_f32 v32, v32
    v_mfma_f32_16x16x32_bf16 v[224:227], v[48:51], v[40:43], 0
    v_add_f32 v25, v25, v32
    v_mfma_f32_16x16x32_bf16 v[228:231], v[52:55], v[40:43], 0
    v_exp_f32 v33, v33
    v_mfma_f32_16x16x32_bf16 v[232:235], v[56:59], v[40:43], 0
    v_cvt_pk_bf16_f32 v32, v32, v33
    v_add_f32 v25, v25, v33
    v_mfma_f32_16x16x32_bf16 v[236:239], v[60:63], v[40:43], 0
    v_exp_f32 v34, v34
    v_mfma_f32_16x16x32_bf16 v[240:243], a[240:243], v[40:43], 0
    ds_read_b64_tr_b16 a[240:241], v9 offset:8192
    v_add_f32 v25, v25, v34
    v_mfma_f32_16x16x32_bf16 v[244:247], a[244:247], v[40:43], 0
    s_waitcnt vmcnt(18) lgkmcnt(0)
    s_barrier
    v_exp_f32 v35, v35
    v_mfma_f32_16x16x32_bf16 v[248:251], a[248:251], v[40:43], 0
    ds_read_b64_tr_b16 a[246:247], v10 offset:12288
    v_cvt_pk_bf16_f32 v33, v34, v35
    v_add_f32 v25, v25, v35
    v_mfma_f32_16x16x32_bf16 v[252:255], a[252:255], v[40:43], 0
    ds_read_b64_tr_b16 a[248:249], v11 offset:8192
    v_exp_f32 v36, v36
    v_mfma_f32_16x16x32_bf16 v[40:43], a[192:195], a[80:83], 0
    ds_read_b64_tr_b16 a[242:243], v9 offset:12288
    ds_read_b64_tr_b16 a[250:251], v11 offset:12288
    v_add_f32 v25, v25, v36
    v_mfma_f32_16x16x32_bf16 v[40:43], a[196:199], a[84:87], v[40:43]
    ds_read_b64_tr_b16 a[252:253], v12 offset:8192
    v_exp_f32 v37, v37
    v_mfma_f32_16x16x32_bf16 v[40:43], a[200:203], a[88:91], v[40:43]
    ds_read_b64_tr_b16 a[254:255], v12 offset:12288
    v_cvt_pk_bf16_f32 v34, v36, v37
    v_add_f32 v25, v25, v37
    v_mfma_f32_16x16x32_bf16 v[40:43], a[204:207], a[92:95], v[40:43]
    ds_read_b128 a[196:199], v2 offset:0
    v_exp_f32 v38, v38
    v_mfma_f32_16x16x32_bf16 v[44:47], a[208:211], a[80:83], 0
    ds_read_b64_tr_b16 a[244:245], v10 offset:8192
    ds_read_b128 a[200:203], v3 offset:0
    v_add_f32 v25, v25, v38
    v_mfma_f32_16x16x32_bf16 v[44:47], a[212:215], a[84:87], v[44:47]
    ds_read_b128 a[204:207], v4 offset:0
    v_exp_f32 v39, v39
    v_mfma_f32_16x16x32_bf16 v[44:47], a[216:219], a[88:91], v[44:47]
    ds_read_b128 a[212:215], v2 offset:4096
    v_cvt_pk_bf16_f32 v35, v38, v39
    v_add_f32 v25, v25, v39
    v_mfma_f32_16x16x32_bf16 v[44:47], a[220:223], a[92:95], v[44:47]
    v_exp_f32 v40, v40
    v_mfma_f32_16x16x32_bf16 v[192:195], a[224:227], v[32:35], v[192:195]
    s_waitcnt lgkmcnt(0)
    s_barrier
    ds_read_b128 a[192:195], v1 offset:0
    ds_read_b128 a[216:219], v3 offset:4096
    v_add_f32 v26, v26, v40
    v_mfma_f32_16x16x32_bf16 v[196:199], a[228:231], v[32:35], v[196:199]
    ds_read_b128 a[220:223], v4 offset:4096
    s_mov_b32 s41, 0x40000000
    v_exp_f32 v41, v41
    v_mfma_f32_16x16x32_bf16 v[200:203], a[232:235], v[32:35], v[200:203]
    ds_read_b64_tr_b16 v[58:59], v7 offset:4096
    s_mov_b32 m0, 0x30000
    v_cvt_pk_bf16_f32 v40, v40, v41
    v_add_f32 v26, v26, v41
    v_mfma_f32_16x16x32_bf16 v[204:207], a[236:239], v[32:35], v[204:207]
    v_exp_f32 v42, v42
    v_mfma_f32_16x16x32_bf16 v[208:211], a[240:243], v[32:35], v[208:211]
    ds_read_b128 a[208:211], v1 offset:4096
    ds_read_b64_tr_b16 v[60:61], v8 offset:0
    buffer_load_dwordx4 v13, s[16:19], s41 offen offset:0 nt lds
    v_add_f32 v26, v26, v42
    v_mfma_f32_16x16x32_bf16 v[212:215], a[244:247], v[32:35], v[212:215]
    ds_read_b64_tr_b16 v[62:63], v8 offset:4096
    buffer_load_dwordx4 v14, s[16:19], s41 offen offset:1024 nt lds
    v_exp_f32 v43, v43
    v_mfma_f32_16x16x32_bf16 v[216:219], a[248:251], v[32:35], v[216:219]
    v_cvt_pk_bf16_f32 v41, v42, v43
    v_add_f32 v26, v26, v43
    v_add_u32 v9, s33, v9
    v_mfma_f32_16x16x32_bf16 v[220:223], a[252:255], v[32:35], v[220:223]
    s_waitcnt lgkmcnt(6)
    v_exp_f32 v44, v44
    v_mfma_f32_16x16x32_bf16 v[32:35], a[192:195], a[0:3], 0
    s_mov_b32 m0, s31
    ds_read_b64_tr_b16 v[48:49], v5 offset:0
    v_add_f32 v26, v26, v44
    v_mfma_f32_16x16x32_bf16 v[32:35], a[196:199], a[4:7], v[32:35]
    buffer_load_dwordx4 v13, s[8:11], s30 offen offset:0 nt lds
    v_exp_f32 v45, v45
    v_mfma_f32_16x16x32_bf16 v[32:35], a[200:203], a[8:11], v[32:35]
    v_cvt_pk_bf16_f32 v42, v44, v45
    v_add_f32 v26, v26, v45
    v_add_u32 v10, s33, v10
    v_mfma_f32_16x16x32_bf16 v[32:35], a[204:207], a[12:15], v[32:35]
    s_waitcnt lgkmcnt(3)
    v_exp_f32 v46, v46
    v_mfma_f32_16x16x32_bf16 v[36:39], a[208:211], a[0:3], 0
    ds_read_b64_tr_b16 v[50:51], v5 offset:4096
    v_add_f32 v26, v26, v46
    v_add_u32 v11, s33, v11
    v_mfma_f32_16x16x32_bf16 v[36:39], a[212:215], a[4:7], v[36:39]
    buffer_load_dwordx4 v14, s[8:11], s30 offen offset:1024 nt lds
    v_exp_f32 v47, v47
    v_mfma_f32_16x16x32_bf16 v[36:39], a[216:219], a[8:11], v[36:39]
    v_cvt_pk_bf16_f32 v43, v46, v47
    v_add_f32 v26, v26, v47
    v_add_u32 v12, s33, v12
    v_mfma_f32_16x16x32_bf16 v[36:39], a[220:223], a[12:15], v[36:39]
    v_exp_f32 v32, v32
    v_mfma_f32_16x16x32_bf16 v[224:227], a[224:227], v[40:43], v[224:227]
    ds_read_b64_tr_b16 v[52:53], v6 offset:0
    v_add_f32 v21, v21, v32
    v_mfma_f32_16x16x32_bf16 v[228:231], a[228:231], v[40:43], v[228:231]
    buffer_load_dwordx4 v15, s[8:11], s30 offen offset:2048 nt lds
    v_exp_f32 v33, v33
    v_mfma_f32_16x16x32_bf16 v[232:235], a[232:235], v[40:43], v[232:235]
    v_cvt_pk_bf16_f32 v32, v32, v33
    v_add_f32 v21, v21, v33
    v_mfma_f32_16x16x32_bf16 v[236:239], a[236:239], v[40:43], v[236:239]
    v_exp_f32 v34, v34
    v_mfma_f32_16x16x32_bf16 v[240:243], a[240:243], v[40:43], v[240:243]
    ds_read_b64_tr_b16 v[54:55], v6 offset:4096
    ds_read_b64_tr_b16 a[242:243], v9 offset:4096
    v_add_f32 v21, v21, v34
    v_mfma_f32_16x16x32_bf16 v[244:247], a[244:247], v[40:43], v[244:247]
    ds_read_b64_tr_b16 a[244:245], v10 offset:0
    buffer_load_dwordx4 v16, s[8:11], s30 offen offset:3072 nt lds
    v_exp_f32 v35, v35
    v_mfma_f32_16x16x32_bf16 v[248:251], a[248:251], v[40:43], v[248:251]
    ds_read_b64_tr_b16 a[246:247], v10 offset:4096
    v_cvt_pk_bf16_f32 v33, v34, v35
    v_add_f32 v21, v21, v35
    v_mfma_f32_16x16x32_bf16 v[252:255], a[252:255], v[40:43], v[252:255]
    ds_read_b64_tr_b16 a[248:249], v11 offset:0
    v_exp_f32 v36, v36
    v_mfma_f32_16x16x32_bf16 v[40:43], a[192:195], a[16:19], 0
    ds_read_b64_tr_b16 v[56:57], v7 offset:0
    ds_read_b64_tr_b16 a[250:251], v11 offset:4096
    v_add_f32 v21, v21, v36
    v_mfma_f32_16x16x32_bf16 v[40:43], a[196:199], a[20:23], v[40:43]
    ds_read_b64_tr_b16 a[252:253], v12 offset:0
    v_exp_f32 v37, v37
    v_mfma_f32_16x16x32_bf16 v[40:43], a[200:203], a[24:27], v[40:43]
    s_add_u32 m0, s31, 65536
    ds_read_b64_tr_b16 a[254:255], v12 offset:4096
    v_cvt_pk_bf16_f32 v34, v36, v37
    v_add_f32 v21, v21, v37
    v_mfma_f32_16x16x32_bf16 v[40:43], a[204:207], a[28:31], v[40:43]
    buffer_load_dwordx4 v17, s[12:15], s30 offen offset:0 nt lds
    v_exp_f32 v38, v38
    v_mfma_f32_16x16x32_bf16 v[44:47], a[208:211], a[16:19], 0
    ds_read_b64_tr_b16 a[240:241], v9 offset:0
    v_add_f32 v21, v21, v38
    v_mfma_f32_16x16x32_bf16 v[44:47], a[212:215], a[20:23], v[44:47]
    v_exp_f32 v39, v39
    v_mfma_f32_16x16x32_bf16 v[44:47], a[216:219], a[24:27], v[44:47]
    v_cvt_pk_bf16_f32 v35, v38, v39
    v_add_f32 v21, v21, v39
    v_mfma_f32_16x16x32_bf16 v[44:47], a[220:223], a[28:31], v[44:47]
    s_waitcnt lgkmcnt(4)
    buffer_load_dwordx4 v18, s[12:15], s30 offen offset:1024 nt lds
    v_exp_f32 v40, v40
    v_mfma_f32_16x16x32_bf16 v[64:67], v[48:51], v[32:35], v[64:67]
    ds_read_b64_tr_b16 a[224:225], v5 offset:8192
    v_add_f32 v22, v22, v40
    v_mfma_f32_16x16x32_bf16 v[68:71], v[52:55], v[32:35], v[68:71]
    s_add_u32 s35, s32, 0x4000
    v_exp_f32 v41, v41
    v_mfma_f32_16x16x32_bf16 v[72:75], v[56:59], v[32:35], v[72:75]
    s_and_b32 s35, s35, 0xffff
    v_cvt_pk_bf16_f32 v40, v40, v41
    v_add_f32 v22, v22, v41
    v_mfma_f32_16x16x32_bf16 v[76:79], v[60:63], v[32:35], v[76:79]
    s_waitcnt lgkmcnt(1)
    s_sub_u32 s33, s35, s32
    buffer_load_dwordx4 v17, s[12:15], s30 offen offset:2048 nt lds
    v_exp_f32 v42, v42
    v_mfma_f32_16x16x32_bf16 v[80:83], a[240:243], v[32:35], v[80:83]
    ds_read_b64_tr_b16 a[226:227], v5 offset:12288
    v_add_f32 v22, v22, v42
    v_mfma_f32_16x16x32_bf16 v[84:87], a[244:247], v[32:35], v[84:87]
    v_exp_f32 v43, v43
    v_mfma_f32_16x16x32_bf16 v[88:91], a[248:251], v[32:35], v[88:91]
    v_cvt_pk_bf16_f32 v41, v42, v43
    v_add_f32 v22, v22, v43
    v_mfma_f32_16x16x32_bf16 v[92:95], a[252:255], v[32:35], v[92:95]
    buffer_load_dwordx4 v18, s[12:15], s30 offen offset:3072 nt lds
    v_exp_f32 v44, v44
    v_mfma_f32_16x16x32_bf16 v[32:35], a[192:195], a[32:35], 0
    s_add_u32 s31, s31, 0x4000
    ds_read_b64_tr_b16 a[228:229], v6 offset:8192
    v_add_f32 v22, v22, v44
    v_mfma_f32_16x16x32_bf16 v[32:35], a[196:199], a[36:39], v[32:35]
    s_and_b32 s31, s31, 0xffff
    v_exp_f32 v45, v45
    v_mfma_f32_16x16x32_bf16 v[32:35], a[200:203], a[40:43], v[32:35]
    s_add_u32 s30, s30, 0x4000
    v_cvt_pk_bf16_f32 v42, v44, v45
    v_add_f32 v22, v22, v45
    v_mfma_f32_16x16x32_bf16 v[32:35], a[204:207], a[44:47], v[32:35]
    v_exp_f32 v46, v46
    v_mfma_f32_16x16x32_bf16 v[36:39], a[208:211], a[32:35], 0
    ds_read_b64_tr_b16 a[230:231], v6 offset:12288
    v_add_f32 v22, v22, v46
    v_mfma_f32_16x16x32_bf16 v[36:39], a[212:215], a[36:39], v[36:39]
    v_exp_f32 v47, v47
    v_mfma_f32_16x16x32_bf16 v[36:39], a[216:219], a[40:43], v[36:39]
    v_cvt_pk_bf16_f32 v43, v46, v47
    v_add_f32 v22, v22, v47
    v_mfma_f32_16x16x32_bf16 v[36:39], a[220:223], a[44:47], v[36:39]
    v_exp_f32 v32, v32
    v_mfma_f32_16x16x32_bf16 v[96:99], v[48:51], v[40:43], v[96:99]
    ds_read_b64_tr_b16 a[232:233], v7 offset:8192
    v_add_f32 v23, v23, v32
    v_mfma_f32_16x16x32_bf16 v[100:103], v[52:55], v[40:43], v[100:103]
    v_exp_f32 v33, v33
    v_mfma_f32_16x16x32_bf16 v[104:107], v[56:59], v[40:43], v[104:107]
    v_cvt_pk_bf16_f32 v32, v32, v33
    v_add_f32 v23, v23, v33
    v_mfma_f32_16x16x32_bf16 v[108:111], v[60:63], v[40:43], v[108:111]
    v_exp_f32 v34, v34
    v_mfma_f32_16x16x32_bf16 v[112:115], a[240:243], v[40:43], v[112:115]
    ds_read_b64_tr_b16 a[234:235], v7 offset:12288
    v_add_f32 v23, v23, v34
    v_mfma_f32_16x16x32_bf16 v[116:119], a[244:247], v[40:43], v[116:119]
    v_exp_f32 v35, v35
    v_mfma_f32_16x16x32_bf16 v[120:123], a[248:251], v[40:43], v[120:123]
    v_cvt_pk_bf16_f32 v33, v34, v35
    v_add_f32 v23, v23, v35
    v_mfma_f32_16x16x32_bf16 v[124:127], a[252:255], v[40:43], v[124:127]
    v_exp_f32 v36, v36
    v_mfma_f32_16x16x32_bf16 v[40:43], a[192:195], a[48:51], 0
    ds_read_b64_tr_b16 a[236:237], v8 offset:8192
    v_add_f32 v23, v23, v36
    v_mfma_f32_16x16x32_bf16 v[40:43], a[196:199], a[52:55], v[40:43]
    v_exp_f32 v37, v37
    v_mfma_f32_16x16x32_bf16 v[40:43], a[200:203], a[56:59], v[40:43]
    v_cvt_pk_bf16_f32 v34, v36, v37
    v_add_f32 v23, v23, v37
    v_mfma_f32_16x16x32_bf16 v[40:43], a[204:207], a[60:63], v[40:43]
    v_exp_f32 v38, v38
    v_mfma_f32_16x16x32_bf16 v[44:47], a[208:211], a[48:51], 0
    ds_read_b64_tr_b16 a[238:239], v8 offset:12288
    v_add_f32 v23, v23, v38
    v_mfma_f32_16x16x32_bf16 v[44:47], a[212:215], a[52:55], v[44:47]
    v_exp_f32 v39, v39
    v_mfma_f32_16x16x32_bf16 v[44:47], a[216:219], a[56:59], v[44:47]
    v_cvt_pk_bf16_f32 v35, v38, v39
    v_add_f32 v23, v23, v39
    v_mfma_f32_16x16x32_bf16 v[44:47], a[220:223], a[60:63], v[44:47]
    v_exp_f32 v40, v40
    v_mfma_f32_16x16x32_bf16 v[128:131], v[48:51], v[32:35], v[128:131]
    v_add_f32 v24, v24, v40
    v_add_u32 v5, s33, v5
    v_mfma_f32_16x16x32_bf16 v[132:135], v[52:55], v[32:35], v[132:135]
    v_exp_f32 v41, v41
    v_mfma_f32_16x16x32_bf16 v[136:139], v[56:59], v[32:35], v[136:139]
    v_cvt_pk_bf16_f32 v40, v40, v41
    v_add_f32 v24, v24, v41
    v_mfma_f32_16x16x32_bf16 v[140:143], v[60:63], v[32:35], v[140:143]
    v_exp_f32 v42, v42
    v_mfma_f32_16x16x32_bf16 v[144:147], a[240:243], v[32:35], v[144:147]
    v_add_f32 v24, v24, v42
    v_add_u32 v6, s33, v6
    v_mfma_f32_16x16x32_bf16 v[148:151], a[244:247], v[32:35], v[148:151]
    v_exp_f32 v43, v43
    v_mfma_f32_16x16x32_bf16 v[152:155], a[248:251], v[32:35], v[152:155]
    v_cvt_pk_bf16_f32 v41, v42, v43
    v_add_f32 v24, v24, v43
    v_mfma_f32_16x16x32_bf16 v[156:159], a[252:255], v[32:35], v[156:159]
    v_exp_f32 v44, v44
    v_mfma_f32_16x16x32_bf16 v[32:35], a[192:195], a[64:67], 0
    v_add_f32 v24, v24, v44
    v_add_u32 v7, s33, v7
    v_mfma_f32_16x16x32_bf16 v[32:35], a[196:199], a[68:71], v[32:35]
    v_exp_f32 v45, v45
    v_mfma_f32_16x16x32_bf16 v[32:35], a[200:203], a[72:75], v[32:35]
    v_cvt_pk_bf16_f32 v42, v44, v45
    v_add_f32 v24, v24, v45
    v_mfma_f32_16x16x32_bf16 v[32:35], a[204:207], a[76:79], v[32:35]
    v_exp_f32 v46, v46
    v_mfma_f32_16x16x32_bf16 v[36:39], a[208:211], a[64:67], 0
    v_add_f32 v24, v24, v46
    v_add_u32 v8, s33, v8
    v_mfma_f32_16x16x32_bf16 v[36:39], a[212:215], a[68:71], v[36:39]
    v_exp_f32 v47, v47
    v_mfma_f32_16x16x32_bf16 v[36:39], a[216:219], a[72:75], v[36:39]
    v_cvt_pk_bf16_f32 v43, v46, v47
    v_add_f32 v24, v24, v47
    v_mfma_f32_16x16x32_bf16 v[36:39], a[220:223], a[76:79], v[36:39]
    v_exp_f32 v32, v32
    v_mfma_f32_16x16x32_bf16 v[160:163], v[48:51], v[40:43], v[160:163]
    v_add_f32 v25, v25, v32
    v_mfma_f32_16x16x32_bf16 v[164:167], v[52:55], v[40:43], v[164:167]
    v_exp_f32 v33, v33
    v_mfma_f32_16x16x32_bf16 v[168:171], v[56:59], v[40:43], v[168:171]
    v_cvt_pk_bf16_f32 v32, v32, v33
    v_add_f32 v25, v25, v33
    v_mfma_f32_16x16x32_bf16 v[172:175], v[60:63], v[40:43], v[172:175]
    v_exp_f32 v34, v34
    v_mfma_f32_16x16x32_bf16 v[176:179], a[240:243], v[40:43], v[176:179]
    v_add_f32 v25, v25, v34
    v_mfma_f32_16x16x32_bf16 v[180:183], a[244:247], v[40:43], v[180:183]
    v_exp_f32 v35, v35
    v_mfma_f32_16x16x32_bf16 v[184:187], a[248:251], v[40:43], v[184:187]
    v_cvt_pk_bf16_f32 v33, v34, v35
    v_add_f32 v25, v25, v35
    v_mfma_f32_16x16x32_bf16 v[188:191], a[252:255], v[40:43], v[188:191]
    v_exp_f32 v36, v36
    v_mfma_f32_16x16x32_bf16 v[40:43], a[192:195], a[80:83], 0
    ds_read_b128 a[192:195], v1 offset:8192
    v_add_f32 v25, v25, v36
    v_mfma_f32_16x16x32_bf16 v[40:43], a[196:199], a[84:87], v[40:43]
    v_exp_f32 v37, v37
    v_mfma_f32_16x16x32_bf16 v[40:43], a[200:203], a[88:91], v[40:43]
    v_cvt_pk_bf16_f32 v34, v36, v37
    v_add_f32 v25, v25, v37
    v_mfma_f32_16x16x32_bf16 v[40:43], a[204:207], a[92:95], v[40:43]
    ds_read_b128 a[204:207], v4 offset:8192
    v_exp_f32 v38, v38
    v_mfma_f32_16x16x32_bf16 v[44:47], a[208:211], a[80:83], 0
    ds_read_b128 a[196:199], v2 offset:8192
    v_add_f32 v25, v25, v38
    v_mfma_f32_16x16x32_bf16 v[44:47], a[212:215], a[84:87], v[44:47]
    s_mov_b32 s32, s35
    ds_read_b128 a[212:215], v2 offset:12288
    v_exp_f32 v39, v39
    v_mfma_f32_16x16x32_bf16 v[44:47], a[216:219], a[88:91], v[44:47]
    ds_read_b128 a[216:219], v3 offset:12288
    v_cvt_pk_bf16_f32 v35, v38, v39
    v_add_f32 v25, v25, v39
    v_mfma_f32_16x16x32_bf16 v[44:47], a[220:223], a[92:95], v[44:47]
    ds_read_b128 a[220:223], v4 offset:12288
    v_exp_f32 v40, v40
    v_mfma_f32_16x16x32_bf16 v[192:195], v[48:51], v[32:35], v[192:195]
    ds_read_b128 a[200:203], v3 offset:8192
    v_add_f32 v26, v26, v40
    v_mfma_f32_16x16x32_bf16 v[196:199], v[52:55], v[32:35], v[196:199]
    v_exp_f32 v41, v41
    v_mfma_f32_16x16x32_bf16 v[200:203], v[56:59], v[32:35], v[200:203]
    v_cvt_pk_bf16_f32 v40, v40, v41
    v_add_f32 v26, v26, v41
    v_mfma_f32_16x16x32_bf16 v[204:207], v[60:63], v[32:35], v[204:207]
    v_exp_f32 v42, v42
    v_mfma_f32_16x16x32_bf16 v[208:211], a[240:243], v[32:35], v[208:211]
    ds_read_b128 a[208:211], v1 offset:12288
    v_add_f32 v26, v26, v42
    v_mfma_f32_16x16x32_bf16 v[212:215], a[244:247], v[32:35], v[212:215]
    v_exp_f32 v43, v43
    v_mfma_f32_16x16x32_bf16 v[216:219], a[248:251], v[32:35], v[216:219]
    v_cvt_pk_bf16_f32 v41, v42, v43
    v_add_f32 v26, v26, v43
    v_mfma_f32_16x16x32_bf16 v[220:223], a[252:255], v[32:35], v[220:223]
    s_waitcnt lgkmcnt(1)
    v_exp_f32 v44, v44
    v_mfma_f32_16x16x32_bf16 v[32:35], a[192:195], a[0:3], 0
    v_add_f32 v26, v26, v44
    v_add_u32 v1, s33, v1
    v_mfma_f32_16x16x32_bf16 v[32:35], a[196:199], a[4:7], v[32:35]
    v_exp_f32 v45, v45
    v_mfma_f32_16x16x32_bf16 v[32:35], a[200:203], a[8:11], v[32:35]
    v_cvt_pk_bf16_f32 v42, v44, v45
    v_add_f32 v26, v26, v45
    v_mfma_f32_16x16x32_bf16 v[32:35], a[204:207], a[12:15], v[32:35]
    s_waitcnt lgkmcnt(0)
    v_exp_f32 v46, v46
    v_mfma_f32_16x16x32_bf16 v[36:39], a[208:211], a[0:3], 0
    v_add_f32 v26, v26, v46
    v_add_u32 v2, s33, v2
    v_mfma_f32_16x16x32_bf16 v[36:39], a[212:215], a[4:7], v[36:39]
    v_exp_f32 v47, v47
    v_mfma_f32_16x16x32_bf16 v[36:39], a[216:219], a[8:11], v[36:39]
    v_cvt_pk_bf16_f32 v43, v46, v47
    v_add_f32 v26, v26, v47
    v_mfma_f32_16x16x32_bf16 v[36:39], a[220:223], a[12:15], v[36:39]
    v_exp_f32 v32, v32
    v_mfma_f32_16x16x32_bf16 v[224:227], v[48:51], v[40:43], v[224:227]
    v_add_f32 v21, v21, v32
    v_add_u32 v3, s33, v3
    v_mfma_f32_16x16x32_bf16 v[228:231], v[52:55], v[40:43], v[228:231]
    v_exp_f32 v33, v33
    v_mfma_f32_16x16x32_bf16 v[232:235], v[56:59], v[40:43], v[232:235]
    v_cvt_pk_bf16_f32 v32, v32, v33
    v_add_f32 v21, v21, v33
    v_mfma_f32_16x16x32_bf16 v[236:239], v[60:63], v[40:43], v[236:239]
    v_exp_f32 v34, v34
    v_mfma_f32_16x16x32_bf16 v[240:243], a[240:243], v[40:43], v[240:243]
    ds_read_b64_tr_b16 a[240:241], v9 offset:8192
    v_add_f32 v21, v21, v34
    v_mfma_f32_16x16x32_bf16 v[244:247], a[244:247], v[40:43], v[244:247]
    ds_read_b64_tr_b16 a[246:247], v10 offset:12288
    v_exp_f32 v35, v35
    v_mfma_f32_16x16x32_bf16 v[248:251], a[248:251], v[40:43], v[248:251]
    ds_read_b64_tr_b16 a[248:249], v11 offset:8192
    v_cvt_pk_bf16_f32 v33, v34, v35
    v_add_f32 v21, v21, v35
    v_mfma_f32_16x16x32_bf16 v[252:255], a[252:255], v[40:43], v[252:255]
    ds_read_b64_tr_b16 a[250:251], v11 offset:12288
    v_exp_f32 v36, v36
    v_mfma_f32_16x16x32_bf16 v[40:43], a[192:195], a[16:19], 0
    ds_read_b64_tr_b16 a[242:243], v9 offset:12288
    ds_read_b64_tr_b16 a[252:253], v12 offset:8192
    v_add_f32 v21, v21, v36
    v_mfma_f32_16x16x32_bf16 v[40:43], a[196:199], a[20:23], v[40:43]
    ds_read_b64_tr_b16 a[254:255], v12 offset:12288
    v_exp_f32 v37, v37
    v_mfma_f32_16x16x32_bf16 v[40:43], a[200:203], a[24:27], v[40:43]
    v_cvt_pk_bf16_f32 v34, v36, v37
    v_add_f32 v21, v21, v37
    v_mfma_f32_16x16x32_bf16 v[40:43], a[204:207], a[28:31], v[40:43]
    v_exp_f32 v38, v38
    v_mfma_f32_16x16x32_bf16 v[44:47], a[208:211], a[16:19], 0
    ds_read_b64_tr_b16 a[244:245], v10 offset:8192
    v_add_f32 v21, v21, v38
    v_mfma_f32_16x16x32_bf16 v[44:47], a[212:215], a[20:23], v[44:47]
    v_exp_f32 v39, v39
    v_mfma_f32_16x16x32_bf16 v[44:47], a[216:219], a[24:27], v[44:47]
    v_cvt_pk_bf16_f32 v35, v38, v39
    v_add_f32 v21, v21, v39
    v_mfma_f32_16x16x32_bf16 v[44:47], a[220:223], a[28:31], v[44:47]
    v_exp_f32 v40, v40
    v_mfma_f32_16x16x32_bf16 v[64:67], a[224:227], v[32:35], v[64:67]
    v_add_f32 v22, v22, v40
    v_add_u32 v4, s33, v4
    v_mfma_f32_16x16x32_bf16 v[68:71], a[228:231], v[32:35], v[68:71]
    v_exp_f32 v41, v41
    v_mfma_f32_16x16x32_bf16 v[72:75], a[232:235], v[32:35], v[72:75]
    v_cvt_pk_bf16_f32 v40, v40, v41
    v_add_f32 v22, v22, v41
    v_mfma_f32_16x16x32_bf16 v[76:79], a[236:239], v[32:35], v[76:79]
    s_waitcnt lgkmcnt(0)
    v_exp_f32 v42, v42
    v_mfma_f32_16x16x32_bf16 v[80:83], a[240:243], v[32:35], v[80:83]
    v_add_f32 v22, v22, v42
    v_add_u32 v9, s33, v9
    v_mfma_f32_16x16x32_bf16 v[84:87], a[244:247], v[32:35], v[84:87]
    v_exp_f32 v43, v43
    v_mfma_f32_16x16x32_bf16 v[88:91], a[248:251], v[32:35], v[88:91]
    v_cvt_pk_bf16_f32 v41, v42, v43
    v_add_f32 v22, v22, v43
    v_mfma_f32_16x16x32_bf16 v[92:95], a[252:255], v[32:35], v[92:95]
    v_exp_f32 v44, v44
    v_mfma_f32_16x16x32_bf16 v[32:35], a[192:195], a[32:35], 0
    v_add_f32 v22, v22, v44
    v_add_u32 v10, s33, v10
    v_mfma_f32_16x16x32_bf16 v[32:35], a[196:199], a[36:39], v[32:35]
    v_exp_f32 v45, v45
    v_mfma_f32_16x16x32_bf16 v[32:35], a[200:203], a[40:43], v[32:35]
    v_cvt_pk_bf16_f32 v42, v44, v45
    v_add_f32 v22, v22, v45
    v_mfma_f32_16x16x32_bf16 v[32:35], a[204:207], a[44:47], v[32:35]
    v_exp_f32 v46, v46
    v_mfma_f32_16x16x32_bf16 v[36:39], a[208:211], a[32:35], 0
    v_add_f32 v22, v22, v46
    v_add_u32 v11, s33, v11
    v_mfma_f32_16x16x32_bf16 v[36:39], a[212:215], a[36:39], v[36:39]
    v_exp_f32 v47, v47
    v_mfma_f32_16x16x32_bf16 v[36:39], a[216:219], a[40:43], v[36:39]
    v_cvt_pk_bf16_f32 v43, v46, v47
    v_add_f32 v22, v22, v47
    v_mfma_f32_16x16x32_bf16 v[36:39], a[220:223], a[44:47], v[36:39]
    v_exp_f32 v32, v32
    v_mfma_f32_16x16x32_bf16 v[96:99], a[224:227], v[40:43], v[96:99]
    v_add_f32 v23, v23, v32
    v_add_u32 v12, s33, v12
    v_mfma_f32_16x16x32_bf16 v[100:103], a[228:231], v[40:43], v[100:103]
    v_exp_f32 v33, v33
    v_mfma_f32_16x16x32_bf16 v[104:107], a[232:235], v[40:43], v[104:107]
    v_cvt_pk_bf16_f32 v32, v32, v33
    v_add_f32 v23, v23, v33
    v_mfma_f32_16x16x32_bf16 v[108:111], a[236:239], v[40:43], v[108:111]
    v_exp_f32 v34, v34
    v_mfma_f32_16x16x32_bf16 v[112:115], a[240:243], v[40:43], v[112:115]
    v_add_f32 v23, v23, v34
    v_mfma_f32_16x16x32_bf16 v[116:119], a[244:247], v[40:43], v[116:119]
    v_exp_f32 v35, v35
    v_mfma_f32_16x16x32_bf16 v[120:123], a[248:251], v[40:43], v[120:123]
    v_cvt_pk_bf16_f32 v33, v34, v35
    v_add_f32 v23, v23, v35
    v_mfma_f32_16x16x32_bf16 v[124:127], a[252:255], v[40:43], v[124:127]
    v_exp_f32 v36, v36
    v_mfma_f32_16x16x32_bf16 v[40:43], a[192:195], a[48:51], 0
    v_add_f32 v23, v23, v36
    v_mfma_f32_16x16x32_bf16 v[40:43], a[196:199], a[52:55], v[40:43]
    v_exp_f32 v37, v37
    v_mfma_f32_16x16x32_bf16 v[40:43], a[200:203], a[56:59], v[40:43]
    v_cvt_pk_bf16_f32 v34, v36, v37
    v_add_f32 v23, v23, v37
    v_mfma_f32_16x16x32_bf16 v[40:43], a[204:207], a[60:63], v[40:43]
    v_exp_f32 v38, v38
    v_mfma_f32_16x16x32_bf16 v[44:47], a[208:211], a[48:51], 0
    v_add_f32 v23, v23, v38
    v_mfma_f32_16x16x32_bf16 v[44:47], a[212:215], a[52:55], v[44:47]
    v_exp_f32 v39, v39
    v_mfma_f32_16x16x32_bf16 v[44:47], a[216:219], a[56:59], v[44:47]
    v_cvt_pk_bf16_f32 v35, v38, v39
    v_add_f32 v23, v23, v39
    v_mfma_f32_16x16x32_bf16 v[44:47], a[220:223], a[60:63], v[44:47]
    v_exp_f32 v40, v40
    v_mfma_f32_16x16x32_bf16 v[128:131], a[224:227], v[32:35], v[128:131]
    v_add_f32 v24, v24, v40
    v_mfma_f32_16x16x32_bf16 v[132:135], a[228:231], v[32:35], v[132:135]
    v_exp_f32 v41, v41
    v_mfma_f32_16x16x32_bf16 v[136:139], a[232:235], v[32:35], v[136:139]
    v_cvt_pk_bf16_f32 v40, v40, v41
    v_add_f32 v24, v24, v41
    v_mfma_f32_16x16x32_bf16 v[140:143], a[236:239], v[32:35], v[140:143]
    v_exp_f32 v42, v42
    v_mfma_f32_16x16x32_bf16 v[144:147], a[240:243], v[32:35], v[144:147]
    v_add_f32 v24, v24, v42
    v_mfma_f32_16x16x32_bf16 v[148:151], a[244:247], v[32:35], v[148:151]
    v_exp_f32 v43, v43
    v_mfma_f32_16x16x32_bf16 v[152:155], a[248:251], v[32:35], v[152:155]
    v_cvt_pk_bf16_f32 v41, v42, v43
    v_add_f32 v24, v24, v43
    v_mfma_f32_16x16x32_bf16 v[156:159], a[252:255], v[32:35], v[156:159]
    v_exp_f32 v44, v44
    v_mfma_f32_16x16x32_bf16 v[32:35], a[192:195], a[64:67], 0
    v_add_f32 v24, v24, v44
    v_mfma_f32_16x16x32_bf16 v[32:35], a[196:199], a[68:71], v[32:35]
    v_exp_f32 v45, v45
    v_mfma_f32_16x16x32_bf16 v[32:35], a[200:203], a[72:75], v[32:35]
    v_cvt_pk_bf16_f32 v42, v44, v45
    v_add_f32 v24, v24, v45
    v_mfma_f32_16x16x32_bf16 v[32:35], a[204:207], a[76:79], v[32:35]
    v_exp_f32 v46, v46
    v_mfma_f32_16x16x32_bf16 v[36:39], a[208:211], a[64:67], 0
    v_add_f32 v24, v24, v46
    v_mfma_f32_16x16x32_bf16 v[36:39], a[212:215], a[68:71], v[36:39]
    v_exp_f32 v47, v47
    v_mfma_f32_16x16x32_bf16 v[36:39], a[216:219], a[72:75], v[36:39]
    v_cvt_pk_bf16_f32 v43, v46, v47
    v_add_f32 v24, v24, v47
    v_mfma_f32_16x16x32_bf16 v[36:39], a[220:223], a[76:79], v[36:39]
    v_exp_f32 v32, v32
    s_mov_b32 s34, 14
    s_mov_b32 s51, 0xaaa
    s_mov_b32 s80, 0
    v_mfma_f32_16x16x32_bf16 v[160:163], a[224:227], v[40:43], v[160:163]
L_loop0:
    v_add_f32 v25, v25, v32
    v_mfma_f32_16x16x32_bf16 v[164:167], a[228:231], v[40:43], v[164:167]
    v_exp_f32 v33, v33
    v_mfma_f32_16x16x32_bf16 v[168:171], a[232:235], v[40:43], v[168:171]
    v_cvt_pk_bf16_f32 v32, v32, v33
    v_add_f32 v25, v25, v33
    v_mfma_f32_16x16x32_bf16 v[172:175], a[236:239], v[40:43], v[172:175]
    v_exp_f32 v34, v34
    v_mfma_f32_16x16x32_bf16 v[176:179], a[240:243], v[40:43], v[176:179]
    v_add_f32 v25, v25, v34
    v_mfma_f32_16x16x32_bf16 v[180:183], a[244:247], v[40:43], v[180:183]
    s_waitcnt vmcnt(20) lgkmcnt(0)
    s_barrier
    s_bitcmp1_b32 s51, s34
    s_cbranch_scc1 L_hookd0
L_hookret0:
    v_exp_f32 v35, v35
    v_mfma_f32_16x16x32_bf16 v[184:187], a[248:251], v[40:43], v[184:187]
    ds_read_b64_tr_b16 v[58:59], v7 offset:4096
    v_cvt_pk_bf16_f32 v33, v34, v35
    v_add_f32 v25, v25, v35
    v_mfma_f32_16x16x32_bf16 v[188:191], a[252:255], v[40:43], v[188:191]
    ds_read_b64_tr_b16 v[60:61], v8 offset:0
    v_exp_f32 v36, v36
    v_mfma_f32_16x16x32_bf16 v[40:43], a[192:195], a[80:83], 0
    ds_read_b128 a[192:195], v1 offset:0
    ds_read_b64_tr_b16 v[62:63], v8 offset:4096
    v_add_f32 v25, v25, v36
    v_mfma_f32_16x16x32_bf16 v[40:43], a[196:199], a[84:87], v[40:43]
    v_exp_f32 v37, v37
    v_mfma_f32_16x16x32_bf16 v[40:43], a[200:203], a[88:91], v[40:43]
    v_cvt_pk_bf16_f32 v34, v36, v37
    v_add_f32 v25, v25, v37
    v_mfma_f32_16x16x32_bf16 v[40:43], a[204:207], a[92:95], v[40:43]
    ds_read_b128 a[204:207], v4 offset:0
    v_exp_f32 v38, v38
    v_mfma_f32_16x16x32_bf16 v[44:47], a[208:211], a[80:83], 0
    ds_read_b128 a[196:199], v2 offset:0
    v_add_f32 v25, v25, v38
    v_mfma_f32_16x16x32_bf16 v[44:47], a[212:215], a[84:87], v[44:47]
    ds_read_b128 a[212:215], v2 offset:4096
    v_exp_f32 v39, v39
    v_mfma_f32_16x16x32_bf16 v[44:47], a[216:219], a[88:91], v[44:47]
    ds_read_b128 a[216:219], v3 offset:4096
    v_cvt_pk_bf16_f32 v35, v38, v39
    v_add_f32 v25, v25, v39
    v_mfma_f32_16x16x32_bf16 v[44:47], a[220:223], a[92:95], v[44:47]
    ds_read_b128 a[220:223], v4 offset:4096
    v_exp_f32 v40, v40
    v_mfma_f32_16x16x32_bf16 v[192:195], a[224:227], v[32:35], v[192:195]
    ds_read_b128 a[200:203], v3 offset:0
    v_add_f32 v26, v26, v40
    v_mfma_f32_16x16x32_bf16 v[196:199], a[228:231], v[32:35], v[196:199]
    v_exp_f32 v41, v41
    v_mfma_f32_16x16x32_bf16 v[200:203], a[232:235], v[32:35], v[200:203]
    v_cvt_pk_bf16_f32 v40, v40, v41
    v_add_f32 v26, v26, v41
    v_mfma_f32_16x16x32_bf16 v[204:207], a[236:239], v[32:35], v[204:207]
    v_exp_f32 v42, v42
    v_mfma_f32_16x16x32_bf16 v[208:211], a[240:243], v[32:35], v[208:211]
    ds_read_b128 a[208:211], v1 offset:4096
    v_add_f32 v26, v26, v42
    v_mfma_f32_16x16x32_bf16 v[212:215], a[244:247], v[32:35], v[212:215]
    v_exp_f32 v43, v43
    v_mfma_f32_16x16x32_bf16 v[216:219], a[248:251], v[32:35], v[216:219]
    v_cvt_pk_bf16_f32 v41, v42, v43
    v_add_f32 v26, v26, v43
    v_mfma_f32_16x16x32_bf16 v[220:223], a[252:255], v[32:35], v[220:223]
    s_waitcnt lgkmcnt(1)
    v_exp_f32 v44, v44
    v_mfma_f32_16x16x32_bf16 v[32:35], a[192:195], a[0:3], 0
    ds_read_b64_tr_b16 v[48:49], v5 offset:0
    v_add_f32 v26, v26, v44
    v_mfma_f32_16x16x32_bf16 v[32:35], a[196:199], a[4:7], v[32:35]
    v_exp_f32 v45, v45
    v_mfma_f32_16x16x32_bf16 v[32:35], a[200:203], a[8:11], v[32:35]
    v_cvt_pk_bf16_f32 v42, v44, v45
    v_add_f32 v26, v26, v45
    v_mfma_f32_16x16x32_bf16 v[32:35], a[204:207], a[12:15], v[32:35]
    s_waitcnt lgkmcnt(1)
    v_exp_f32 v46, v46
    v_mfma_f32_16x16x32_bf16 v[36:39], a[208:211], a[0:3], 0
    ds_read_b64_tr_b16 v[50:51], v5 offset:4096
    v_add_f32 v26, v26, v46
    v_mfma_f32_16x16x32_bf16 v[36:39], a[212:215], a[4:7], v[36:39]
    v_exp_f32 v47, v47
    v_mfma_f32_16x16x32_bf16 v[36:39], a[216:219], a[8:11], v[36:39]
    v_cvt_pk_bf16_f32 v43, v46, v47
    v_add_f32 v26, v26, v47
    v_mfma_f32_16x16x32_bf16 v[36:39], a[220:223], a[12:15], v[36:39]
    v_exp_f32 v32, v32
    v_mfma_f32_16x16x32_bf16 v[224:227], a[224:227], v[40:43], v[224:227]
    ds_read_b64_tr_b16 v[52:53], v6 offset:0
    v_add_f32 v21, v21, v32
    v_mfma_f32_16x16x32_bf16 v[228:231], a[228:231], v[40:43], v[228:231]
    v_exp_f32 v33, v33
    v_mfma_f32_16x16x32_bf16 v[232:235], a[232:235], v[40:43], v[232:235]
    v_cvt_pk_bf16_f32 v32, v32, v33
    v_add_f32 v21, v21, v33
    v_mfma_f32_16x16x32_bf16 v[236:239], a[236:239], v[40:43], v[236:239]
    v_exp_f32 v34, v34
    v_mfma_f32_16x16x32_bf16 v[240:243], a[240:243], v[40:43], v[240:243]
    ds_read_b64_tr_b16 v[54:55], v6 offset:4096
    ds_read_b64_tr_b16 a[242:243], v9 offset:4096
    v_add_f32 v21, v21, v34
    v_mfma_f32_16x16x32_bf16 v[244:247], a[244:247], v[40:43], v[244:247]
    ds_read_b64_tr_b16 a[244:245], v10 offset:0
    v_exp_f32 v35, v35
    v_mfma_f32_16x16x32_bf16 v[248:251], a[248:251], v[40:43], v[248:251]
    ds_read_b64_tr_b16 a[246:247], v10 offset:4096
    v_cvt_pk_bf16_f32 v33, v34, v35
    v_add_f32 v21, v21, v35
    v_mfma_f32_16x16x32_bf16 v[252:255], a[252:255], v[40:43], v[252:255]
    ds_read_b64_tr_b16 a[248:249], v11 offset:0
    v_exp_f32 v36, v36
    v_mfma_f32_16x16x32_bf16 v[40:43], a[192:195], a[16:19], 0
    s_add_u32 s58, s48, s37
    ds_read_b64_tr_b16 v[56:57], v7 offset:0
    ds_read_b64_tr_b16 a[250:251], v11 offset:4096
    v_add_f32 v21, v21, v36
    v_mfma_f32_16x16x32_bf16 v[40:43], a[196:199], a[20:23], v[40:43]
    s_bitcmp1_b32 s39, s34
    ds_read_b64_tr_b16 a[252:253], v12 offset:0
    v_exp_f32 v37, v37
    v_mfma_f32_16x16x32_bf16 v[40:43], a[200:203], a[24:27], v[40:43]
    s_cselect_b32 s40, s58, 0x30000
    ds_read_b64_tr_b16 a[254:255], v12 offset:4096
    v_cvt_pk_bf16_f32 v34, v36, v37
    v_add_f32 v21, v21, v37
    v_mfma_f32_16x16x32_bf16 v[40:43], a[204:207], a[28:31], v[40:43]
    s_cselect_b32 s41, s38, 0x40000000
    v_exp_f32 v38, v38
    v_mfma_f32_16x16x32_bf16 v[44:47], a[208:211], a[16:19], 0
    s_add_u32 s37, s37, 0x800
    ds_read_b64_tr_b16 a[240:241], v9 offset:0
    v_add_f32 v21, v21, v38
    v_mfma_f32_16x16x32_bf16 v[44:47], a[212:215], a[20:23], v[44:47]
    s_and_b32 s37, s37, 0x1fff
    v_exp_f32 v39, v39
    v_mfma_f32_16x16x32_bf16 v[44:47], a[216:219], a[24:27], v[44:47]
    s_add_u32 s38, s38, 0x800
    v_cvt_pk_bf16_f32 v35, v38, v39
    v_add_f32 v21, v21, v39
    v_mfma_f32_16x16x32_bf16 v[44:47], a[220:223], a[28:31], v[44:47]
    s_waitcnt lgkmcnt(4)
    s_mov_b32 m0, s40
    v_exp_f32 v40, v40
    v_mfma_f32_16x16x32_bf16 v[64:67], v[48:51], v[32:35], v[64:67]
    buffer_load_dwordx4 v13, s[16:19], s41 offen offset:0 nt lds
    v_add_f32 v22, v22, v40
    v_mfma_f32_16x16x32_bf16 v[68:71], v[52:55], v[32:35], v[68:71]
    v_exp_f32 v41, v41
    v_mfma_f32_16x16x32_bf16 v[72:75], v[56:59], v[32:35], v[72:75]
    v_cvt_pk_bf16_f32 v40, v40, v41
    v_add_f32 v22, v22, v41
    v_mfma_f32_16x16x32_bf16 v[76:79], v[60:63], v[32:35], v[76:79]
    s_waitcnt lgkmcnt(0)
    v_exp_f32 v42, v42
    v_mfma_f32_16x16x32_bf16 v[80:83], a[240:243], v[32:35], v[80:83]
    ds_read_b64_tr_b16 a[224:225], v5 offset:8192
    v_add_f32 v22, v22, v42
    v_mfma_f32_16x16x32_bf16 v[84:87], a[244:247], v[32:35], v[84:87]
    v_exp_f32 v43, v43
    v_mfma_f32_16x16x32_bf16 v[88:91], a[248:251], v[32:35], v[88:91]
    v_cvt_pk_bf16_f32 v41, v42, v43
    v_add_f32 v22, v22, v43
    v_mfma_f32_16x16x32_bf16 v[92:95], a[252:255], v[32:35], v[92:95]
    v_exp_f32 v44, v44
    v_mfma_f32_16x16x32_bf16 v[32:35], a[192:195], a[32:35], 0
    buffer_load_dwordx4 v14, s[16:19], s41 offen offset:1024 nt lds
    v_add_f32 v22, v22, v44
    v_mfma_f32_16x16x32_bf16 v[32:35], a[196:199], a[36:39], v[32:35]
    s_add_u32 s35, s32, 0x4000
    v_exp_f32 v45, v45
    v_mfma_f32_16x16x32_bf16 v[32:35], a[200:203], a[40:43], v[32:35]
    s_and_b32 s35, s35, 0xffff
    v_cvt_pk_bf16_f32 v42, v44, v45
    v_add_f32 v22, v22, v45
    v_mfma_f32_16x16x32_bf16 v[32:35], a[204:207], a[44:47], v[32:35]
    s_sub_u32 s33, s35, s32
    v_exp_f32 v46, v46
    v_mfma_f32_16x16x32_bf16 v[36:39], a[208:211], a[32:35], 0
    ds_read_b64_tr_b16 a[226:227], v5 offset:12288
    v_add_f32 v22, v22, v46
    v_add_u32 v5, s33, v5
    v_mfma_f32_16x16x32_bf16 v[36:39], a[212:215], a[36:39], v[36:39]
    v_exp_f32 v47, v47
    v_mfma_f32_16x16x32_bf16 v[36:39], a[216:219], a[40:43], v[36:39]
    v_cvt_pk_bf16_f32 v43, v46, v47
    v_add_f32 v22, v22, v47
    v_mfma_f32_16x16x32_bf16 v[36:39], a[220:223], a[44:47], v[36:39]
    s_mov_b32 m0, s31
    v_exp_f32 v32, v32
    v_mfma_f32_16x16x32_bf16 v[96:99], v[48:51], v[40:43], v[96:99]
    buffer_load_dwordx4 v13, s[8:11], s30 offen offset:0 nt lds
    v_add_f32 v23, v23, v32
    v_mfma_f32_16x16x32_bf16 v[100:103], v[52:55], v[40:43], v[100:103]
    v_exp_f32 v33, v33
    v_mfma_f32_16x16x32_bf16 v[104:107], v[56:59], v[40:43], v[104:107]
    v_cvt_pk_bf16_f32 v32, v32, v33
    v_add_f32 v23, v23, v33
    v_mfma_f32_16x16x32_bf16 v[108:111], v[60:63], v[40:43], v[108:111]
    v_exp_f32 v34, v34
    v_mfma_f32_16x16x32_bf16 v[112:115], a[240:243], v[40:43], v[112:115]
    buffer_load_dwordx4 v14, s[8:11], s30 offen offset:1024 nt lds
    v_add_f32 v23, v23, v34
    v_mfma_f32_16x16x32_bf16 v[116:119], a[244:247], v[40:43], v[116:119]
    v_exp_f32 v35, v35
    v_mfma_f32_16x16x32_bf16 v[120:123], a[248:251], v[40:43], v[120:123]
    v_cvt_pk_bf16_f32 v33, v34, v35
    v_add_f32 v23, v23, v35
    v_mfma_f32_16x16x32_bf16 v[124:127], a[252:255], v[40:43], v[124:127]
    v_exp_f32 v36, v36
    v_mfma_f32_16x16x32_bf16 v[40:43], a[192:195], a[48:51], 0
    buffer_load_dwordx4 v15, s[8:11], s30 offen offset:2048 nt lds
    v_add_f32 v23, v23, v36
    v_mfma_f32_16x16x32_bf16 v[40:43], a[196:199], a[52:55], v[40:43]
    v_exp_f32 v37, v37
    v_mfma_f32_16x16x32_bf16 v[40:43], a[200:203], a[56:59], v[40:43]
    v_cvt_pk_bf16_f32 v34, v36, v37
    v_add_f32 v23, v23, v37
    v_mfma_f32_16x16x32_bf16 v[40:43], a[204:207], a[60:63], v[40:43]
    v_exp_f32 v38, v38
    v_mfma_f32_16x16x32_bf16 v[44:47], a[208:211], a[48:51], 0
    buffer_load_dwordx4 v16, s[8:11], s30 offen offset:3072 nt lds
    v_add_f32 v23, v23, v38
    v_mfma_f32_16x16x32_bf16 v[44:47], a[212:215], a[52:55], v[44:47]
    v_exp_f32 v39, v39
    v_mfma_f32_16x16x32_bf16 v[44:47], a[216:219], a[56:59], v[44:47]
    v_cvt_pk_bf16_f32 v35, v38, v39
    v_add_f32 v23, v23, v39
    v_mfma_f32_16x16x32_bf16 v[44:47], a[220:223], a[60:63], v[44:47]
    s_add_u32 m0, s31, 65536
    v_exp_f32 v40, v40
    v_mfma_f32_16x16x32_bf16 v[128:131], v[48:51], v[32:35], v[128:131]
    buffer_load_dwordx4 v17, s[12:15], s30 offen offset:0 nt lds
    v_add_f32 v24, v24, v40
    v_mfma_f32_16x16x32_bf16 v[132:135], v[52:55], v[32:35], v[132:135]
    v_exp_f32 v41, v41
    v_mfma_f32_16x16x32_bf16 v[136:139], v[56:59], v[32:35], v[136:139]
    v_cvt_pk_bf16_f32 v40, v40, v41
    v_add_f32 v24, v24, v41
    v_mfma_f32_16x16x32_bf16 v[140:143], v[60:63], v[32:35], v[140:143]
    v_exp_f32 v42, v42
    v_mfma_f32_16x16x32_bf16 v[144:147], a[240:243], v[32:35], v[144:147]
    buffer_load_dwordx4 v18, s[12:15], s30 offen offset:1024 nt lds
    v_add_f32 v24, v24, v42
    v_mfma_f32_16x16x32_bf16 v[148:151], a[244:247], v[32:35], v[148:151]
    v_exp_f32 v43, v43
    v_mfma_f32_16x16x32_bf16 v[152:155], a[248:251], v[32:35], v[152:155]
    v_cvt_pk_bf16_f32 v41, v42, v43
    v_add_f32 v24, v24, v43
    v_mfma_f32_16x16x32_bf16 v[156:159], a[252:255], v[32:35], v[156:159]
    v_exp_f32 v44, v44
    v_mfma_f32_16x16x32_bf16 v[32:35], a[192:195], a[64:67], 0
    buffer_load_dwordx4 v17, s[12:15], s30 offen offset:2048 nt lds
    v_add_f32 v24, v24, v44
    v_mfma_f32_16x16x32_bf16 v[32:35], a[196:199], a[68:71], v[32:35]
    v_exp_f32 v45, v45
    v_mfma_f32_16x16x32_bf16 v[32:35], a[200:203], a[72:75], v[32:35]
    v_cvt_pk_bf16_f32 v42, v44, v45
    v_add_f32 v24, v24, v45
    v_mfma_f32_16x16x32_bf16 v[32:35], a[204:207], a[76:79], v[32:35]
    v_exp_f32 v46, v46
    v_mfma_f32_16x16x32_bf16 v[36:39], a[208:211], a[64:67], 0
    buffer_load_dwordx4 v18, s[12:15], s30 offen offset:3072 nt lds
    v_add_f32 v24, v24, v46
    v_mfma_f32_16x16x32_bf16 v[36:39], a[212:215], a[68:71], v[36:39]
    s_add_u32 s31, s31, 0x4000
    v_exp_f32 v47, v47
    v_mfma_f32_16x16x32_bf16 v[36:39], a[216:219], a[72:75], v[36:39]
    s_and_b32 s31, s31, 0xffff
    v_cvt_pk_bf16_f32 v43, v46, v47
    v_add_f32 v24, v24, v47
    v_mfma_f32_16x16x32_bf16 v[36:39], a[220:223], a[76:79], v[36:39]
    s_add_u32 s30, s30, 0x4000
    v_exp_f32 v32, v32
    v_mfma_f32_16x16x32_bf16 v[160:163], v[48:51], v[40:43], v[160:163]
    ds_read_b64_tr_b16 a[228:229], v6 offset:8192
    v_add_f32 v25, v25, v32
    v_mfma_f32_16x16x32_bf16 v[164:167], v[52:55], v[40:43], v[164:167]
    v_exp_f32 v33, v33
    v_mfma_f32_16x16x32_bf16 v[168:171], v[56:59], v[40:43], v[168:171]
    v_cvt_pk_bf16_f32 v32, v32, v33
    v_add_f32 v25, v25, v33
    v_mfma_f32_16x16x32_bf16 v[172:175], v[60:63], v[40:43], v[172:175]
    v_exp_f32 v34, v34
    v_mfma_f32_16x16x32_bf16 v[176:179], a[240:243], v[40:43], v[176:179]
    ds_read_b64_tr_b16 a[230:231], v6 offset:12288
    v_add_f32 v25, v25, v34
    v_add_u32 v6, s33, v6
    v_mfma_f32_16x16x32_bf16 v[180:183], a[244:247], v[40:43], v[180:183]
    v_exp_f32 v35, v35
    v_mfma_f32_16x16x32_bf16 v[184:187], a[248:251], v[40:43], v[184:187]
    v_cvt_pk_bf16_f32 v33, v34, v35
    v_add_f32 v25, v25, v35
    v_mfma_f32_16x16x32_bf16 v[188:191], a[252:255], v[40:43], v[188:191]
    v_exp_f32 v36, v36
    v_mfma_f32_16x16x32_bf16 v[40:43], a[192:195], a[80:83], 0
    ds_read_b128 a[192:195], v1 offset:8192
    v_add_f32 v25, v25, v36
    v_mfma_f32_16x16x32_bf16 v[40:43], a[196:199], a[84:87], v[40:43]
    v_exp_f32 v37, v37
    v_mfma_f32_16x16x32_bf16 v[40:43], a[200:203], a[88:91], v[40:43]
    v_cvt_pk_bf16_f32 v34, v36, v37
    v_add_f32 v25, v25, v37
    v_mfma_f32_16x16x32_bf16 v[40:43], a[204:207], a[92:95], v[40:43]
    ds_read_b128 a[204:207], v4 offset:8192
    v_exp_f32 v38, v38
    v_mfma_f32_16x16x32_bf16 v[44:47], a[208:211], a[80:83], 0
    ds_read_b128 a[196:199], v2 offset:8192
    v_add_f32 v25, v25, v38
    v_mfma_f32_16x16x32_bf16 v[44:47], a[212:215], a[84:87], v[44:47]
    s_mov_b32 s32, s35
    ds_read_b128 a[212:215], v2 offset:12288
    v_exp_f32 v39, v39
    v_mfma_f32_16x16x32_bf16 v[44:47], a[216:219], a[88:91], v[44:47]
    ds_read_b128 a[216:219], v3 offset:12288
    v_cvt_pk_bf16_f32 v35, v38, v39
    v_add_f32 v25, v25, v39
    v_mfma_f32_16x16x32_bf16 v[44:47], a[220:223], a[92:95], v[44:47]
    ds_read_b128 a[220:223], v4 offset:12288
    v_exp_f32 v40, v40
    v_mfma_f32_16x16x32_bf16 v[192:195], v[48:51], v[32:35], v[192:195]
    ds_read_b128 a[200:203], v3 offset:8192
    v_add_f32 v26, v26, v40
    v_mfma_f32_16x16x32_bf16 v[196:199], v[52:55], v[32:35], v[196:199]
    v_exp_f32 v41, v41
    v_mfma_f32_16x16x32_bf16 v[200:203], v[56:59], v[32:35], v[200:203]
    v_cvt_pk_bf16_f32 v40, v40, v41
    v_add_f32 v26, v26, v41
    v_mfma_f32_16x16x32_bf16 v[204:207], v[60:63], v[32:35], v[204:207]
    v_exp_f32 v42, v42
    v_mfma_f32_16x16x32_bf16 v[208:211], a[240:243], v[32:35], v[208:211]
    ds_read_b128 a[208:211], v1 offset:12288
    v_add_f32 v26, v26, v42
    v_mfma_f32_16x16x32_bf16 v[212:215], a[244:247], v[32:35], v[212:215]
    v_exp_f32 v43, v43
    v_mfma_f32_16x16x32_bf16 v[216:219], a[248:251], v[32:35], v[216:219]
    v_cvt_pk_bf16_f32 v41, v42, v43
    v_add_f32 v26, v26, v43
    v_mfma_f32_16x16x32_bf16 v[220:223], a[252:255], v[32:35], v[220:223]
    s_waitcnt lgkmcnt(1)
    v_exp_f32 v44, v44
    v_mfma_f32_16x16x32_bf16 v[32:35], a[192:195], a[0:3], 0
    ds_read_b64_tr_b16 a[232:233], v7 offset:8192
    v_add_f32 v26, v26, v44
    v_mfma_f32_16x16x32_bf16 v[32:35], a[196:199], a[4:7], v[32:35]
    v_exp_f32 v45, v45
    v_mfma_f32_16x16x32_bf16 v[32:35], a[200:203], a[8:11], v[32:35]
    v_cvt_pk_bf16_f32 v42, v44, v45
    v_add_f32 v26, v26, v45
    v_mfma_f32_16x16x32_bf16 v[32:35], a[204:207], a[12:15], v[32:35]
    s_waitcnt lgkmcnt(1)
    v_exp_f32 v46, v46
    v_mfma_f32_16x16x32_bf16 v[36:39], a[208:211], a[0:3], 0
    ds_read_b64_tr_b16 a[234:235], v7 offset:12288
    v_add_f32 v26, v26, v46
    v_mfma_f32_16x16x32_bf16 v[36:39], a[212:215], a[4:7], v[36:39]
    v_exp_f32 v47, v47
    v_mfma_f32_16x16x32_bf16 v[36:39], a[216:219], a[8:11], v[36:39]
    v_cvt_pk_bf16_f32 v43, v46, v47
    v_add_f32 v26, v26, v47
    v_mfma_f32_16x16x32_bf16 v[36:39], a[220:223], a[12:15], v[36:39]
    v_exp_f32 v32, v32
    v_mfma_f32_16x16x32_bf16 v[224:227], v[48:51], v[40:43], v[224:227]
    ds_read_b64_tr_b16 a[236:237], v8 offset:8192
    v_add_f32 v21, v21, v32
    v_mfma_f32_16x16x32_bf16 v[228:231], v[52:55], v[40:43], v[228:231]
    v_exp_f32 v33, v33
    v_mfma_f32_16x16x32_bf16 v[232:235], v[56:59], v[40:43], v[232:235]
    v_cvt_pk_bf16_f32 v32, v32, v33
    v_add_f32 v21, v21, v33
    v_mfma_f32_16x16x32_bf16 v[236:239], v[60:63], v[40:43], v[236:239]
    v_exp_f32 v34, v34
    v_mfma_f32_16x16x32_bf16 v[240:243], a[240:243], v[40:43], v[240:243]
    ds_read_b64_tr_b16 a[238:239], v8 offset:12288
    v_add_f32 v21, v21, v34
    v_mfma_f32_16x16x32_bf16 v[244:247], a[244:247], v[40:43], v[244:247]
    ds_read_b64_tr_b16 a[244:245], v10 offset:8192
    v_exp_f32 v35, v35
    v_mfma_f32_16x16x32_bf16 v[248:251], a[248:251], v[40:43], v[248:251]
    ds_read_b64_tr_b16 a[246:247], v10 offset:12288
    v_cvt_pk_bf16_f32 v33, v34, v35
    v_add_f32 v21, v21, v35
    v_mfma_f32_16x16x32_bf16 v[252:255], a[252:255], v[40:43], v[252:255]
    ds_read_b64_tr_b16 a[248:249], v11 offset:8192
    v_exp_f32 v36, v36
    v_mfma_f32_16x16x32_bf16 v[40:43], a[192:195], a[16:19], 0
    ds_read_b64_tr_b16 a[240:241], v9 offset:8192
    ds_read_b64_tr_b16 a[250:251], v11 offset:12288
    v_add_f32 v21, v21, v36
    v_mfma_f32_16x16x32_bf16 v[40:43], a[196:199], a[20:23], v[40:43]
    ds_read_b64_tr_b16 a[252:253], v12 offset:8192
    v_exp_f32 v37, v37
    v_mfma_f32_16x16x32_bf16 v[40:43], a[200:203], a[24:27], v[40:43]
    ds_read_b64_tr_b16 a[254:255], v12 offset:12288
    v_cvt_pk_bf16_f32 v34, v36, v37
    v_add_f32 v21, v21, v37
    v_mfma_f32_16x16x32_bf16 v[40:43], a[204:207], a[28:31], v[40:43]
    v_exp_f32 v38, v38
    v_mfma_f32_16x16x32_bf16 v[44:47], a[208:211], a[16:19], 0
    ds_read_b64_tr_b16 a[242:243], v9 offset:12288
    v_add_f32 v21, v21, v38
    v_mfma_f32_16x16x32_bf16 v[44:47], a[212:215], a[20:23], v[44:47]
    v_exp_f32 v39, v39
    v_mfma_f32_16x16x32_bf16 v[44:47], a[216:219], a[24:27], v[44:47]
    v_cvt_pk_bf16_f32 v35, v38, v39
    v_add_f32 v21, v21, v39
    v_mfma_f32_16x16x32_bf16 v[44:47], a[220:223], a[28:31], v[44:47]
    s_waitcnt lgkmcnt(8)
    v_exp_f32 v40, v40
    v_mfma_f32_16x16x32_bf16 v[64:67], a[224:227], v[32:35], v[64:67]
    v_add_f32 v22, v22, v40
    v_add_u32 v1, s33, v1
    v_mfma_f32_16x16x32_bf16 v[68:71], a[228:231], v[32:35], v[68:71]
    v_exp_f32 v41, v41
    v_mfma_f32_16x16x32_bf16 v[72:75], a[232:235], v[32:35], v[72:75]
    v_cvt_pk_bf16_f32 v40, v40, v41
    v_add_f32 v22, v22, v41
    v_mfma_f32_16x16x32_bf16 v[76:79], a[236:239], v[32:35], v[76:79]
    s_waitcnt lgkmcnt(0)
    v_exp_f32 v42, v42
    v_mfma_f32_16x16x32_bf16 v[80:83], a[240:243], v[32:35], v[80:83]
    v_add_f32 v22, v22, v42
    v_add_u32 v2, s33, v2
    v_mfma_f32_16x16x32_bf16 v[84:87], a[244:247], v[32:35], v[84:87]
    v_exp_f32 v43, v43
    v_mfma_f32_16x16x32_bf16 v[88:91], a[248:251], v[32:35], v[88:91]
    v_cvt_pk_bf16_f32 v41, v42, v43
    v_add_f32 v22, v22, v43
    v_mfma_f32_16x16x32_bf16 v[92:95], a[252:255], v[32:35], v[92:95]
    v_exp_f32 v44, v44
    v_mfma_f32_16x16x32_bf16 v[32:35], a[192:195], a[32:35], 0
    v_add_f32 v22, v22, v44
    v_add_u32 v3, s33, v3
    v_mfma_f32_16x16x32_bf16 v[32:35], a[196:199], a[36:39], v[32:35]
    v_exp_f32 v45, v45
    v_mfma_f32_16x16x32_bf16 v[32:35], a[200:203], a[40:43], v[32:35]
    v_cvt_pk_bf16_f32 v42, v44, v45
    v_add_f32 v22, v22, v45
    v_mfma_f32_16x16x32_bf16 v[32:35], a[204:207], a[44:47], v[32:35]
    v_exp_f32 v46, v46
    v_mfma_f32_16x16x32_bf16 v[36:39], a[208:211], a[32:35], 0
    v_add_f32 v22, v22, v46
    v_add_u32 v4, s33, v4
    v_mfma_f32_16x16x32_bf16 v[36:39], a[212:215], a[36:39], v[36:39]
    v_exp_f32 v47, v47
    v_mfma_f32_16x16x32_bf16 v[36:39], a[216:219], a[40:43], v[36:39]
    v_cvt_pk_bf16_f32 v43, v46, v47
    v_add_f32 v22, v22, v47
    v_mfma_f32_16x16x32_bf16 v[36:39], a[220:223], a[44:47], v[36:39]
    v_exp_f32 v32, v32
    v_mfma_f32_16x16x32_bf16 v[96:99], a[224:227], v[40:43], v[96:99]
    v_add_f32 v23, v23, v32
    v_add_u32 v7, s33, v7
    v_mfma_f32_16x16x32_bf16 v[100:103], a[228:231], v[40:43], v[100:103]
    v_exp_f32 v33, v33
    v_mfma_f32_16x16x32_bf16 v[104:107], a[232:235], v[40:43], v[104:107]
    v_cvt_pk_bf16_f32 v32, v32, v33
    v_add_f32 v23, v23, v33
    v_mfma_f32_16x16x32_bf16 v[108:111], a[236:239], v[40:43], v[108:111]
    v_exp_f32 v34, v34
    v_mfma_f32_16x16x32_bf16 v[112:115], a[240:243], v[40:43], v[112:115]
    v_add_f32 v23, v23, v34
    v_add_u32 v8, s33, v8
    v_mfma_f32_16x16x32_bf16 v[116:119], a[244:247], v[40:43], v[116:119]
    v_exp_f32 v35, v35
    v_mfma_f32_16x16x32_bf16 v[120:123], a[248:251], v[40:43], v[120:123]
    v_cvt_pk_bf16_f32 v33, v34, v35
    v_add_f32 v23, v23, v35
    v_mfma_f32_16x16x32_bf16 v[124:127], a[252:255], v[40:43], v[124:127]
    v_exp_f32 v36, v36
    v_mfma_f32_16x16x32_bf16 v[40:43], a[192:195], a[48:51], 0
    v_add_f32 v23, v23, v36
    v_add_u32 v9, s33, v9
    v_mfma_f32_16x16x32_bf16 v[40:43], a[196:199], a[52:55], v[40:43]
    v_exp_f32 v37, v37
    v_mfma_f32_16x16x32_bf16 v[40:43], a[200:203], a[56:59], v[40:43]
    v_cvt_pk_bf16_f32 v34, v36, v37
    v_add_f32 v23, v23, v37
    v_mfma_f32_16x16x32_bf16 v[40:43], a[204:207], a[60:63], v[40:43]
    v_exp_f32 v38, v38
    v_mfma_f32_16x16x32_bf16 v[44:47], a[208:211], a[48:51], 0
    v_add_f32 v23, v23, v38
    v_add_u32 v10, s33, v10
    v_mfma_f32_16x16x32_bf16 v[44:47], a[212:215], a[52:55], v[44:47]
    v_exp_f32 v39, v39
    v_mfma_f32_16x16x32_bf16 v[44:47], a[216:219], a[56:59], v[44:47]
    v_cvt_pk_bf16_f32 v35, v38, v39
    v_add_f32 v23, v23, v39
    v_mfma_f32_16x16x32_bf16 v[44:47], a[220:223], a[60:63], v[44:47]
    v_exp_f32 v40, v40
    v_mfma_f32_16x16x32_bf16 v[128:131], a[224:227], v[32:35], v[128:131]
    v_add_f32 v24, v24, v40
    v_add_u32 v11, s33, v11
    v_mfma_f32_16x16x32_bf16 v[132:135], a[228:231], v[32:35], v[132:135]
    v_exp_f32 v41, v41
    v_mfma_f32_16x16x32_bf16 v[136:139], a[232:235], v[32:35], v[136:139]
    v_cvt_pk_bf16_f32 v40, v40, v41
    v_add_f32 v24, v24, v41
    v_mfma_f32_16x16x32_bf16 v[140:143], a[236:239], v[32:35], v[140:143]
    v_exp_f32 v42, v42
    v_mfma_f32_16x16x32_bf16 v[144:147], a[240:243], v[32:35], v[144:147]
    v_add_f32 v24, v24, v42
    v_add_u32 v12, s33, v12
    v_mfma_f32_16x16x32_bf16 v[148:151], a[244:247], v[32:35], v[148:151]
    v_exp_f32 v43, v43
    v_mfma_f32_16x16x32_bf16 v[152:155], a[248:251], v[32:35], v[152:155]
    v_cvt_pk_bf16_f32 v41, v42, v43
    v_add_f32 v24, v24, v43
    v_mfma_f32_16x16x32_bf16 v[156:159], a[252:255], v[32:35], v[156:159]
    v_exp_f32 v44, v44
    v_mfma_f32_16x16x32_bf16 v[32:35], a[192:195], a[64:67], 0
    v_add_f32 v24, v24, v44
    v_mfma_f32_16x16x32_bf16 v[32:35], a[196:199], a[68:71], v[32:35]
    v_exp_f32 v45, v45
    v_mfma_f32_16x16x32_bf16 v[32:35], a[200:203], a[72:75], v[32:35]
    v_cvt_pk_bf16_f32 v42, v44, v45
    v_add_f32 v24, v24, v45
    v_mfma_f32_16x16x32_bf16 v[32:35], a[204:207], a[76:79], v[32:35]
    v_exp_f32 v46, v46
    v_mfma_f32_16x16x32_bf16 v[36:39], a[208:211], a[64:67], 0
    v_add_f32 v24, v24, v46
    v_mfma_f32_16x16x32_bf16 v[36:39], a[212:215], a[68:71], v[36:39]
    v_exp_f32 v47, v47
    v_mfma_f32_16x16x32_bf16 v[36:39], a[216:219], a[72:75], v[36:39]
    v_cvt_pk_bf16_f32 v43, v46, v47
    v_add_f32 v24, v24, v47
    v_mfma_f32_16x16x32_bf16 v[36:39], a[220:223], a[76:79], v[36:39]
    s_sub_u32 s34, s34, 1
    v_exp_f32 v32, v32
    s_cmp_eq_u32 s34, 0
    s_cbranch_scc1 L_exit0
    v_mfma_f32_16x16x32_bf16 v[160:163], a[224:227], v[40:43], v[160:163]
    s_branch L_loop0
L_exit0:
L_trans:
    v_mfma_f32_16x16x32_bf16 v[160:163], a[224:227], v[40:43], v[160:163]
    v_add_f32 v25, v25, v32
    v_mfma_f32_16x16x32_bf16 v[164:167], a[228:231], v[40:43], v[164:167]
    s_waitcnt vmcnt(10)
    v_exp_f32 v33, v33
    v_mov_b32 v29, v21
    s_nop 1
    v_permlane16_swap_b32 v21, v29
    v_add_f32 v21, v21, v29
    v_mov_b32 v29, v21
    s_nop 1
    v_permlane32_swap_b32 v21, v29
    v_add_f32 v21, v21, v29
    v_rcp_f32 v30, v21
    v_cmp_ngt_f32 vcc, s29, v21
    v_mfma_f32_16x16x32_bf16 v[168:171], a[232:235], v[40:43], v[168:171]
    s_nop 0
    s_or_b64 s[42:43], s[42:43], vcc
    v_cvt_pk_bf16_f32 v32, v32, v33
    v_add_f32 v25, v25, v33
    v_cmp_nle_f32 vcc, s36, v21
    v_mfma_f32_16x16x32_bf16 v[172:175], a[236:239], v[40:43], v[172:175]
    s_nop 0
    s_or_b64 s[42:43], s[42:43], vcc
    v_exp_f32 v34, v34
    v_mul_f32 v64, v64, v30
    v_mul_f32 v65, v65, v30
    v_mul_f32 v66, v66, v30
    v_mul_f32 v67, v67, v30
    v_mul_f32 v68, v68, v30
    v_mul_f32 v69, v69, v30
    v_mul_f32 v70, v70, v30
    v_mfma_f32_16x16x32_bf16 v[176:179], a[240:243], v[40:43], v[176:179]
    v_add_f32 v25, v25, v34
    v_mul_f32 v71, v71, v30
    v_cvt_pk_bf16_f32 v64, v64, v65
    v_cvt_pk_bf16_f32 v65, v66, v67
    v_cvt_pk_bf16_f32 v66, v68, v69
    v_mfma_f32_16x16x32_bf16 v[180:183], a[244:247], v[40:43], v[180:183]
    s_waitcnt vmcnt(10) lgkmcnt(0)
    s_barrier
    v_exp_f32 v35, v35
    v_cvt_pk_bf16_f32 v67, v70, v71
    v_mfma_f32_16x16x32_bf16 v[184:187], a[248:251], v[40:43], v[184:187]
    ds_write_b64 v20, v[64:65] offset:0
    ds_write_b64 v20, v[66:67] offset:32
    v_cvt_pk_bf16_f32 v33, v34, v35
    v_add_f32 v25, v25, v35
    v_mfma_f32_16x16x32_bf16 a[0:3], v[64:67], v[64:67], 0
    v_mul_f32 v72, v72, v30
    v_mul_f32 v73, v73, v30
    v_mul_f32 v74, v74, v30
    v_mul_f32 v75, v75, v30
    v_mul_f32 v76, v76, v30
    v_mfma_f32_16x16x32_bf16 v[188:191], a[252:255], v[40:43], v[188:191]
    v_exp_f32 v36, v36
    v_mul_f32 v77, v77, v30
    v_mul_f32 v78, v78, v30
    v_mul_f32 v79, v79, v30
    v_cvt_pk_bf16_f32 v72, v72, v73
    v_cvt_pk_bf16_f32 v73, v74, v75
    v_mfma_f32_16x16x32_bf16 v[40:43], a[192:195], a[80:83], 0
    ds_read_b128 a[192:195], v1 offset:0
    ds_read_b64_tr_b16 v[62:63], v8 offset:4096
    v_add_f32 v25, v25, v36
    v_cvt_pk_bf16_f32 v74, v76, v77
    v_cvt_pk_bf16_f32 v75, v78, v79
    v_mfma_f32_16x16x32_bf16 v[40:43], a[196:199], a[84:87], v[40:43]
    ds_write_b64 v20, v[72:73] offset:64
    ds_write_b64 v20, v[74:75] offset:96
    v_exp_f32 v37, v37
    v_mfma_f32_16x16x32_bf16 a[0:3], v[72:75], v[72:75], a[0:3]
    v_mul_f32 v80, v80, v30
    v_mul_f32 v81, v81, v30
    v_mul_f32 v82, v82, v30
    v_mul_f32 v83, v83, v30
    v_mfma_f32_16x16x32_bf16 v[40:43], a[200:203], a[88:91], v[40:43]
    v_cvt_pk_bf16_f32 v34, v36, v37
    v_add_f32 v25, v25, v37
    v_mul_f32 v84, v84, v30
    v_mul_f32 v85, v85, v30
    v_mul_f32 v86, v86, v30
    v_mul_f32 v87, v87, v30
    v_mfma_f32_16x16x32_bf16 v[40:43], a[204:207], a[92:95], v[40:43]
    v_exp_f32 v38, v38
    v_cvt_pk_bf16_f32 v80, v80, v81
    v_cvt_pk_bf16_f32 v81, v82, v83
    v_cvt_pk_bf16_f32 v82, v84, v85
    v_cvt_pk_bf16_f32 v83, v86, v87
    v_mfma_f32_16x16x32_bf16 v[44:47], a[208:211], a[80:83], 0
    ds_write_b64 v20, v[80:81] offset:128
    ds_write_b64 v20, v[82:83] offset:160
    v_add_f32 v25, v25, v38
    v_mfma_f32_16x16x32_bf16 a[0:3], v[80:83], v[80:83], a[0:3]
    v_mul_f32 v88, v88, v30
    v_mul_f32 v89, v89, v30
    v_mfma_f32_16x16x32_bf16 v[44:47], a[212:215], a[84:87], v[44:47]
    v_exp_f32 v39, v39
    v_mul_f32 v90, v90, v30
    v_mul_f32 v91, v91, v30
    v_mul_f32 v92, v92, v30
    v_mul_f32 v93, v93, v30
    v_mul_f32 v94, v94, v30
    v_mfma_f32_16x16x32_bf16 v[44:47], a[216:219], a[88:91], v[44:47]
    v_cvt_pk_bf16_f32 v35, v38, v39
    v_add_f32 v25, v25, v39
    v_mul_f32 v95, v95, v30
    v_cvt_pk_bf16_f32 v88, v88, v89
    v_cvt_pk_bf16_f32 v89, v90, v91
    v_cvt_pk_bf16_f32 v90, v92, v93
    v_mfma_f32_16x16x32_bf16 v[44:47], a[220:223], a[92:95], v[44:47]
    ds_read_b128 a[196:199], v2 offset:0
    ds_read_b128 a[200:203], v3 offset:0
    v_exp_f32 v40, v40
    v_cvt_pk_bf16_f32 v91, v94, v95
    v_mfma_f32_16x16x32_bf16 v[192:195], a[224:227], v[32:35], v[192:195]
    ds_write_b64 v20, v[88:89] offset:192
    ds_write_b64 v20, v[90:91] offset:224
    v_add_f32 v26, v26, v40
    v_mfma_f32_16x16x32_bf16 a[0:3], v[88:91], v[88:91], a[0:3]
    v_mfma_f32_16x16x32_bf16 v[196:199], a[228:231], v[32:35], v[196:199]
    ds_read_b128 a[4:7], v19 offset:1088
    ds_read_b128 a[8:11], v19 offset:2176
    ds_read_b128 a[12:15], v19 offset:3264
    v_exp_f32 v41, v41
    s_nop 2
    v_accvgpr_read_b32 v29, a0
    v_sub_f32 v29, v29, v29
    v_accvgpr_read_b32 v31, a1
    v_fma_f32 v29, v31, 0, v29
    v_accvgpr_read_b32 v31, a2
    v_fma_f32 v29, v31, 0, v29
    v_accvgpr_read_b32 v31, a3
    v_mfma_f32_16x16x32_bf16 v[200:203], a[232:235], v[32:35], v[200:203]
    ds_read_b128 a[208:211], v1 offset:4096
    v_cvt_pk_bf16_f32 v40, v40, v41
    v_add_f32 v26, v26, v41
    v_fma_f32 v29, v31, 0, v29
    v_cmp_u_f32 vcc, v29, v29
    v_mfma_f32_16x16x32_bf16 v[204:207], a[236:239], v[32:35], v[204:207]
    ds_read_b128 a[204:207], v4 offset:0
    ds_read_b128 a[212:215], v2 offset:4096
    s_or_b64 s[42:43], s[42:43], vcc
    ds_read_b128 a[0:3], v19 offset:0
    v_exp_f32 v42, v42
    v_mfma_f32_16x16x32_bf16 v[208:211], a[240:243], v[32:35], v[208:211]
    v_add_f32 v26, v26, v42
    v_mov_b32 v29, v22
    s_nop 1
    v_permlane16_swap_b32 v22, v29
    v_add_f32 v22, v22, v29
    v_mov_b32 v29, v22
    s_nop 1
    v_permlane32_swap_b32 v22, v29
    v_mfma_f32_16x16x32_bf16 v[212:215], a[244:247], v[32:35], v[212:215]
    v_exp_f32 v43, v43
    v_add_f32 v22, v22, v29
    v_rcp_f32 v30, v22
    v_cmp_ngt_f32 vcc, s29, v22
    v_mfma_f32_16x16x32_bf16 v[216:219], a[248:251], v[32:35], v[216:219]
    ds_read_b128 a[216:219], v3 offset:4096
    ds_read_b128 a[220:223], v4 offset:4096
    s_or_b64 s[42:43], s[42:43], vcc
    v_cvt_pk_bf16_f32 v41, v42, v43
    v_add_f32 v26, v26, v43
    v_cmp_nle_f32 vcc, s36, v22
    v_mfma_f32_16x16x32_bf16 v[220:223], a[252:255], v[32:35], v[220:223]
    s_waitcnt lgkmcnt(4)
    s_or_b64 s[42:43], s[42:43], vcc
    v_exp_f32 v44, v44
    v_mul_f32 v96, v96, v30
    v_mul_f32 v97, v97, v30
    v_mul_f32 v98, v98, v30
    v_mul_f32 v99, v99, v30
    v_mul_f32 v100, v100, v30
    v_mul_f32 v101, v101, v30
    v_mul_f32 v102, v102, v30
    v_mfma_f32_16x16x32_bf16 v[32:35], a[192:195], a[96:99], 0
    v_add_f32 v26, v26, v44
    v_mul_f32 v103, v103, v30
    v_cvt_pk_bf16_f32 v96, v96, v97
    v_cvt_pk_bf16_f32 v97, v98, v99
    v_cvt_pk_bf16_f32 v98, v100, v101
    v_cvt_pk_bf16_f32 v99, v102, v103
    v_mfma_f32_16x16x32_bf16 v[32:35], a[196:199], a[100:103], v[32:35]
    ds_read_b64_tr_b16 v[48:49], v5 offset:0
    ds_read_b64_tr_b16 v[52:53], v6 offset:0
    v_exp_f32 v45, v45
    v_mfma_f32_16x16x32_bf16 v[32:35], a[200:203], a[104:107], v[32:35]
    ds_write_b64 v20, v[96:97] offset:0
    ds_write_b64 v20, v[98:99] offset:32
    v_cvt_pk_bf16_f32 v42, v44, v45
    v_add_f32 v26, v26, v45
    v_mfma_f32_16x16x32_bf16 a[16:19], v[96:99], v[96:99], 0
    v_mul_f32 v104, v104, v30
    v_mul_f32 v105, v105, v30
    v_mul_f32 v106, v106, v30
    v_mul_f32 v107, v107, v30
    v_mul_f32 v108, v108, v30
    v_mul_f32 v109, v109, v30
    v_mfma_f32_16x16x32_bf16 v[32:35], a[204:207], a[108:111], v[32:35]
    s_waitcnt lgkmcnt(4)
    v_exp_f32 v46, v46
    v_mul_f32 v110, v110, v30
    v_mul_f32 v111, v111, v30
    v_cvt_pk_bf16_f32 v104, v104, v105
    v_cvt_pk_bf16_f32 v105, v106, v107
    v_mfma_f32_16x16x32_bf16 v[36:39], a[208:211], a[96:99], 0
    ds_read_b64_tr_b16 v[54:55], v6 offset:4096
    v_add_f32 v26, v26, v46
    v_cvt_pk_bf16_f32 v106, v108, v109
    v_cvt_pk_bf16_f32 v107, v110, v111
    v_mfma_f32_16x16x32_bf16 v[36:39], a[212:215], a[100:103], v[36:39]
    ds_write_b64 v20, v[104:105] offset:64
    ds_write_b64 v20, v[106:107] offset:96
    v_exp_f32 v47, v47
    v_mfma_f32_16x16x32_bf16 a[16:19], v[104:107], v[104:107], a[16:19]
    v_mul_f32 v112, v112, v30
    v_mul_f32 v113, v113, v30
    v_mul_f32 v114, v114, v30
    v_mul_f32 v115, v115, v30
    v_mfma_f32_16x16x32_bf16 v[36:39], a[216:219], a[104:107], v[36:39]
    v_cvt_pk_bf16_f32 v43, v46, v47
    v_add_f32 v26, v26, v47
    v_mul_f32 v116, v116, v30
    v_mul_f32 v117, v117, v30
    v_mul_f32 v118, v118, v30
    v_mul_f32 v119, v119, v30
    v_cvt_pk_bf16_f32 v112, v112, v113
    v_mfma_f32_16x16x32_bf16 v[36:39], a[220:223], a[108:111], v[36:39]
    v_exp_f32 v32, v32
    v_cvt_pk_bf16_f32 v113, v114, v115
    v_cvt_pk_bf16_f32 v114, v116, v117
    v_cvt_pk_bf16_f32 v115, v118, v119
    v_mfma_f32_16x16x32_bf16 v[224:227], a[224:227], v[40:43], v[224:227]
    ds_write_b64 v20, v[112:113] offset:128
    ds_write_b64 v20, v[114:115] offset:160
    v_mov_b32 v21, v32
    v_mfma_f32_16x16x32_bf16 a[16:19], v[112:115], v[112:115], a[16:19]
    v_mul_f32 v120, v120, v30
    v_mul_f32 v121, v121, v30
    v_mul_f32 v122, v122, v30
    v_mfma_f32_16x16x32_bf16 v[228:231], a[228:231], v[40:43], v[228:231]
    v_exp_f32 v33, v33
    v_mul_f32 v123, v123, v30
    v_mul_f32 v124, v124, v30
    v_mul_f32 v125, v125, v30
    v_mul_f32 v126, v126, v30
    v_mfma_f32_16x16x32_bf16 v[232:235], a[232:235], v[40:43], v[232:235]
    v_cvt_pk_bf16_f32 v32, v32, v33
    v_add_f32 v21, v21, v33
    v_mul_f32 v127, v127, v30
    v_cvt_pk_bf16_f32 v120, v120, v121
    v_cvt_pk_bf16_f32 v121, v122, v123
    v_cvt_pk_bf16_f32 v122, v124, v125
    v_cvt_pk_bf16_f32 v123, v126, v127
    v_mfma_f32_16x16x32_bf16 v[236:239], a[236:239], v[40:43], v[236:239]
    ds_read_b64_tr_b16 v[50:51], v5 offset:4096
    ds_read_b64_tr_b16 v[56:57], v7 offset:0
    v_exp_f32 v34, v34
    v_mfma_f32_16x16x32_bf16 v[240:243], a[240:243], v[40:43], v[240:243]
    ds_write_b64 v20, v[120:121] offset:192
    ds_write_b64 v20, v[122:123] offset:224
    v_add_f32 v21, v21, v34
    v_mfma_f32_16x16x32_bf16 a[16:19], v[120:123], v[120:123], a[16:19]
    v_mfma_f32_16x16x32_bf16 v[244:247], a[244:247], v[40:43], v[244:247]
    ds_read_b128 a[20:23], v19 offset:1088
    ds_read_b128 a[24:27], v19 offset:2176
    ds_read_b128 a[28:31], v19 offset:3264
    v_exp_f32 v35, v35
    s_nop 2
    v_accvgpr_read_b32 v29, a16
    v_sub_f32 v29, v29, v29
    v_accvgpr_read_b32 v31, a17
    v_fma_f32 v29, v31, 0, v29
    v_accvgpr_read_b32 v31, a18
    v_fma_f32 v29, v31, 0, v29
    v_accvgpr_read_b32 v31, a19
    v_mfma_f32_16x16x32_bf16 v[248:251], a[248:251], v[40:43], v[248:251]
    ds_read_b64_tr_b16 a[240:241], v9 offset:0
    v_cvt_pk_bf16_f32 v33, v34, v35
    v_add_f32 v21, v21, v35
    v_fma_f32 v29, v31, 0, v29
    v_cmp_u_f32 vcc, v29, v29
    v_mfma_f32_16x16x32_bf16 v[252:255], a[252:255], v[40:43], v[252:255]
    ds_read_b64_tr_b16 v[58:59], v7 offset:4096
    ds_read_b64_tr_b16 a[242:243], v9 offset:4096
    ds_read_b64_tr_b16 a[254:255], v12 offset:4096
    s_or_b64 s[42:43], s[42:43], vcc
    ds_read_b128 a[16:19], v19 offset:0
    v_exp_f32 v36, v36
    v_mfma_f32_16x16x32_bf16 v[40:43], a[192:195], a[112:115], 0
    v_add_f32 v21, v21, v36
    v_mov_b32 v29, v23
    s_nop 1
    v_permlane16_swap_b32 v23, v29
    v_add_f32 v23, v23, v29
    v_mov_b32 v29, v23
    s_nop 1
    v_permlane32_swap_b32 v23, v29
    v_mfma_f32_16x16x32_bf16 v[40:43], a[196:199], a[116:119], v[40:43]
    v_exp_f32 v37, v37
    v_add_f32 v23, v23, v29
    v_rcp_f32 v30, v23
    v_cmp_ngt_f32 vcc, s29, v23
    v_mfma_f32_16x16x32_bf16 v[40:43], a[200:203], a[120:123], v[40:43]
    ds_read_b64_tr_b16 v[60:61], v8 offset:0
    ds_read_b64_tr_b16 a[250:251], v11 offset:4096
    s_or_b64 s[42:43], s[42:43], vcc
    v_cvt_pk_bf16_f32 v34, v36, v37
    v_add_f32 v21, v21, v37
    v_cmp_nle_f32 vcc, s36, v23
    v_mfma_f32_16x16x32_bf16 v[40:43], a[204:207], a[124:127], v[40:43]
    s_nop 0
    s_or_b64 s[42:43], s[42:43], vcc
    v_exp_f32 v38, v38
    v_mul_f32 v128, v128, v30
    v_mul_f32 v129, v129, v30
    v_mul_f32 v130, v130, v30
    v_mul_f32 v131, v131, v30
    v_mul_f32 v132, v132, v30
    v_mul_f32 v133, v133, v30
    v_mul_f32 v134, v134, v30
    v_mfma_f32_16x16x32_bf16 v[44:47], a[208:211], a[112:115], 0
    v_add_f32 v21, v21, v38
    v_mul_f32 v135, v135, v30
    v_cvt_pk_bf16_f32 v128, v128, v129
    v_cvt_pk_bf16_f32 v129, v130, v131
    v_cvt_pk_bf16_f32 v130, v132, v133
    v_cvt_pk_bf16_f32 v131, v134, v135
    v_mfma_f32_16x16x32_bf16 v[44:47], a[212:215], a[116:119], v[44:47]
    ds_read_b64_tr_b16 a[244:245], v10 offset:0
    ds_read_b64_tr_b16 a[246:247], v10 offset:4096
    ds_read_b64_tr_b16 a[248:249], v11 offset:0
    ds_read_b64_tr_b16 a[252:253], v12 offset:0
    v_exp_f32 v39, v39
    v_mfma_f32_16x16x32_bf16 v[44:47], a[216:219], a[120:123], v[44:47]
    ds_write_b64 v20, v[128:129] offset:0
    ds_write_b64 v20, v[130:131] offset:32
    v_cvt_pk_bf16_f32 v35, v38, v39
    v_add_f32 v21, v21, v39
    v_mfma_f32_16x16x32_bf16 a[32:35], v[128:131], v[128:131], 0
    v_mul_f32 v136, v136, v30
    v_mul_f32 v137, v137, v30
    v_mul_f32 v138, v138, v30
    v_mul_f32 v139, v139, v30
    v_mul_f32 v140, v140, v30
    v_mul_f32 v141, v141, v30
    v_mfma_f32_16x16x32_bf16 v[44:47], a[220:223], a[124:127], v[44:47]
    s_waitcnt lgkmcnt(7)
    v_exp_f32 v40, v40
    v_mul_f32 v142, v142, v30
    v_mul_f32 v143, v143, v30
    v_cvt_pk_bf16_f32 v136, v136, v137
    v_cvt_pk_bf16_f32 v137, v138, v139
    v_mfma_f32_16x16x32_bf16 v[64:67], v[48:51], v[32:35], 0
    v_mov_b32 v22, v40
    v_cvt_pk_bf16_f32 v138, v140, v141
    v_cvt_pk_bf16_f32 v139, v142, v143
    v_mfma_f32_16x16x32_bf16 v[68:71], v[52:55], v[32:35], 0
    ds_write_b64 v20, v[136:137] offset:64
    ds_write_b64 v20, v[138:139] offset:96
    v_exp_f32 v41, v41
    v_mfma_f32_16x16x32_bf16 a[32:35], v[136:139], v[136:139], a[32:35]
    v_mul_f32 v144, v144, v30
    v_mul_f32 v145, v145, v30
    v_mul_f32 v146, v146, v30
    v_mul_f32 v147, v147, v30
    v_mfma_f32_16x16x32_bf16 v[72:75], v[56:59], v[32:35], 0
    v_cvt_pk_bf16_f32 v40, v40, v41
    v_add_f32 v22, v22, v41
    v_mul_f32 v148, v148, v30
    v_mul_f32 v149, v149, v30
    v_mul_f32 v150, v150, v30
    v_mul_f32 v151, v151, v30
    v_cvt_pk_bf16_f32 v144, v144, v145
    v_mfma_f32_16x16x32_bf16 v[76:79], v[60:63], v[32:35], 0
    s_waitcnt lgkmcnt(4)
    v_exp_f32 v42, v42
    v_cvt_pk_bf16_f32 v145, v146, v147
    v_cvt_pk_bf16_f32 v146, v148, v149
    v_cvt_pk_bf16_f32 v147, v150, v151
    v_mfma_f32_16x16x32_bf16 v[80:83], a[240:243], v[32:35], 0
    ds_write_b64 v20, v[144:145] offset:128
    ds_write_b64 v20, v[146:147] offset:160
    v_add_f32 v22, v22, v42
    v_mfma_f32_16x16x32_bf16 a[32:35], v[144:147], v[144:147], a[32:35]
    v_mul_f32 v152, v152, v30
    v_mul_f32 v153, v153, v30
    v_mul_f32 v154, v154, v30
    v_mfma_f32_16x16x32_bf16 v[84:87], a[244:247], v[32:35], 0
    v_exp_f32 v43, v43
    v_mul_f32 v155, v155, v30
    v_mul_f32 v156, v156, v30
    v_mul_f32 v157, v157, v30
    v_mul_f32 v158, v158, v30
    v_mfma_f32_16x16x32_bf16 v[88:91], a[248:251], v[32:35], 0
    v_cvt_pk_bf16_f32 v41, v42, v43
    v_add_f32 v22, v22, v43
    v_mul_f32 v159, v159, v30
    v_cvt_pk_bf16_f32 v152, v152, v153
    v_cvt_pk_bf16_f32 v153, v154, v155
    v_cvt_pk_bf16_f32 v154, v156, v157
    v_cvt_pk_bf16_f32 v155, v158, v159
    v_mfma_f32_16x16x32_bf16 v[92:95], a[252:255], v[32:35], 0
    ds_read_b64_tr_b16 a[234:235], v7 offset:12288
    v_exp_f32 v44, v44
    v_mfma_f32_16x16x32_bf16 v[32:35], a[192:195], a[128:131], 0
    ds_write_b64 v20, v[152:153] offset:192
    ds_write_b64 v20, v[154:155] offset:224
    v_add_f32 v22, v22, v44
    v_mfma_f32_16x16x32_bf16 a[32:35], v[152:155], v[152:155], a[32:35]
    v_mfma_f32_16x16x32_bf16 v[32:35], a[196:199], a[132:135], v[32:35]
    ds_read_b128 a[36:39], v19 offset:1088
    ds_read_b128 a[40:43], v19 offset:2176
    ds_read_b128 a[44:47], v19 offset:3264
    v_exp_f32 v45, v45
    s_nop 2
    v_accvgpr_read_b32 v29, a32
    v_sub_f32 v29, v29, v29
    v_accvgpr_read_b32 v31, a33
    v_fma_f32 v29, v31, 0, v29
    v_accvgpr_read_b32 v31, a34
    v_fma_f32 v29, v31, 0, v29
    v_accvgpr_read_b32 v31, a35
    v_mfma_f32_16x16x32_bf16 v[32:35], a[200:203], a[136:139], v[32:35]
    v_cvt_pk_bf16_f32 v42, v44, v45
    v_add_f32 v22, v22, v45
    v_fma_f32 v29, v31, 0, v29
    v_cmp_u_f32 vcc, v29, v29
    v_mfma_f32_16x16x32_bf16 v[32:35], a[204:207], a[140:143], v[32:35]
    s_nop 0
    s_or_b64 s[42:43], s[42:43], vcc
    ds_read_b128 a[32:35], v19 offset:0
    v_exp_f32 v46, v46
    v_mfma_f32_16x16x32_bf16 v[36:39], a[208:211], a[128:131], 0
    v_add_f32 v22, v22, v46
    v_mov_b32 v29, v24
    s_nop 1
    v_permlane16_swap_b32 v24, v29
    v_add_f32 v24, v24, v29
    v_mov_b32 v29, v24
    s_nop 1
    v_permlane32_swap_b32 v24, v29
    v_mfma_f32_16x16x32_bf16 v[36:39], a[212:215], a[132:135], v[36:39]
    v_exp_f32 v47, v47
    v_add_f32 v24, v24, v29
    v_rcp_f32 v30, v24
    v_cmp_ngt_f32 vcc, s29, v24
    v_mfma_f32_16x16x32_bf16 v[36:39], a[216:219], a[136:139], v[36:39]
    s_nop 0
    s_or_b64 s[42:43], s[42:43], vcc
    v_cvt_pk_bf16_f32 v43, v46, v47
    v_add_f32 v22, v22, v47
    v_cmp_nle_f32 vcc, s36, v24
    v_mfma_f32_16x16x32_bf16 v[36:39], a[220:223], a[140:143], v[36:39]
    s_mov_b32 m0, s31
    s_or_b64 s[42:43], s[42:43], vcc
    v_exp_f32 v32, v32
    v_mul_f32 v160, v160, v30
    v_mul_f32 v161, v161, v30
    v_mul_f32 v162, v162, v30
    v_mul_f32 v163, v163, v30
    v_mul_f32 v164, v164, v30
    v_mul_f32 v165, v165, v30
    v_mul_f32 v166, v166, v30
    v_mfma_f32_16x16x32_bf16 v[96:99], v[48:51], v[40:43], 0
    buffer_load_dwordx4 v13, s[8:11], s30 offen offset:0 nt lds
    v_mov_b32 v23, v32
    v_mul_f32 v167, v167, v30
    v_cvt_pk_bf16_f32 v160, v160, v161
    v_cvt_pk_bf16_f32 v161, v162, v163
    v_cvt_pk_bf16_f32 v162, v164, v165
    v_cvt_pk_bf16_f32 v163, v166, v167
    v_mfma_f32_16x16x32_bf16 v[100:103], v[52:55], v[40:43], 0
    ds_read_b64_tr_b16 a[236:237], v8 offset:8192
    v_exp_f32 v33, v33
    v_mfma_f32_16x16x32_bf16 v[104:107], v[56:59], v[40:43], 0
    ds_write_b64 v20, v[160:161] offset:0
    ds_write_b64 v20, v[162:163] offset:32
    v_cvt_pk_bf16_f32 v32, v32, v33
    v_add_f32 v23, v23, v33
    v_mfma_f32_16x16x32_bf16 a[48:51], v[160:163], v[160:163], 0
    v_mul_f32 v168, v168, v30
    v_mul_f32 v169, v169, v30
    v_mul_f32 v170, v170, v30
    v_mul_f32 v171, v171, v30
    v_mul_f32 v172, v172, v30
    v_mul_f32 v173, v173, v30
    v_mfma_f32_16x16x32_bf16 v[108:111], v[60:63], v[40:43], 0
    v_exp_f32 v34, v34
    v_mul_f32 v174, v174, v30
    v_mul_f32 v175, v175, v30
    v_cvt_pk_bf16_f32 v168, v168, v169
    v_cvt_pk_bf16_f32 v169, v170, v171
    v_mfma_f32_16x16x32_bf16 v[112:115], a[240:243], v[40:43], 0
    buffer_load_dwordx4 v14, s[8:11], s30 offen offset:1024 nt lds
    v_add_f32 v23, v23, v34
    v_cvt_pk_bf16_f32 v170, v172, v173
    v_cvt_pk_bf16_f32 v171, v174, v175
    v_mfma_f32_16x16x32_bf16 v[116:119], a[244:247], v[40:43], 0
    ds_write_b64 v20, v[168:169] offset:64
    ds_write_b64 v20, v[170:171] offset:96
    v_exp_f32 v35, v35
    v_mfma_f32_16x16x32_bf16 a[48:51], v[168:171], v[168:171], a[48:51]
    v_mul_f32 v176, v176, v30
    v_mul_f32 v177, v177, v30
    v_mul_f32 v178, v178, v30
    v_mul_f32 v179, v179, v30
    v_mfma_f32_16x16x32_bf16 v[120:123], a[248:251], v[40:43], 0
    v_cvt_pk_bf16_f32 v33, v34, v35
    v_add_f32 v23, v23, v35
    v_mul_f32 v180, v180, v30
    v_mul_f32 v181, v181, v30
    v_mul_f32 v182, v182, v30
    v_mul_f32 v183, v183, v30
    v_cvt_pk_bf16_f32 v176, v176, v177
    v_mfma_f32_16x16x32_bf16 v[124:127], a[252:255], v[40:43], 0
    v_exp_f32 v36, v36
    v_cvt_pk_bf16_f32 v177, v178, v179
    v_cvt_pk_bf16_f32 v178, v180, v181
    v_cvt_pk_bf16_f32 v179, v182, v183
    v_mfma_f32_16x16x32_bf16 v[40:43], a[192:195], a[144:147], 0
    s_add_u32 s35, s32, 0x4000
    buffer_load_dwordx4 v15, s[8:11], s30 offen offset:2048 nt lds
    ds_write_b64 v20, v[176:177] offset:128
    ds_write_b64 v20, v[178:179] offset:160
    v_add_f32 v23, v23, v36
    v_mfma_f32_16x16x32_bf16 a[48:51], v[176:179], v[176:179], a[48:51]
    v_mul_f32 v184, v184, v30
    v_mul_f32 v185, v185, v30
    v_mul_f32 v186, v186, v30
    v_mfma_f32_16x16x32_bf16 v[40:43], a[196:199], a[148:151], v[40:43]
    s_and_b32 s35, s35, 0xffff
    v_exp_f32 v37, v37
    v_mul_f32 v187, v187, v30
    v_mul_f32 v188, v188, v30
    v_mul_f32 v189, v189, v30
    v_mul_f32 v190, v190, v30
    v_mfma_f32_16x16x32_bf16 v[40:43], a[200:203], a[152:155], v[40:43]
    s_sub_u32 s33, s35, s32
    v_cvt_pk_bf16_f32 v34, v36, v37
    v_add_f32 v23, v23, v37
    v_mul_f32 v191, v191, v30
    v_cvt_pk_bf16_f32 v184, v184, v185
    v_cvt_pk_bf16_f32 v185, v186, v187
    v_cvt_pk_bf16_f32 v186, v188, v189
    v_cvt_pk_bf16_f32 v187, v190, v191
    v_mfma_f32_16x16x32_bf16 v[40:43], a[204:207], a[156:159], v[40:43]
    ds_read_b64_tr_b16 a[238:239], v8 offset:12288
    v_exp_f32 v38, v38
    v_mfma_f32_16x16x32_bf16 v[44:47], a[208:211], a[144:147], 0
    buffer_load_dwordx4 v16, s[8:11], s30 offen offset:3072 nt lds
    ds_write_b64 v20, v[184:185] offset:192
    ds_write_b64 v20, v[186:187] offset:224
    v_add_f32 v23, v23, v38
    v_mfma_f32_16x16x32_bf16 a[48:51], v[184:187], v[184:187], a[48:51]
    v_mfma_f32_16x16x32_bf16 v[44:47], a[212:215], a[148:151], v[44:47]
    ds_read_b128 a[52:55], v19 offset:1088
    ds_read_b128 a[56:59], v19 offset:2176
    ds_read_b128 a[60:63], v19 offset:3264
    v_exp_f32 v39, v39
    s_nop 2
    v_accvgpr_read_b32 v29, a48
    v_sub_f32 v29, v29, v29
    v_accvgpr_read_b32 v31, a49
    v_fma_f32 v29, v31, 0, v29
    v_accvgpr_read_b32 v31, a50
    v_fma_f32 v29, v31, 0, v29
    v_accvgpr_read_b32 v31, a51
    v_mfma_f32_16x16x32_bf16 v[44:47], a[216:219], a[152:155], v[44:47]
    v_cvt_pk_bf16_f32 v35, v38, v39
    v_add_f32 v23, v23, v39
    v_fma_f32 v29, v31, 0, v29
    v_cmp_u_f32 vcc, v29, v29
    v_mfma_f32_16x16x32_bf16 v[44:47], a[220:223], a[156:159], v[44:47]
    s_add_u32 m0, s31, 65536
    s_or_b64 s[42:43], s[42:43], vcc
    ds_read_b128 a[48:51], v19 offset:0
    v_exp_f32 v40, v40
    v_mfma_f32_16x16x32_bf16 v[128:131], v[48:51], v[32:35], 0
    buffer_load_dwordx4 v17, s[12:15], s30 offen offset:0 nt lds
    v_mov_b32 v24, v40
    v_mov_b32 v29, v25
    s_nop 1
    v_permlane16_swap_b32 v25, v29
    v_add_f32 v25, v25, v29
    v_mov_b32 v29, v25
    s_nop 1
    v_permlane32_swap_b32 v25, v29
    v_mfma_f32_16x16x32_bf16 v[132:135], v[52:55], v[32:35], 0
    v_exp_f32 v41, v41
    v_add_f32 v25, v25, v29
    v_rcp_f32 v30, v25
    v_cmp_ngt_f32 vcc, s29, v25
    v_mfma_f32_16x16x32_bf16 v[136:139], v[56:59], v[32:35], 0
    s_nop 0
    s_or_b64 s[42:43], s[42:43], vcc
    v_cvt_pk_bf16_f32 v40, v40, v41
    v_add_f32 v24, v24, v41
    v_cmp_nle_f32 vcc, s36, v25
    v_mfma_f32_16x16x32_bf16 v[140:143], v[60:63], v[32:35], 0
    s_nop 0
    s_or_b64 s[42:43], s[42:43], vcc
    v_exp_f32 v42, v42
    v_mul_f32 v192, v192, v30
    v_mul_f32 v193, v193, v30
    v_mul_f32 v194, v194, v30
    v_mul_f32 v195, v195, v30
    v_mul_f32 v196, v196, v30
    v_mul_f32 v197, v197, v30
    v_mul_f32 v198, v198, v30
    v_mfma_f32_16x16x32_bf16 v[144:147], a[240:243], v[32:35], 0
    buffer_load_dwordx4 v18, s[12:15], s30 offen offset:1024 nt lds
    v_add_f32 v24, v24, v42
    v_mul_f32 v199, v199, v30
    v_cvt_pk_bf16_f32 v192, v192, v193
    v_cvt_pk_bf16_f32 v193, v194, v195
    v_cvt_pk_bf16_f32 v194, v196, v197
    v_cvt_pk_bf16_f32 v195, v198, v199
    v_mfma_f32_16x16x32_bf16 v[148:151], a[244:247], v[32:35], 0
    v_exp_f32 v43, v43
    v_add_u32 v8, s33, v8
    v_mfma_f32_16x16x32_bf16 v[152:155], a[248:251], v[32:35], 0
    ds_write_b64 v20, v[192:193] offset:0
    ds_write_b64 v20, v[194:195] offset:32
    v_cvt_pk_bf16_f32 v41, v42, v43
    v_add_f32 v24, v24, v43
    v_mfma_f32_16x16x32_bf16 a[64:67], v[192:195], v[192:195], 0
    v_mul_f32 v200, v200, v30
    v_mul_f32 v201, v201, v30
    v_mul_f32 v202, v202, v30
    v_mul_f32 v203, v203, v30
    v_mul_f32 v204, v204, v30
    v_mul_f32 v205, v205, v30
    v_mfma_f32_16x16x32_bf16 v[156:159], a[252:255], v[32:35], 0
    v_exp_f32 v44, v44
    v_mul_f32 v206, v206, v30
    v_mul_f32 v207, v207, v30
    v_cvt_pk_bf16_f32 v200, v200, v201
    v_cvt_pk_bf16_f32 v201, v202, v203
    v_mfma_f32_16x16x32_bf16 v[32:35], a[192:195], a[160:163], 0
    buffer_load_dwordx4 v17, s[12:15], s30 offen offset:2048 nt lds
    v_add_f32 v24, v24, v44
    v_cvt_pk_bf16_f32 v202, v204, v205
    v_cvt_pk_bf16_f32 v203, v206, v207
    v_mfma_f32_16x16x32_bf16 v[32:35], a[196:199], a[164:167], v[32:35]
    ds_write_b64 v20, v[200:201] offset:64
    ds_write_b64 v20, v[202:203] offset:96
    v_exp_f32 v45, v45
    v_mfma_f32_16x16x32_bf16 a[64:67], v[200:203], v[200:203], a[64:67]
    v_mul_f32 v208, v208, v30
    v_mul_f32 v209, v209, v30
    v_mul_f32 v210, v210, v30
    v_mul_f32 v211, v211, v30
    v_mfma_f32_16x16x32_bf16 v[32:35], a[200:203], a[168:171], v[32:35]
    v_cvt_pk_bf16_f32 v42, v44, v45
    v_add_f32 v24, v24, v45
    v_mul_f32 v212, v212, v30
    v_mul_f32 v213, v213, v30
    v_mul_f32 v214, v214, v30
    v_mul_f32 v215, v215, v30
    v_cvt_pk_bf16_f32 v208, v208, v209
    v_mfma_f32_16x16x32_bf16 v[32:35], a[204:207], a[172:175], v[32:35]
    v_exp_f32 v46, v46
    v_cvt_pk_bf16_f32 v209, v210, v211
    v_cvt_pk_bf16_f32 v210, v212, v213
    v_cvt_pk_bf16_f32 v211, v214, v215
    v_mfma_f32_16x16x32_bf16 v[36:39], a[208:211], a[160:163], 0
    buffer_load_dwordx4 v18, s[12:15], s30 offen offset:3072 nt lds
    ds_write_b64 v20, v[208:209] offset:128
    ds_write_b64 v20, v[210:211] offset:160
    v_add_f32 v24, v24, v46
    v_mfma_f32_16x16x32_bf16 a[64:67], v[208:211], v[208:211], a[64:67]
    v_mul_f32 v216, v216, v30
    v_mul_f32 v217, v217, v30
    v_mul_f32 v218, v218, v30
    v_mfma_f32_16x16x32_bf16 v[36:39], a[212:215], a[164:167], v[36:39]
    s_add_u32 s31, s31, 0x4000
    v_exp_f32 v47, v47
    v_mul_f32 v219, v219, v30
    v_mul_f32 v220, v220, v30
    v_mul_f32 v221, v221, v30
    v_mul_f32 v222, v222, v30
    v_mfma_f32_16x16x32_bf16 v[36:39], a[216:219], a[168:171], v[36:39]
    s_and_b32 s31, s31, 0xffff
    v_cvt_pk_bf16_f32 v43, v46, v47
    v_add_f32 v24, v24, v47
    v_mul_f32 v223, v223, v30
    v_cvt_pk_bf16_f32 v216, v216, v217
    v_cvt_pk_bf16_f32 v217, v218, v219
    v_cvt_pk_bf16_f32 v218, v220, v221
    v_cvt_pk_bf16_f32 v219, v222, v223
    v_mfma_f32_16x16x32_bf16 v[36:39], a[220:223], a[172:175], v[36:39]
    s_add_u32 s30, s30, 0x4000
    v_exp_f32 v32, v32
    v_mfma_f32_16x16x32_bf16 v[160:163], v[48:51], v[40:43], 0
    ds_write_b64 v20, v[216:217] offset:192
    ds_write_b64 v20, v[218:219] offset:224
    v_mov_b32 v25, v32
    v_mfma_f32_16x16x32_bf16 a[64:67], v[216:219], v[216:219], a[64:67]
    v_mfma_f32_16x16x32_bf16 v[164:167], v[52:55], v[40:43], 0
    ds_read_b128 a[68:71], v19 offset:1088
    ds_read_b128 a[72:75], v19 offset:2176
    ds_read_b128 a[76:79], v19 offset:3264
    v_exp_f32 v33, v33
    s_nop 2
    v_accvgpr_read_b32 v29, a64
    v_sub_f32 v29, v29, v29
    v_accvgpr_read_b32 v31, a65
    v_fma_f32 v29, v31, 0, v29
    v_accvgpr_read_b32 v31, a66
    v_fma_f32 v29, v31, 0, v29
    v_accvgpr_read_b32 v31, a67
    v_mfma_f32_16x16x32_bf16 v[168:171], v[56:59], v[40:43], 0
    v_cvt_pk_bf16_f32 v32, v32, v33
    v_add_f32 v25, v25, v33
    v_fma_f32 v29, v31, 0, v29
    v_cmp_u_f32 vcc, v29, v29
    v_mfma_f32_16x16x32_bf16 v[172:175], v[60:63], v[40:43], 0
    s_nop 0
    s_or_b64 s[42:43], s[42:43], vcc
    ds_read_b128 a[64:67], v19 offset:0
    v_exp_f32 v34, v34
    v_mfma_f32_16x16x32_bf16 v[176:179], a[240:243], v[40:43], 0
    v_add_f32 v25, v25, v34
    v_mov_b32 v29, v26
    s_nop 1
    v_permlane16_swap_b32 v26, v29
    v_add_f32 v26, v26, v29
    v_mov_b32 v29, v26
    s_nop 1
    v_permlane32_swap_b32 v26, v29
    v_mfma_f32_16x16x32_bf16 v[180:183], a[244:247], v[40:43], 0
    v_exp_f32 v35, v35
    v_add_f32 v26, v26, v29
    v_rcp_f32 v30, v26
    v_cmp_ngt_f32 vcc, s29, v26
    v_mfma_f32_16x16x32_bf16 v[184:187], a[248:251], v[40:43], 0
    s_nop 0
    s_or_b64 s[42:43], s[42:43], vcc
    v_cvt_pk_bf16_f32 v33, v34, v35
    v_add_f32 v25, v25, v35
    v_cmp_nle_f32 vcc, s36, v26
    v_mfma_f32_16x16x32_bf16 v[188:191], a[252:255], v[40:43], 0
    s_nop 0
    s_or_b64 s[42:43], s[42:43], vcc
    v_exp_f32 v36, v36
    v_mul_f32 v224, v224, v30
    v_mul_f32 v225, v225, v30
    v_mul_f32 v226, v226, v30
    v_mul_f32 v227, v227, v30
    v_mul_f32 v228, v228, v30
    v_mul_f32 v229, v229, v30
    v_mul_f32 v230, v230, v30
    v_mfma_f32_16x16x32_bf16 v[40:43], a[192:195], a[176:179], 0
    v_add_f32 v25, v25, v36
    v_mul_f32 v231, v231, v30
    v_cvt_pk_bf16_f32 v224, v224, v225
    v_cvt_pk_bf16_f32 v225, v226, v227
    v_cvt_pk_bf16_f32 v226, v228, v229
    v_cvt_pk_bf16_f32 v227, v230, v231
    v_mfma_f32_16x16x32_bf16 v[40:43], a[196:199], a[180:183], v[40:43]
    ds_read_b128 a[192:195], v1 offset:8192
    ds_read_b128 a[196:199], v2 offset:8192
    v_exp_f32 v37, v37
    v_mfma_f32_16x16x32_bf16 v[40:43], a[200:203], a[184:187], v[40:43]
    ds_write_b64 v20, v[224:225] offset:0
    ds_write_b64 v20, v[226:227] offset:32
    v_cvt_pk_bf16_f32 v34, v36, v37
    v_add_f32 v25, v25, v37
    v_mfma_f32_16x16x32_bf16 a[80:83], v[224:227], v[224:227], 0
    v_mul_f32 v232, v232, v30
    v_mul_f32 v233, v233, v30
    v_mul_f32 v234, v234, v30
    v_mul_f32 v235, v235, v30
    v_mul_f32 v236, v236, v30
    v_mul_f32 v237, v237, v30
    v_mfma_f32_16x16x32_bf16 v[40:43], a[204:207], a[188:191], v[40:43]
    v_exp_f32 v38, v38
    v_mul_f32 v238, v238, v30
    v_mul_f32 v239, v239, v30
    v_cvt_pk_bf16_f32 v232, v232, v233
    v_cvt_pk_bf16_f32 v233, v234, v235
    v_mfma_f32_16x16x32_bf16 v[44:47], a[208:211], a[176:179], 0
    ds_read_b128 a[200:203], v3 offset:8192
    v_add_f32 v25, v25, v38
    v_cvt_pk_bf16_f32 v234, v236, v237
    v_cvt_pk_bf16_f32 v235, v238, v239
    v_mfma_f32_16x16x32_bf16 v[44:47], a[212:215], a[180:183], v[44:47]
    ds_write_b64 v20, v[232:233] offset:64
    ds_write_b64 v20, v[234:235] offset:96
    v_exp_f32 v39, v39
    v_mfma_f32_16x16x32_bf16 a[80:83], v[232:235], v[232:235], a[80:83]
    v_mul_f32 v240, v240, v30
    v_mul_f32 v241, v241, v30
    v_mul_f32 v242, v242, v30
    v_mul_f32 v243, v243, v30
    v_mfma_f32_16x16x32_bf16 v[44:47], a[216:219], a[184:187], v[44:47]
    v_cvt_pk_bf16_f32 v35, v38, v39
    v_add_f32 v25, v25, v39
    v_mul_f32 v244, v244, v30
    v_mul_f32 v245, v245, v30
    v_mul_f32 v246, v246, v30
    v_mul_f32 v247, v247, v30
    v_cvt_pk_bf16_f32 v240, v240, v241
    v_mfma_f32_16x16x32_bf16 v[44:47], a[220:223], a[188:191], v[44:47]
    v_exp_f32 v40, v40
    v_cvt_pk_bf16_f32 v241, v242, v243
    v_cvt_pk_bf16_f32 v242, v244, v245
    v_cvt_pk_bf16_f32 v243, v246, v247
    v_mfma_f32_16x16x32_bf16 v[192:195], v[48:51], v[32:35], 0
    ds_write_b64 v20, v[240:241] offset:128
    ds_write_b64 v20, v[242:243] offset:160
    v_mov_b32 v26, v40
    v_mfma_f32_16x16x32_bf16 a[80:83], v[240:243], v[240:243], a[80:83]
    v_mul_f32 v248, v248, v30
    v_mul_f32 v249, v249, v30
    v_mul_f32 v250, v250, v30
    v_mfma_f32_16x16x32_bf16 v[196:199], v[52:55], v[32:35], 0
    v_exp_f32 v41, v41
    v_mul_f32 v251, v251, v30
    v_mul_f32 v252, v252, v30
    v_mul_f32 v253, v253, v30
    v_mul_f32 v254, v254, v30
    v_mfma_f32_16x16x32_bf16 v[200:203], v[56:59], v[32:35], 0
    v_cvt_pk_bf16_f32 v40, v40, v41
    v_add_f32 v26, v26, v41
    v_mul_f32 v255, v255, v30
    v_cvt_pk_bf16_f32 v248, v248, v249
    v_cvt_pk_bf16_f32 v249, v250, v251
    v_cvt_pk_bf16_f32 v250, v252, v253
    v_cvt_pk_bf16_f32 v251, v254, v255
    v_mfma_f32_16x16x32_bf16 v[204:207], v[60:63], v[32:35], 0
    s_mov_b32 s32, s35
    ds_read_b128 a[204:207], v4 offset:8192
    ds_read_b128 a[208:211], v1 offset:12288
    ds_read_b128 a[212:215], v2 offset:12288
    v_exp_f32 v42, v42
    v_mfma_f32_16x16x32_bf16 v[208:211], a[240:243], v[32:35], 0
    ds_write_b64 v20, v[248:249] offset:192
    ds_write_b64 v20, v[250:251] offset:224
    v_add_f32 v26, v26, v42
    v_mfma_f32_16x16x32_bf16 a[80:83], v[248:251], v[248:251], a[80:83]
    v_mfma_f32_16x16x32_bf16 v[212:215], a[244:247], v[32:35], 0
    ds_read_b128 a[84:87], v19 offset:1088
    ds_read_b128 a[88:91], v19 offset:2176
    ds_read_b128 a[92:95], v19 offset:3264
    v_exp_f32 v43, v43
    s_nop 2
    v_accvgpr_read_b32 v29, a80
    v_sub_f32 v29, v29, v29
    v_accvgpr_read_b32 v31, a81
    v_fma_f32 v29, v31, 0, v29
    v_accvgpr_read_b32 v31, a82
    v_fma_f32 v29, v31, 0, v29
    v_accvgpr_read_b32 v31, a83
    v_mfma_f32_16x16x32_bf16 v[216:219], a[248:251], v[32:35], 0
    ds_read_b128 a[216:219], v3 offset:12288
    v_cvt_pk_bf16_f32 v41, v42, v43
    v_add_f32 v26, v26, v43
    v_fma_f32 v29, v31, 0, v29
    v_cmp_u_f32 vcc, v29, v29
    v_mfma_f32_16x16x32_bf16 v[220:223], a[252:255], v[32:35], 0
    s_waitcnt lgkmcnt(8)
    ds_read_b128 a[220:223], v4 offset:12288
    s_or_b64 s[42:43], s[42:43], vcc
    ds_read_b128 a[80:83], v19 offset:0
    v_exp_f32 v44, v44
    v_mfma_f32_16x16x32_bf16 v[32:35], a[192:195], a[96:99], 0
    ds_read_b64_tr_b16 a[224:225], v5 offset:8192
    v_add_f32 v26, v26, v44
    v_mfma_f32_16x16x32_bf16 v[32:35], a[196:199], a[100:103], v[32:35]
    v_exp_f32 v45, v45
    v_mfma_f32_16x16x32_bf16 v[32:35], a[200:203], a[104:107], v[32:35]
    v_cvt_pk_bf16_f32 v42, v44, v45
    v_add_f32 v26, v26, v45
    v_mfma_f32_16x16x32_bf16 v[32:35], a[204:207], a[108:111], v[32:35]
    s_waitcnt lgkmcnt(2)
    v_exp_f32 v46, v46
    v_mfma_f32_16x16x32_bf16 v[36:39], a[208:211], a[96:99], 0
    ds_read_b64_tr_b16 a[226:227], v5 offset:12288
    v_add_f32 v26, v26, v46
    v_mfma_f32_16x16x32_bf16 v[36:39], a[212:215], a[100:103], v[36:39]
    v_exp_f32 v47, v47
    v_mfma_f32_16x16x32_bf16 v[36:39], a[216:219], a[104:107], v[36:39]
    v_cvt_pk_bf16_f32 v43, v46, v47
    v_add_f32 v26, v26, v47
    v_mfma_f32_16x16x32_bf16 v[36:39], a[220:223], a[108:111], v[36:39]
    v_exp_f32 v32, v32
    v_mfma_f32_16x16x32_bf16 v[224:227], v[48:51], v[40:43], 0
    ds_read_b64_tr_b16 a[228:229], v6 offset:8192
    v_add_f32 v21, v21, v32
    v_mfma_f32_16x16x32_bf16 v[228:231], v[52:55], v[40:43], 0
    v_exp_f32 v33, v33
    v_mfma_f32_16x16x32_bf16 v[232:235], v[56:59], v[40:43], 0
    v_cvt_pk_bf16_f32 v32, v32, v33
    v_add_f32 v21, v21, v33
    v_mfma_f32_16x16x32_bf16 v[236:239], v[60:63], v[40:43], 0
    v_exp_f32 v34, v34
    v_mfma_f32_16x16x32_bf16 v[240:243], a[240:243], v[40:43], 0
    ds_read_b64_tr_b16 a[230:231], v6 offset:12288
    ds_read_b64_tr_b16 a[242:243], v9 offset:12288
    v_add_f32 v21, v21, v34
    v_mfma_f32_16x16x32_bf16 v[244:247], a[244:247], v[40:43], 0
    ds_read_b64_tr_b16 a[244:245], v10 offset:8192
    v_exp_f32 v35, v35
    v_mfma_f32_16x16x32_bf16 v[248:251], a[248:251], v[40:43], 0
    ds_read_b64_tr_b16 a[246:247], v10 offset:12288
    v_cvt_pk_bf16_f32 v33, v34, v35
    v_add_f32 v21, v21, v35
    v_mfma_f32_16x16x32_bf16 v[252:255], a[252:255], v[40:43], 0
    ds_read_b64_tr_b16 a[248:249], v11 offset:8192
    v_exp_f32 v36, v36
    v_mfma_f32_16x16x32_bf16 v[40:43], a[192:195], a[112:115], 0
    ds_read_b64_tr_b16 a[232:233], v7 offset:8192
    ds_read_b64_tr_b16 a[250:251], v11 offset:12288
    v_add_f32 v21, v21, v36
    v_mfma_f32_16x16x32_bf16 v[40:43], a[196:199], a[116:119], v[40:43]
    ds_read_b64_tr_b16 a[252:253], v12 offset:8192
    v_exp_f32 v37, v37
    v_mfma_f32_16x16x32_bf16 v[40:43], a[200:203], a[120:123], v[40:43]
    ds_read_b64_tr_b16 a[254:255], v12 offset:12288
    v_cvt_pk_bf16_f32 v34, v36, v37
    v_add_f32 v21, v21, v37
    v_mfma_f32_16x16x32_bf16 v[40:43], a[204:207], a[124:127], v[40:43]
    v_exp_f32 v38, v38
    v_mfma_f32_16x16x32_bf16 v[44:47], a[208:211], a[112:115], 0
    ds_read_b64_tr_b16 a[240:241], v9 offset:8192
    v_add_f32 v21, v21, v38
    v_mfma_f32_16x16x32_bf16 v[44:47], a[212:215], a[116:119], v[44:47]
    v_exp_f32 v39, v39
    v_mfma_f32_16x16x32_bf16 v[44:47], a[216:219], a[120:123], v[44:47]
    v_cvt_pk_bf16_f32 v35, v38, v39
    v_add_f32 v21, v21, v39
    v_mfma_f32_16x16x32_bf16 v[44:47], a[220:223], a[124:127], v[44:47]
    s_waitcnt lgkmcnt(4)
    v_exp_f32 v40, v40
    v_mfma_f32_16x16x32_bf16 v[64:67], a[224:227], v[32:35], v[64:67]
    v_add_f32 v22, v22, v40
    v_add_u32 v1, s33, v1
    v_mfma_f32_16x16x32_bf16 v[68:71], a[228:231], v[32:35], v[68:71]
    v_exp_f32 v41, v41
    v_mfma_f32_16x16x32_bf16 v[72:75], a[232:235], v[32:35], v[72:75]
    v_cvt_pk_bf16_f32 v40, v40, v41
    v_add_f32 v22, v22, v41
    v_mfma_f32_16x16x32_bf16 v[76:79], a[236:239], v[32:35], v[76:79]
    s_waitcnt lgkmcnt(0)
    v_exp_f32 v42, v42
    v_mfma_f32_16x16x32_bf16 v[80:83], a[240:243], v[32:35], v[80:83]
    v_add_f32 v22, v22, v42
    v_add_u32 v2, s33, v2
    v_mfma_f32_16x16x32_bf16 v[84:87], a[244:247], v[32:35], v[84:87]
    v_exp_f32 v43, v43
    v_mfma_f32_16x16x32_bf16 v[88:91], a[248:251], v[32:35], v[88:91]
    v_cvt_pk_bf16_f32 v41, v42, v43
    v_add_f32 v22, v22, v43
    v_mfma_f32_16x16x32_bf16 v[92:95], a[252:255], v[32:35], v[92:95]
    v_exp_f32 v44, v44
    v_mfma_f32_16x16x32_bf16 v[32:35], a[192:195], a[128:131], 0
    v_add_f32 v22, v22, v44
    v_add_u32 v3, s33, v3
    v_mfma_f32_16x16x32_bf16 v[32:35], a[196:199], a[132:135], v[32:35]
    v_exp_f32 v45, v45
    v_mfma_f32_16x16x32_bf16 v[32:35], a[200:203], a[136:139], v[32:35]
    v_cvt_pk_bf16_f32 v42, v44, v45
    v_add_f32 v22, v22, v45
    v_mfma_f32_16x16x32_bf16 v[32:35], a[204:207], a[140:143], v[32:35]
    v_exp_f32 v46, v46
    v_mfma_f32_16x16x32_bf16 v[36:39], a[208:211], a[128:131], 0
    v_add_f32 v22, v22, v46
    v_add_u32 v4, s33, v4
    v_mfma_f32_16x16x32_bf16 v[36:39], a[212:215], a[132:135], v[36:39]
    v_exp_f32 v47, v47
    v_mfma_f32_16x16x32_bf16 v[36:39], a[216:219], a[136:139], v[36:39]
    v_cvt_pk_bf16_f32 v43, v46, v47
    v_add_f32 v22, v22, v47
    v_mfma_f32_16x16x32_bf16 v[36:39], a[220:223], a[140:143], v[36:39]
    v_exp_f32 v32, v32
    v_mfma_f32_16x16x32_bf16 v[96:99], a[224:227], v[40:43], v[96:99]
    v_add_f32 v23, v23, v32
    v_add_u32 v5, s33, v5
    v_mfma_f32_16x16x32_bf16 v[100:103], a[228:231], v[40:43], v[100:103]
    v_exp_f32 v33, v33
    v_mfma_f32_16x16x32_bf16 v[104:107], a[232:235], v[40:43], v[104:107]
    v_cvt_pk_bf16_f32 v32, v32, v33
    v_add_f32 v23, v23, v33
    v_mfma_f32_16x16x32_bf16 v[108:111], a[236:239], v[40:43], v[108:111]
    v_exp_f32 v34, v34
    v_mfma_f32_16x16x32_bf16 v[112:115], a[240:243], v[40:43], v[112:115]
    v_add_f32 v23, v23, v34
    v_add_u32 v6, s33, v6
    v_mfma_f32_16x16x32_bf16 v[116:119], a[244:247], v[40:43], v[116:119]
    v_exp_f32 v35, v35
    v_mfma_f32_16x16x32_bf16 v[120:123], a[248:251], v[40:43], v[120:123]
    v_cvt_pk_bf16_f32 v33, v34, v35
    v_add_f32 v23, v23, v35
    v_mfma_f32_16x16x32_bf16 v[124:127], a[252:255], v[40:43], v[124:127]
    v_exp_f32 v36, v36
    v_mfma_f32_16x16x32_bf16 v[40:43], a[192:195], a[144:147], 0
    v_add_f32 v23, v23, v36
    v_add_u32 v7, s33, v7
    v_mfma_f32_16x16x32_bf16 v[40:43], a[196:199], a[148:151], v[40:43]
    v_exp_f32 v37, v37
    v_mfma_f32_16x16x32_bf16 v[40:43], a[200:203], a[152:155], v[40:43]
    v_cvt_pk_bf16_f32 v34, v36, v37
    v_add_f32 v23, v23, v37
    v_mfma_f32_16x16x32_bf16 v[40:43], a[204:207], a[156:159], v[40:43]
    v_exp_f32 v38, v38
    v_mfma_f32_16x16x32_bf16 v[44:47], a[208:211], a[144:147], 0
    v_add_f32 v23, v23, v38
    v_add_u32 v9, s33, v9
    v_mfma_f32_16x16x32_bf16 v[44:47], a[212:215], a[148:151], v[44:47]
    v_exp_f32 v39, v39
    v_mfma_f32_16x16x32_bf16 v[44:47], a[216:219], a[152:155], v[44:47]
    v_cvt_pk_bf16_f32 v35, v38, v39
    v_add_f32 v23, v23, v39
    v_mfma_f32_16x16x32_bf16 v[44:47], a[220:223], a[156:159], v[44:47]
    v_exp_f32 v40, v40
    v_mfma_f32_16x16x32_bf16 v[128:131], a[224:227], v[32:35], v[128:131]
    v_add_f32 v24, v24, v40
    v_add_u32 v10, s33, v10
    v_mfma_f32_16x16x32_bf16 v[132:135], a[228:231], v[32:35], v[132:135]
    v_exp_f32 v41, v41
    v_mfma_f32_16x16x32_bf16 v[136:139], a[232:235], v[32:35], v[136:139]
    v_cvt_pk_bf16_f32 v40, v40, v41
    v_add_f32 v24, v24, v41
    v_mfma_f32_16x16x32_bf16 v[140:143], a[236:239], v[32:35], v[140:143]
    v_exp_f32 v42, v42
    v_mfma_f32_16x16x32_bf16 v[144:147], a[240:243], v[32:35], v[144:147]
    v_add_f32 v24, v24, v42
    v_add_u32 v11, s33, v11
    v_mfma_f32_16x16x32_bf16 v[148:151], a[244:247], v[32:35], v[148:151]
    v_exp_f32 v43, v43
    v_mfma_f32_16x16x32_bf16 v[152:155], a[248:251], v[32:35], v[152:155]
    v_cvt_pk_bf16_f32 v41, v42, v43
    v_add_f32 v24, v24, v43
    v_mfma_f32_16x16x32_bf16 v[156:159], a[252:255], v[32:35], v[156:159]
    v_exp_f32 v44, v44
    v_mfma_f32_16x16x32_bf16 v[32:35], a[192:195], a[160:163], 0
    v_add_f32 v24, v24, v44
    v_add_u32 v12, s33, v12
    v_mfma_f32_16x16x32_bf16 v[32:35], a[196:199], a[164:167], v[32:35]
    v_exp_f32 v45, v45
    v_mfma_f32_16x16x32_bf16 v[32:35], a[200:203], a[168:171], v[32:35]
    v_cvt_pk_bf16_f32 v42, v44, v45
    v_add_f32 v24, v24, v45
    v_mfma_f32_16x16x32_bf16 v[32:35], a[204:207], a[172:175], v[32:35]
    v_exp_f32 v46, v46
    v_mfma_f32_16x16x32_bf16 v[36:39], a[208:211], a[160:163], 0
    v_add_f32 v24, v24, v46
    v_mfma_f32_16x16x32_bf16 v[36:39], a[212:215], a[164:167], v[36:39]
    v_exp_f32 v47, v47
    v_mfma_f32_16x16x32_bf16 v[36:39], a[216:219], a[168:171], v[36:39]
    v_cvt_pk_bf16_f32 v43, v46, v47
    v_add_f32 v24, v24, v47
    v_mfma_f32_16x16x32_bf16 v[36:39], a[220:223], a[172:175], v[36:39]
    v_exp_f32 v32, v32
    s_mov_b32 s34, 14
    s_mov_b32 s51, 0x2aaa
    s_mov_b32 s80, 0
    v_mfma_f32_16x16x32_bf16 v[160:163], a[224:227], v[40:43], v[160:163]
L_loop1:
    v_add_f32 v25, v25, v32
    v_mfma_f32_16x16x32_bf16 v[164:167], a[228:231], v[40:43], v[164:167]
    v_exp_f32 v33, v33
    v_mfma_f32_16x16x32_bf16 v[168:171], a[232:235], v[40:43], v[168:171]
    v_cvt_pk_bf16_f32 v32, v32, v33
    v_add_f32 v25, v25, v33
    v_mfma_f32_16x16x32_bf16 v[172:175], a[236:239], v[40:43], v[172:175]
    v_exp_f32 v34, v34
    v_mfma_f32_16x16x32_bf16 v[176:179], a[240:243], v[40:43], v[176:179]
    v_add_f32 v25, v25, v34
    v_mfma_f32_16x16x32_bf16 v[180:183], a[244:247], v[40:43], v[180:183]
    s_waitcnt vmcnt(16) lgkmcnt(0)
    s_barrier
    s_bitcmp1_b32 s51, s34
    s_cbranch_scc1 L_hookd1
L_hookret1:
    v_exp_f32 v35, v35
    v_mfma_f32_16x16x32_bf16 v[184:187], a[248:251], v[40:43], v[184:187]
    ds_read_b64_tr_b16 v[58:59], v7 offset:4096
    v_cvt_pk_bf16_f32 v33, v34, v35
    v_add_f32 v25, v25, v35
    v_mfma_f32_16x16x32_bf16 v[188:191], a[252:255], v[40:43], v[188:191]
    ds_read_b64_tr_b16 v[60:61], v8 offset:0
    v_exp_f32 v36, v36
    v_mfma_f32_16x16x32_bf16 v[40:43], a[192:195], a[176:179], 0
    ds_read_b128 a[192:195], v1 offset:0
    ds_read_b64_tr_b16 v[62:63], v8 offset:4096
    v_add_f32 v25, v25, v36
    v_mfma_f32_16x16x32_bf16 v[40:43], a[196:199], a[180:183], v[40:43]
    v_exp_f32 v37, v37
    v_mfma_f32_16x16x32_bf16 v[40:43], a[200:203], a[184:187], v[40:43]
    v_cvt_pk_bf16_f32 v34, v36, v37
    v_add_f32 v25, v25, v37
    v_mfma_f32_16x16x32_bf16 v[40:43], a[204:207], a[188:191], v[40:43]
    ds_read_b128 a[204:207], v4 offset:0
    v_exp_f32 v38, v38
    v_mfma_f32_16x16x32_bf16 v[44:47], a[208:211], a[176:179], 0
    ds_read_b128 a[196:199], v2 offset:0
    v_add_f32 v25, v25, v38
    v_mfma_f32_16x16x32_bf16 v[44:47], a[212:215], a[180:183], v[44:47]
    ds_read_b128 a[212:215], v2 offset:4096
    v_exp_f32 v39, v39
    v_mfma_f32_16x16x32_bf16 v[44:47], a[216:219], a[184:187], v[44:47]
    ds_read_b128 a[216:219], v3 offset:4096
    v_cvt_pk_bf16_f32 v35, v38, v39
    v_add_f32 v25, v25, v39
    v_mfma_f32_16x16x32_bf16 v[44:47], a[220:223], a[188:191], v[44:47]
    ds_read_b128 a[220:223], v4 offset:4096
    v_exp_f32 v40, v40
    v_mfma_f32_16x16x32_bf16 v[192:195], a[224:227], v[32:35], v[192:195]
    ds_read_b128 a[200:203], v3 offset:0
    v_add_f32 v26, v26, v40
    v_mfma_f32_16x16x32_bf16 v[196:199], a[228:231], v[32:35], v[196:199]
    v_exp_f32 v41, v41
    v_mfma_f32_16x16x32_bf16 v[200:203], a[232:235], v[32:35], v[200:203]
    v_cvt_pk_bf16_f32 v40, v40, v41
    v_add_f32 v26, v26, v41
    v_mfma_f32_16x16x32_bf16 v[204:207], a[236:239], v[32:35], v[204:207]
    v_exp_f32 v42, v42
    v_mfma_f32_16x16x32_bf16 v[208:211], a[240:243], v[32:35], v[208:211]
    ds_read_b128 a[208:211], v1 offset:4096
    v_add_f32 v26, v26, v42
    v_mfma_f32_16x16x32_bf16 v[212:215], a[244:247], v[32:35], v[212:215]
    v_exp_f32 v43, v43
    v_mfma_f32_16x16x32_bf16 v[216:219], a[248:251], v[32:35], v[216:219]
    v_cvt_pk_bf16_f32 v41, v42, v43
    v_add_f32 v26, v26, v43
    v_mfma_f32_16x16x32_bf16 v[220:223], a[252:255], v[32:35], v[220:223]
    s_waitcnt lgkmcnt(1)
    v_exp_f32 v44, v44
    v_mfma_f32_16x16x32_bf16 v[32:35], a[192:195], a[96:99], 0
    ds_read_b64_tr_b16 v[48:49], v5 offset:0
    v_add_f32 v26, v26, v44
    v_mfma_f32_16x16x32_bf16 v[32:35], a[196:199], a[100:103], v[32:35]
    v_exp_f32 v45, v45
    v_mfma_f32_16x16x32_bf16 v[32:35], a[200:203], a[104:107], v[32:35]
    v_cvt_pk_bf16_f32 v42, v44, v45
    v_add_f32 v26, v26, v45
    v_mfma_f32_16x16x32_bf16 v[32:35], a[204:207], a[108:111], v[32:35]
    s_waitcnt lgkmcnt(1)
    v_exp_f32 v46, v46
    v_mfma_f32_16x16x32_bf16 v[36:39], a[208:211], a[96:99], 0
    ds_read_b64_tr_b16 v[50:51], v5 offset:4096
    v_add_f32 v26, v26, v46
    v_mfma_f32_16x16x32_bf16 v[36:39], a[212:215], a[100:103], v[36:39]
    v_exp_f32 v47, v47
    v_mfma_f32_16x16x32_bf16 v[36:39], a[216:219], a[104:107], v[36:39]
    v_cvt_pk_bf16_f32 v43, v46, v47
    v_add_f32 v26, v26, v47
    v_mfma_f32_16x16x32_bf16 v[36:39], a[220:223], a[108:111], v[36:39]
    v_exp_f32 v32, v32
    v_mfma_f32_16x16x32_bf16 v[224:227], a[224:227], v[40:43], v[224:227]
    ds_read_b64_tr_b16 v[52:53], v6 offset:0
    v_add_f32 v21, v21, v32
    v_mfma_f32_16x16x32_bf16 v[228:231], a[228:231], v[40:43], v[228:231]
    v_exp_f32 v33, v33
    v_mfma_f32_16x16x32_bf16 v[232:235], a[232:235], v[40:43], v[232:235]
    v_cvt_pk_bf16_f32 v32, v32, v33
    v_add_f32 v21, v21, v33
    v_mfma_f32_16x16x32_bf16 v[236:239], a[236:239], v[40:43], v[236:239]
    v_exp_f32 v34, v34
    v_mfma_f32_16x16x32_bf16 v[240:243], a[240:243], v[40:43], v[240:243]
    ds_read_b64_tr_b16 v[54:55], v6 offset:4096
    ds_read_b64_tr_b16 a[242:243], v9 offset:4096
    v_add_f32 v21, v21, v34
    v_mfma_f32_16x16x32_bf16 v[244:247], a[244:247], v[40:43], v[244:247]
    ds_read_b64_tr_b16 a[244:245], v10 offset:0
    v_exp_f32 v35, v35
    v_mfma_f32_16x16x32_bf16 v[248:251], a[248:251], v[40:43], v[248:251]
    ds_read_b64_tr_b16 a[246:247], v10 offset:4096
    v_cvt_pk_bf16_f32 v33, v34, v35
    v_add_f32 v21, v21, v35
    v_mfma_f32_16x16x32_bf16 v[252:255], a[252:255], v[40:43], v[252:255]
    ds_read_b64_tr_b16 a[248:249], v11 offset:0
    v_exp_f32 v36, v36
    v_mfma_f32_16x16x32_bf16 v[40:43], a[192:195], a[112:115], 0
    ds_read_b64_tr_b16 v[56:57], v7 offset:0
    ds_read_b64_tr_b16 a[250:251], v11 offset:4096
    v_add_f32 v21, v21, v36
    v_mfma_f32_16x16x32_bf16 v[40:43], a[196:199], a[116:119], v[40:43]
    ds_read_b64_tr_b16 a[252:253], v12 offset:0
    v_exp_f32 v37, v37
    v_mfma_f32_16x16x32_bf16 v[40:43], a[200:203], a[120:123], v[40:43]
    ds_read_b64_tr_b16 a[254:255], v12 offset:4096
    v_cvt_pk_bf16_f32 v34, v36, v37
    v_add_f32 v21, v21, v37
    v_mfma_f32_16x16x32_bf16 v[40:43], a[204:207], a[124:127], v[40:43]
    v_exp_f32 v38, v38
    v_mfma_f32_16x16x32_bf16 v[44:47], a[208:211], a[112:115], 0
    ds_read_b64_tr_b16 a[240:241], v9 offset:0
    v_add_f32 v21, v21, v38
    v_mfma_f32_16x16x32_bf16 v[44:47], a[212:215], a[116:119], v[44:47]
    v_exp_f32 v39, v39
    v_mfma_f32_16x16x32_bf16 v[44:47], a[216:219], a[120:123], v[44:47]
    v_cvt_pk_bf16_f32 v35, v38, v39
    v_add_f32 v21, v21, v39
    v_mfma_f32_16x16x32_bf16 v[44:47], a[220:223], a[124:127], v[44:47]
    s_waitcnt lgkmcnt(4)
    v_exp_f32 v40, v40
    v_mfma_f32_16x16x32_bf16 v[64:67], v[48:51], v[32:35], v[64:67]
    ds_read_b64_tr_b16 a[224:225], v5 offset:8192
    v_add_f32 v22, v22, v40
    v_mfma_f32_16x16x32_bf16 v[68:71], v[52:55], v[32:35], v[68:71]
    s_add_u32 s35, s32, 0x4000
    v_exp_f32 v41, v41
    v_mfma_f32_16x16x32_bf16 v[72:75], v[56:59], v[32:35], v[72:75]
    s_and_b32 s35, s35, 0xffff
    v_cvt_pk_bf16_f32 v40, v40, v41
    v_add_f32 v22, v22, v41
    v_mfma_f32_16x16x32_bf16 v[76:79], v[60:63], v[32:35], v[76:79]
    s_waitcnt lgkmcnt(1)
    s_sub_u32 s33, s35, s32
    v_exp_f32 v42, v42
    v_mfma_f32_16x16x32_bf16 v[80:83], a[240:243], v[32:35], v[80:83]
    ds_read_b64_tr_b16 a[226:227], v5 offset:12288
    v_add_f32 v22, v22, v42
    v_add_u32 v5, s33, v5
    v_mfma_f32_16x16x32_bf16 v[84:87], a[244:247], v[32:35], v[84:87]
    v_exp_f32 v43, v43
    v_mfma_f32_16x16x32_bf16 v[88:91], a[248:251], v[32:35], v[88:91]
    v_cvt_pk_bf16_f32 v41, v42, v43
    v_add_f32 v22, v22, v43
    v_mfma_f32_16x16x32_bf16 v[92:95], a[252:255], v[32:35], v[92:95]
    v_exp_f32 v44, v44
    v_mfma_f32_16x16x32_bf16 v[32:35], a[192:195], a[128:131], 0
    ds_read_b64_tr_b16 a[228:229], v6 offset:8192
    v_add_f32 v22, v22, v44
    v_mfma_f32_16x16x32_bf16 v[32:35], a[196:199], a[132:135], v[32:35]
    v_exp_f32 v45, v45
    v_mfma_f32_16x16x32_bf16 v[32:35], a[200:203], a[136:139], v[32:35]
    v_cvt_pk_bf16_f32 v42, v44, v45
    v_add_f32 v22, v22, v45
    v_mfma_f32_16x16x32_bf16 v[32:35], a[204:207], a[140:143], v[32:35]
    v_exp_f32 v46, v46
    v_mfma_f32_16x16x32_bf16 v[36:39], a[208:211], a[128:131], 0
    ds_read_b64_tr_b16 a[230:231], v6 offset:12288
    v_add_f32 v22, v22, v46
    v_add_u32 v6, s33, v6
    v_mfma_f32_16x16x32_bf16 v[36:39], a[212:215], a[132:135], v[36:39]
    v_exp_f32 v47, v47
    v_mfma_f32_16x16x32_bf16 v[36:39], a[216:219], a[136:139], v[36:39]
    v_cvt_pk_bf16_f32 v43, v46, v47
    v_add_f32 v22, v22, v47
    v_mfma_f32_16x16x32_bf16 v[36:39], a[220:223], a[140:143], v[36:39]
    s_mov_b32 m0, s31
    v_exp_f32 v32, v32
    v_mfma_f32_16x16x32_bf16 v[96:99], v[48:51], v[40:43], v[96:99]
    buffer_load_dwordx4 v13, s[8:11], s30 offen offset:0 nt lds
    v_add_f32 v23, v23, v32
    v_mfma_f32_16x16x32_bf16 v[100:103], v[52:55], v[40:43], v[100:103]
    v_exp_f32 v33, v33
    v_mfma_f32_16x16x32_bf16 v[104:107], v[56:59], v[40:43], v[104:107]
    v_cvt_pk_bf16_f32 v32, v32, v33
    v_add_f32 v23, v23, v33
    v_mfma_f32_16x16x32_bf16 v[108:111], v[60:63], v[40:43], v[108:111]
    v_exp_f32 v34, v34
    v_mfma_f32_16x16x32_bf16 v[112:115], a[240:243], v[40:43], v[112:115]
    buffer_load_dwordx4 v14, s[8:11], s30 offen offset:1024 nt lds
    v_add_f32 v23, v23, v34
    v_mfma_f32_16x16x32_bf16 v[116:119], a[244:247], v[40:43], v[116:119]
    v_exp_f32 v35, v35
    v_mfma_f32_16x16x32_bf16 v[120:123], a[248:251], v[40:43], v[120:123]
    v_cvt_pk_bf16_f32 v33, v34, v35
    v_add_f32 v23, v23, v35
    v_mfma_f32_16x16x32_bf16 v[124:127], a[252:255], v[40:43], v[124:127]
    v_exp_f32 v36, v36
    v_mfma_f32_16x16x32_bf16 v[40:43], a[192:195], a[144:147], 0
    buffer_load_dwordx4 v15, s[8:11], s30 offen offset:2048 nt lds
    v_add_f32 v23, v23, v36
    v_mfma_f32_16x16x32_bf16 v[40:43], a[196:199], a[148:151], v[40:43]
    v_exp_f32 v37, v37
    v_mfma_f32_16x16x32_bf16 v[40:43], a[200:203], a[152:155], v[40:43]
    v_cvt_pk_bf16_f32 v34, v36, v37
    v_add_f32 v23, v23, v37
    v_mfma_f32_16x16x32_bf16 v[40:43], a[204:207], a[156:159], v[40:43]
    v_exp_f32 v38, v38
    v_mfma_f32_16x16x32_bf16 v[44:47], a[208:211], a[144:147], 0
    buffer_load_dwordx4 v16, s[8:11], s30 offen offset:3072 nt lds
    v_add_f32 v23, v23, v38
    v_mfma_f32_16x16x32_bf16 v[44:47], a[212:215], a[148:151], v[44:47]
    v_exp_f32 v39, v39
    v_mfma_f32_16x16x32_bf16 v[44:47], a[216:219], a[152:155], v[44:47]
    v_cvt_pk_bf16_f32 v35, v38, v39
    v_add_f32 v23, v23, v39
    v_mfma_f32_16x16x32_bf16 v[44:47], a[220:223], a[156:159], v[44:47]
    s_add_u32 m0, s31, 65536
    v_exp_f32 v40, v40
    v_mfma_f32_16x16x32_bf16 v[128:131], v[48:51], v[32:35], v[128:131]
    buffer_load_dwordx4 v17, s[12:15], s30 offen offset:0 nt lds
    v_add_f32 v24, v24, v40
    v_mfma_f32_16x16x32_bf16 v[132:135], v[52:55], v[32:35], v[132:135]
    v_exp_f32 v41, v41
    v_mfma_f32_16x16x32_bf16 v[136:139], v[56:59], v[32:35], v[136:139]
    v_cvt_pk_bf16_f32 v40, v40, v41
    v_add_f32 v24, v24, v41
    v_mfma_f32_16x16x32_bf16 v[140:143], v[60:63], v[32:35], v[140:143]
    v_exp_f32 v42, v42
    v_mfma_f32_16x16x32_bf16 v[144:147], a[240:243], v[32:35], v[144:147]
    buffer_load_dwordx4 v18, s[12:15], s30 offen offset:1024 nt lds
    v_add_f32 v24, v24, v42
    v_mfma_f32_16x16x32_bf16 v[148:151], a[244:247], v[32:35], v[148:151]
    v_exp_f32 v43, v43
    v_mfma_f32_16x16x32_bf16 v[152:155], a[248:251], v[32:35], v[152:155]
    v_cvt_pk_bf16_f32 v41, v42, v43
    v_add_f32 v24, v24, v43
    v_mfma_f32_16x16x32_bf16 v[156:159], a[252:255], v[32:35], v[156:159]
    v_exp_f32 v44, v44
    v_mfma_f32_16x16x32_bf16 v[32:35], a[192:195], a[160:163], 0
    buffer_load_dwordx4 v17, s[12:15], s30 offen offset:2048 nt lds
    v_add_f32 v24, v24, v44
    v_mfma_f32_16x16x32_bf16 v[32:35], a[196:199], a[164:167], v[32:35]
    v_exp_f32 v45, v45
    v_mfma_f32_16x16x32_bf16 v[32:35], a[200:203], a[168:171], v[32:35]
    v_cvt_pk_bf16_f32 v42, v44, v45
    v_add_f32 v24, v24, v45
    v_mfma_f32_16x16x32_bf16 v[32:35], a[204:207], a[172:175], v[32:35]
    v_exp_f32 v46, v46
    v_mfma_f32_16x16x32_bf16 v[36:39], a[208:211], a[160:163], 0
    buffer_load_dwordx4 v18, s[12:15], s30 offen offset:3072 nt lds
    v_add_f32 v24, v24, v46
    v_mfma_f32_16x16x32_bf16 v[36:39], a[212:215], a[164:167], v[36:39]
    s_add_u32 s31, s31, 0x4000
    v_exp_f32 v47, v47
    v_mfma_f32_16x16x32_bf16 v[36:39], a[216:219], a[168:171], v[36:39]
    s_and_b32 s31, s31, 0xffff
    v_cvt_pk_bf16_f32 v43, v46, v47
    v_add_f32 v24, v24, v47
    v_mfma_f32_16x16x32_bf16 v[36:39], a[220:223], a[172:175], v[36:39]
    s_add_u32 s30, s30, 0x4000
    v_exp_f32 v32, v32
    v_mfma_f32_16x16x32_bf16 v[160:163], v[48:51], v[40:43], v[160:163]
    ds_read_b64_tr_b16 a[232:233], v7 offset:8192
    v_add_f32 v25, v25, v32
    v_mfma_f32_16x16x32_bf16 v[164:167], v[52:55], v[40:43], v[164:167]
    v_exp_f32 v33, v33
    v_mfma_f32_16x16x32_bf16 v[168:171], v[56:59], v[40:43], v[168:171]
    v_cvt_pk_bf16_f32 v32, v32, v33
    v_add_f32 v25, v25, v33
    v_mfma_f32_16x16x32_bf16 v[172:175], v[60:63], v[40:43], v[172:175]
    v_exp_f32 v34, v34
    v_mfma_f32_16x16x32_bf16 v[176:179], a[240:243], v[40:43], v[176:179]
    ds_read_b64_tr_b16 a[234:235], v7 offset:12288
    v_add_f32 v25, v25, v34
    v_add_u32 v7, s33, v7
    v_mfma_f32_16x16x32_bf16 v[180:183], a[244:247], v[40:43], v[180:183]
    v_exp_f32 v35, v35
    v_mfma_f32_16x16x32_bf16 v[184:187], a[248:251], v[40:43], v[184:187]
    v_cvt_pk_bf16_f32 v33, v34, v35
    v_add_f32 v25, v25, v35
    v_mfma_f32_16x16x32_bf16 v[188:191], a[252:255], v[40:43], v[188:191]
    v_exp_f32 v36, v36
    v_mfma_f32_16x16x32_bf16 v[40:43], a[192:195], a[176:179], 0
    ds_read_b128 a[192:195], v1 offset:8192
    v_add_f32 v25, v25, v36
    v_mfma_f32_16x16x32_bf16 v[40:43], a[196:199], a[180:183], v[40:43]
    v_exp_f32 v37, v37
    v_mfma_f32_16x16x32_bf16 v[40:43], a[200:203], a[184:187], v[40:43]
    v_cvt_pk_bf16_f32 v34, v36, v37
    v_add_f32 v25, v25, v37
    v_mfma_f32_16x16x32_bf16 v[40:43], a[204:207], a[188:191], v[40:43]
    ds_read_b128 a[204:207], v4 offset:8192
    v_exp_f32 v38, v38
    v_mfma_f32_16x16x32_bf16 v[44:47], a[208:211], a[176:179], 0
    ds_read_b128 a[196:199], v2 offset:8192
    v_add_f32 v25, v25, v38
    v_mfma_f32_16x16x32_bf16 v[44:47], a[212:215], a[180:183], v[44:47]
    s_mov_b32 s32, s35
    ds_read_b128 a[212:215], v2 offset:12288
    v_exp_f32 v39, v39
    v_mfma_f32_16x16x32_bf16 v[44:47], a[216:219], a[184:187], v[44:47]
    ds_read_b128 a[216:219], v3 offset:12288
    v_cvt_pk_bf16_f32 v35, v38, v39
    v_add_f32 v25, v25, v39
    v_mfma_f32_16x16x32_bf16 v[44:47], a[220:223], a[188:191], v[44:47]
    ds_read_b128 a[220:223], v4 offset:12288
    v_exp_f32 v40, v40
    v_mfma_f32_16x16x32_bf16 v[192:195], v[48:51], v[32:35], v[192:195]
    ds_read_b128 a[200:203], v3 offset:8192
    v_add_f32 v26, v26, v40
    v_mfma_f32_16x16x32_bf16 v[196:199], v[52:55], v[32:35], v[196:199]
    v_exp_f32 v41, v41
    v_mfma_f32_16x16x32_bf16 v[200:203], v[56:59], v[32:35], v[200:203]
    v_cvt_pk_bf16_f32 v40, v40, v41
    v_add_f32 v26, v26, v41
    v_mfma_f32_16x16x32_bf16 v[204:207], v[60:63], v[32:35], v[204:207]
    v_exp_f32 v42, v42
    v_mfma_f32_16x16x32_bf16 v[208:211], a[240:243], v[32:35], v[208:211]
    ds_read_b128 a[208:211], v1 offset:12288
    v_add_f32 v26, v26, v42
    v_mfma_f32_16x16x32_bf16 v[212:215], a[244:247], v[32:35], v[212:215]
    v_exp_f32 v43, v43
    v_mfma_f32_16x16x32_bf16 v[216:219], a[248:251], v[32:35], v[216:219]
    v_cvt_pk_bf16_f32 v41, v42, v43
    v_add_f32 v26, v26, v43
    v_mfma_f32_16x16x32_bf16 v[220:223], a[252:255], v[32:35], v[220:223]
    s_waitcnt lgkmcnt(1)
    v_exp_f32 v44, v44
    v_mfma_f32_16x16x32_bf16 v[32:35], a[192:195], a[96:99], 0
    ds_read_b64_tr_b16 a[236:237], v8 offset:8192
    v_add_f32 v26, v26, v44
    v_mfma_f32_16x16x32_bf16 v[32:35], a[196:199], a[100:103], v[32:35]
    v_exp_f32 v45, v45
    v_mfma_f32_16x16x32_bf16 v[32:35], a[200:203], a[104:107], v[32:35]
    v_cvt_pk_bf16_f32 v42, v44, v45
    v_add_f32 v26, v26, v45
    v_mfma_f32_16x16x32_bf16 v[32:35], a[204:207], a[108:111], v[32:35]
    s_waitcnt lgkmcnt(1)
    v_exp_f32 v46, v46
    v_mfma_f32_16x16x32_bf16 v[36:39], a[208:211], a[96:99], 0
    ds_read_b64_tr_b16 a[238:239], v8 offset:12288
    v_add_f32 v26, v26, v46
    v_mfma_f32_16x16x32_bf16 v[36:39], a[212:215], a[100:103], v[36:39]
    v_exp_f32 v47, v47
    v_mfma_f32_16x16x32_bf16 v[36:39], a[216:219], a[104:107], v[36:39]
    v_cvt_pk_bf16_f32 v43, v46, v47
    v_add_f32 v26, v26, v47
    v_mfma_f32_16x16x32_bf16 v[36:39], a[220:223], a[108:111], v[36:39]
    v_exp_f32 v32, v32
    v_mfma_f32_16x16x32_bf16 v[224:227], v[48:51], v[40:43], v[224:227]
    v_add_f32 v21, v21, v32
    v_add_u32 v1, s33, v1
    v_mfma_f32_16x16x32_bf16 v[228:231], v[52:55], v[40:43], v[228:231]
    v_exp_f32 v33, v33
    v_mfma_f32_16x16x32_bf16 v[232:235], v[56:59], v[40:43], v[232:235]
    v_cvt_pk_bf16_f32 v32, v32, v33
    v_add_f32 v21, v21, v33
    v_mfma_f32_16x16x32_bf16 v[236:239], v[60:63], v[40:43], v[236:239]
    v_exp_f32 v34, v34
    v_mfma_f32_16x16x32_bf16 v[240:243], a[240:243], v[40:43], v[240:243]
    ds_read_b64_tr_b16 a[240:241], v9 offset:8192
    v_add_f32 v21, v21, v34
    v_mfma_f32_16x16x32_bf16 v[244:247], a[244:247], v[40:43], v[244:247]
    ds_read_b64_tr_b16 a[246:247], v10 offset:12288
    v_exp_f32 v35, v35
    v_mfma_f32_16x16x32_bf16 v[248:251], a[248:251], v[40:43], v[248:251]
    ds_read_b64_tr_b16 a[248:249], v11 offset:8192
    v_cvt_pk_bf16_f32 v33, v34, v35
    v_add_f32 v21, v21, v35
    v_mfma_f32_16x16x32_bf16 v[252:255], a[252:255], v[40:43], v[252:255]
    ds_read_b64_tr_b16 a[250:251], v11 offset:12288
    v_exp_f32 v36, v36
    v_mfma_f32_16x16x32_bf16 v[40:43], a[192:195], a[112:115], 0
    ds_read_b64_tr_b16 a[242:243], v9 offset:12288
    ds_read_b64_tr_b16 a[252:253], v12 offset:8192
    v_add_f32 v21, v21, v36
    v_mfma_f32_16x16x32_bf16 v[40:43], a[196:199], a[116:119], v[40:43]
    ds_read_b64_tr_b16 a[254:255], v12 offset:12288
    v_exp_f32 v37, v37
    v_mfma_f32_16x16x32_bf16 v[40:43], a[200:203], a[120:123], v[40:43]
    v_cvt_pk_bf16_f32 v34, v36, v37
    v_add_f32 v21, v21, v37
    v_mfma_f32_16x16x32_bf16 v[40:43], a[204:207], a[124:127], v[40:43]
    v_exp_f32 v38, v38
    v_mfma_f32_16x16x32_bf16 v[44:47], a[208:211], a[112:115], 0
    ds_read_b64_tr_b16 a[244:245], v10 offset:8192
    v_add_f32 v21, v21, v38
    v_mfma_f32_16x16x32_bf16 v[44:47], a[212:215], a[116:119], v[44:47]
    v_exp_f32 v39, v39
    v_mfma_f32_16x16x32_bf16 v[44:47], a[216:219], a[120:123], v[44:47]
    v_cvt_pk_bf16_f32 v35, v38, v39
    v_add_f32 v21, v21, v39
    v_mfma_f32_16x16x32_bf16 v[44:47], a[220:223], a[124:127], v[44:47]
    s_waitcnt lgkmcnt(8)
    v_exp_f32 v40, v40
    v_mfma_f32_16x16x32_bf16 v[64:67], a[224:227], v[32:35], v[64:67]
    v_add_f32 v22, v22, v40
    v_add_u32 v2, s33, v2
    v_mfma_f32_16x16x32_bf16 v[68:71], a[228:231], v[32:35], v[68:71]
    v_exp_f32 v41, v41
    v_mfma_f32_16x16x32_bf16 v[72:75], a[232:235], v[32:35], v[72:75]
    v_cvt_pk_bf16_f32 v40, v40, v41
    v_add_f32 v22, v22, v41
    v_mfma_f32_16x16x32_bf16 v[76:79], a[236:239], v[32:35], v[76:79]
    s_waitcnt lgkmcnt(0)
    v_exp_f32 v42, v42
    v_mfma_f32_16x16x32_bf16 v[80:83], a[240:243], v[32:35], v[80:83]
    v_add_f32 v22, v22, v42
    v_add_u32 v3, s33, v3
    v_mfma_f32_16x16x32_bf16 v[84:87], a[244:247], v[32:35], v[84:87]
    v_exp_f32 v43, v43
    v_mfma_f32_16x16x32_bf16 v[88:91], a[248:251], v[32:35], v[88:91]
    v_cvt_pk_bf16_f32 v41, v42, v43
    v_add_f32 v22, v22, v43
    v_mfma_f32_16x16x32_bf16 v[92:95], a[252:255], v[32:35], v[92:95]
    v_exp_f32 v44, v44
    v_mfma_f32_16x16x32_bf16 v[32:35], a[192:195], a[128:131], 0
    v_add_f32 v22, v22, v44
    v_add_u32 v4, s33, v4
    v_mfma_f32_16x16x32_bf16 v[32:35], a[196:199], a[132:135], v[32:35]
    v_exp_f32 v45, v45
    v_mfma_f32_16x16x32_bf16 v[32:35], a[200:203], a[136:139], v[32:35]
    v_cvt_pk_bf16_f32 v42, v44, v45
    v_add_f32 v22, v22, v45
    v_mfma_f32_16x16x32_bf16 v[32:35], a[204:207], a[140:143], v[32:35]
    v_exp_f32 v46, v46
    v_mfma_f32_16x16x32_bf16 v[36:39], a[208:211], a[128:131], 0
    v_add_f32 v22, v22, v46
    v_add_u32 v8, s33, v8
    v_mfma_f32_16x16x32_bf16 v[36:39], a[212:215], a[132:135], v[36:39]
    v_exp_f32 v47, v47
    v_mfma_f32_16x16x32_bf16 v[36:39], a[216:219], a[136:139], v[36:39]
    v_cvt_pk_bf16_f32 v43, v46, v47
    v_add_f32 v22, v22, v47
    v_mfma_f32_16x16x32_bf16 v[36:39], a[220:223], a[140:143], v[36:39]
    v_exp_f32 v32, v32
    v_mfma_f32_16x16x32_bf16 v[96:99], a[224:227], v[40:43], v[96:99]
    v_add_f32 v23, v23, v32
    v_add_u32 v9, s33, v9
    v_mfma_f32_16x16x32_bf16 v[100:103], a[228:231], v[40:43], v[100:103]
    v_exp_f32 v33, v33
    v_mfma_f32_16x16x32_bf16 v[104:107], a[232:235], v[40:43], v[104:107]
    v_cvt_pk_bf16_f32 v32, v32, v33
    v_add_f32 v23, v23, v33
    v_mfma_f32_16x16x32_bf16 v[108:111], a[236:239], v[40:43], v[108:111]
    v_exp_f32 v34, v34
    v_mfma_f32_16x16x32_bf16 v[112:115], a[240:243], v[40:43], v[112:115]
    v_add_f32 v23, v23, v34
    v_add_u32 v10, s33, v10
    v_mfma_f32_16x16x32_bf16 v[116:119], a[244:247], v[40:43], v[116:119]
    v_exp_f32 v35, v35
    v_mfma_f32_16x16x32_bf16 v[120:123], a[248:251], v[40:43], v[120:123]
    v_cvt_pk_bf16_f32 v33, v34, v35
    v_add_f32 v23, v23, v35
    v_mfma_f32_16x16x32_bf16 v[124:127], a[252:255], v[40:43], v[124:127]
    v_exp_f32 v36, v36
    v_mfma_f32_16x16x32_bf16 v[40:43], a[192:195], a[144:147], 0
    v_add_f32 v23, v23, v36
    v_add_u32 v11, s33, v11
    v_mfma_f32_16x16x32_bf16 v[40:43], a[196:199], a[148:151], v[40:43]
    v_exp_f32 v37, v37
    v_mfma_f32_16x16x32_bf16 v[40:43], a[200:203], a[152:155], v[40:43]
    v_cvt_pk_bf16_f32 v34, v36, v37
    v_add_f32 v23, v23, v37
    v_mfma_f32_16x16x32_bf16 v[40:43], a[204:207], a[156:159], v[40:43]
    v_exp_f32 v38, v38
    v_mfma_f32_16x16x32_bf16 v[44:47], a[208:211], a[144:147], 0
    v_add_f32 v23, v23, v38
    v_add_u32 v12, s33, v12
    v_mfma_f32_16x16x32_bf16 v[44:47], a[212:215], a[148:151], v[44:47]
    v_exp_f32 v39, v39
    v_mfma_f32_16x16x32_bf16 v[44:47], a[216:219], a[152:155], v[44:47]
    v_cvt_pk_bf16_f32 v35, v38, v39
    v_add_f32 v23, v23, v39
    v_mfma_f32_16x16x32_bf16 v[44:47], a[220:223], a[156:159], v[44:47]
    v_exp_f32 v40, v40
    v_mfma_f32_16x16x32_bf16 v[128:131], a[224:227], v[32:35], v[128:131]
    v_add_f32 v24, v24, v40
    v_mfma_f32_16x16x32_bf16 v[132:135], a[228:231], v[32:35], v[132:135]
    v_exp_f32 v41, v41
    v_mfma_f32_16x16x32_bf16 v[136:139], a[232:235], v[32:35], v[136:139]
    v_cvt_pk_bf16_f32 v40, v40, v41
    v_add_f32 v24, v24, v41
    v_mfma_f32_16x16x32_bf16 v[140:143], a[236:239], v[32:35], v[140:143]
    v_exp_f32 v42, v42
    v_mfma_f32_16x16x32_bf16 v[144:147], a[240:243], v[32:35], v[144:147]
    v_add_f32 v24, v24, v42
    v_mfma_f32_16x16x32_bf16 v[148:151], a[244:247], v[32:35], v[148:151]
    v_exp_f32 v43, v43
    v_mfma_f32_16x16x32_bf16 v[152:155], a[248:251], v[32:35], v[152:155]
    v_cvt_pk_bf16_f32 v41, v42, v43
    v_add_f32 v24, v24, v43
    v_mfma_f32_16x16x32_bf16 v[156:159], a[252:255], v[32:35], v[156:159]
    v_exp_f32 v44, v44
    v_mfma_f32_16x16x32_bf16 v[32:35], a[192:195], a[160:163], 0
    v_add_f32 v24, v24, v44
    v_mfma_f32_16x16x32_bf16 v[32:35], a[196:199], a[164:167], v[32:35]
    v_exp_f32 v45, v45
    v_mfma_f32_16x16x32_bf16 v[32:35], a[200:203], a[168:171], v[32:35]
    v_cvt_pk_bf16_f32 v42, v44, v45
    v_add_f32 v24, v24, v45
    v_mfma_f32_16x16x32_bf16 v[32:35], a[204:207], a[172:175], v[32:35]
    v_exp_f32 v46, v46
    v_mfma_f32_16x16x32_bf16 v[36:39], a[208:211], a[160:163], 0
    v_add_f32 v24, v24, v46
    v_mfma_f32_16x16x32_bf16 v[36:39], a[212:215], a[164:167], v[36:39]
    v_exp_f32 v47, v47
    v_mfma_f32_16x16x32_bf16 v[36:39], a[216:219], a[168:171], v[36:39]
    v_cvt_pk_bf16_f32 v43, v46, v47
    v_add_f32 v24, v24, v47
    v_mfma_f32_16x16x32_bf16 v[36:39], a[220:223], a[172:175], v[36:39]
    s_sub_u32 s34, s34, 1
    v_exp_f32 v32, v32
    s_cmp_eq_u32 s34, 0
    s_cbranch_scc1 L_exit1
    v_mfma_f32_16x16x32_bf16 v[160:163], a[224:227], v[40:43], v[160:163]
    s_branch L_loop1
L_exit1:
L_tail:
    v_mfma_f32_16x16x32_bf16 v[160:163], a[224:227], v[40:43], v[160:163]
    v_add_f32 v25, v25, v32
    v_mfma_f32_16x16x32_bf16 v[164:167], a[228:231], v[40:43], v[164:167]
    v_exp_f32 v33, v33
    v_mfma_f32_16x16x32_bf16 v[168:171], a[232:235], v[40:43], v[168:171]
    v_cvt_pk_bf16_f32 v32, v32, v33
    v_add_f32 v25, v25, v33
    v_mfma_f32_16x16x32_bf16 v[172:175], a[236:239], v[40:43], v[172:175]
    v_exp_f32 v34, v34
    v_mfma_f32_16x16x32_bf16 v[176:179], a[240:243], v[40:43], v[176:179]
    v_add_f32 v25, v25, v34
    v_mfma_f32_16x16x32_bf16 v[180:183], a[244:247], v[40:43], v[180:183]
    s_waitcnt vmcnt(24) lgkmcnt(0)
    s_barrier
    v_exp_f32 v35, v35
    v_mfma_f32_16x16x32_bf16 v[184:187], a[248:251], v[40:43], v[184:187]
    ds_read_b64_tr_b16 v[58:59], v7 offset:4096
    v_cvt_pk_bf16_f32 v33, v34, v35
    v_add_f32 v25, v25, v35
    v_mfma_f32_16x16x32_bf16 v[188:191], a[252:255], v[40:43], v[188:191]
    ds_read_b64_tr_b16 v[60:61], v8 offset:0
    v_exp_f32 v36, v36
    v_mfma_f32_16x16x32_bf16 v[40:43], a[192:195], a[176:179], 0
    ds_read_b128 a[192:195], v1 offset:0
    ds_read_b64_tr_b16 v[62:63], v8 offset:4096
    v_add_f32 v25, v25, v36
    v_mfma_f32_16x16x32_bf16 v[40:43], a[196:199], a[180:183], v[40:43]
    v_exp_f32 v37, v37
    v_mfma_f32_16x16x32_bf16 v[40:43], a[200:203], a[184:187], v[40:43]
    v_cvt_pk_bf16_f32 v34, v36, v37
    v_add_f32 v25, v25, v37
    v_mfma_f32_16x16x32_bf16 v[40:43], a[204:207], a[188:191], v[40:43]
    ds_read_b128 a[204:207], v4 offset:0
    v_exp_f32 v38, v38
    v_mfma_f32_16x16x32_bf16 v[44:47], a[208:211], a[176:179], 0
    ds_read_b128 a[196:199], v2 offset:0
    v_add_f32 v25, v25, v38
    v_mfma_f32_16x16x32_bf16 v[44:47], a[212:215], a[180:183], v[44:47]
    ds_read_b128 a[212:215], v2 offset:4096
    v_exp_f32 v39, v39
    v_mfma_f32_16x16x32_bf16 v[44:47], a[216:219], a[184:187], v[44:47]
    ds_read_b128 a[216:219], v3 offset:4096
    v_cvt_pk_bf16_f32 v35, v38, v39
    v_add_f32 v25, v25, v39
    v_mfma_f32_16x16x32_bf16 v[44:47], a[220:223], a[188:191], v[44:47]
    ds_read_b128 a[220:223], v4 offset:4096
    v_exp_f32 v40, v40
    v_mfma_f32_16x16x32_bf16 v[192:195], a[224:227], v[32:35], v[192:195]
    ds_read_b128 a[200:203], v3 offset:0
    v_add_f32 v26, v26, v40
    v_mfma_f32_16x16x32_bf16 v[196:199], a[228:231], v[32:35], v[196:199]
    v_exp_f32 v41, v41
    v_mfma_f32_16x16x32_bf16 v[200:203], a[232:235], v[32:35], v[200:203]
    v_cvt_pk_bf16_f32 v40, v40, v41
    v_add_f32 v26, v26, v41
    v_mfma_f32_16x16x32_bf16 v[204:207], a[236:239], v[32:35], v[204:207]
    v_exp_f32 v42, v42
    v_mfma_f32_16x16x32_bf16 v[208:211], a[240:243], v[32:35], v[208:211]
    ds_read_b128 a[208:211], v1 offset:4096
    v_add_f32 v26, v26, v42
    v_mfma_f32_16x16x32_bf16 v[212:215], a[244:247], v[32:35], v[212:215]
    v_exp_f32 v43, v43
    v_mfma_f32_16x16x32_bf16 v[216:219], a[248:251], v[32:35], v[216:219]
    v_cvt_pk_bf16_f32 v41, v42, v43
    v_add_f32 v26, v26, v43
    v_mfma_f32_16x16x32_bf16 v[220:223], a[252:255], v[32:35], v[220:223]
    s_waitcnt lgkmcnt(1)
    v_exp_f32 v44, v44
    v_mfma_f32_16x16x32_bf16 v[32:35], a[192:195], a[96:99], 0
    ds_read_b64_tr_b16 v[48:49], v5 offset:0
    v_add_f32 v26, v26, v44
    v_mfma_f32_16x16x32_bf16 v[32:35], a[196:199], a[100:103], v[32:35]
    v_exp_f32 v45, v45
    v_mfma_f32_16x16x32_bf16 v[32:35], a[200:203], a[104:107], v[32:35]
    v_cvt_pk_bf16_f32 v42, v44, v45
    v_add_f32 v26, v26, v45
    v_mfma_f32_16x16x32_bf16 v[32:35], a[204:207], a[108:111], v[32:35]
    s_waitcnt lgkmcnt(1)
    v_exp_f32 v46, v46
    v_mfma_f32_16x16x32_bf16 v[36:39], a[208:211], a[96:99], 0
    ds_read_b64_tr_b16 v[50:51], v5 offset:4096
    v_add_f32 v26, v26, v46
    v_mfma_f32_16x16x32_bf16 v[36:39], a[212:215], a[100:103], v[36:39]
    v_exp_f32 v47, v47
    v_mfma_f32_16x16x32_bf16 v[36:39], a[216:219], a[104:107], v[36:39]
    v_cvt_pk_bf16_f32 v43, v46, v47
    v_add_f32 v26, v26, v47
    v_mfma_f32_16x16x32_bf16 v[36:39], a[220:223], a[108:111], v[36:39]
    v_exp_f32 v32, v32
    v_mfma_f32_16x16x32_bf16 v[224:227], a[224:227], v[40:43], v[224:227]
    ds_read_b64_tr_b16 v[52:53], v6 offset:0
    v_add_f32 v21, v21, v32
    v_mfma_f32_16x16x32_bf16 v[228:231], a[228:231], v[40:43], v[228:231]
    v_exp_f32 v33, v33
    v_mfma_f32_16x16x32_bf16 v[232:235], a[232:235], v[40:43], v[232:235]
    ds_read_b64_tr_b16 a[234:235], v7 offset:12288
    v_cvt_pk_bf16_f32 v32, v32, v33
    v_add_f32 v21, v21, v33
    v_mfma_f32_16x16x32_bf16 v[236:239], a[236:239], v[40:43], v[236:239]
    ds_read_b64_tr_b16 a[236:237], v8 offset:8192
    v_exp_f32 v34, v34
    v_mfma_f32_16x16x32_bf16 v[240:243], a[240:243], v[40:43], v[240:243]
    ds_read_b64_tr_b16 v[54:55], v6 offset:4096
    ds_read_b64_tr_b16 a[242:243], v9 offset:4096
    v_add_f32 v21, v21, v34
    v_mfma_f32_16x16x32_bf16 v[244:247], a[244:247], v[40:43], v[244:247]
    ds_read_b64_tr_b16 a[244:245], v10 offset:0
    v_exp_f32 v35, v35
    v_mfma_f32_16x16x32_bf16 v[248:251], a[248:251], v[40:43], v[248:251]
    ds_read_b64_tr_b16 a[246:247], v10 offset:4096
    v_cvt_pk_bf16_f32 v33, v34, v35
    v_add_f32 v21, v21, v35
    v_mfma_f32_16x16x32_bf16 v[252:255], a[252:255], v[40:43], v[252:255]
    ds_read_b64_tr_b16 a[248:249], v11 offset:0
    v_exp_f32 v36, v36
    v_mfma_f32_16x16x32_bf16 v[40:43], a[192:195], a[112:115], 0
    ds_read_b64_tr_b16 v[56:57], v7 offset:0
    ds_read_b64_tr_b16 a[250:251], v11 offset:4096
    v_add_f32 v21, v21, v36
    v_mfma_f32_16x16x32_bf16 v[40:43], a[196:199], a[116:119], v[40:43]
    ds_read_b64_tr_b16 a[252:253], v12 offset:0
    v_exp_f32 v37, v37
    v_mfma_f32_16x16x32_bf16 v[40:43], a[200:203], a[120:123], v[40:43]
    ds_read_b64_tr_b16 a[254:255], v12 offset:4096
    v_cvt_pk_bf16_f32 v34, v36, v37
    v_add_f32 v21, v21, v37
    v_mfma_f32_16x16x32_bf16 v[40:43], a[204:207], a[124:127], v[40:43]
    ds_read_b128 a[196:199], v2 offset:8192
    v_exp_f32 v38, v38
    v_mfma_f32_16x16x32_bf16 v[44:47], a[208:211], a[112:115], 0
    ds_read_b64_tr_b16 a[240:241], v9 offset:0
    ds_read_b128 a[200:203], v3 offset:8192
    v_add_f32 v21, v21, v38
    v_mfma_f32_16x16x32_bf16 v[44:47], a[212:215], a[116:119], v[44:47]
    ds_read_b128 a[204:207], v4 offset:8192
    v_exp_f32 v39, v39
    v_mfma_f32_16x16x32_bf16 v[44:47], a[216:219], a[120:123], v[44:47]
    ds_read_b128 a[212:215], v2 offset:12288
    v_cvt_pk_bf16_f32 v35, v38, v39
    v_add_f32 v21, v21, v39
    v_mfma_f32_16x16x32_bf16 v[44:47], a[220:223], a[124:127], v[44:47]
    s_waitcnt lgkmcnt(8)
    v_exp_f32 v40, v40
    v_mfma_f32_16x16x32_bf16 v[64:67], v[48:51], v[32:35], v[64:67]
    ds_read_b128 a[192:195], v1 offset:8192
    ds_read_b128 a[216:219], v3 offset:12288
    v_add_f32 v22, v22, v40
    v_mfma_f32_16x16x32_bf16 v[68:71], v[52:55], v[32:35], v[68:71]
    ds_read_b128 a[220:223], v4 offset:12288
    v_exp_f32 v41, v41
    v_mfma_f32_16x16x32_bf16 v[72:75], v[56:59], v[32:35], v[72:75]
    ds_read_b64_tr_b16 a[238:239], v8 offset:12288
    v_cvt_pk_bf16_f32 v40, v40, v41
    v_add_f32 v22, v22, v41
    v_mfma_f32_16x16x32_bf16 v[76:79], v[60:63], v[32:35], v[76:79]
    s_waitcnt lgkmcnt(7)
    v_exp_f32 v42, v42
    v_mfma_f32_16x16x32_bf16 v[80:83], a[240:243], v[32:35], v[80:83]
    ds_read_b128 a[208:211], v1 offset:12288
    v_add_f32 v22, v22, v42
    v_mfma_f32_16x16x32_bf16 v[84:87], a[244:247], v[32:35], v[84:87]
    v_exp_f32 v43, v43
    v_mfma_f32_16x16x32_bf16 v[88:91], a[248:251], v[32:35], v[88:91]
    v_cvt_pk_bf16_f32 v41, v42, v43
    v_add_f32 v22, v22, v43
    v_mfma_f32_16x16x32_bf16 v[92:95], a[252:255], v[32:35], v[92:95]
    s_waitcnt lgkmcnt(4)
    v_exp_f32 v44, v44
    v_mfma_f32_16x16x32_bf16 v[32:35], a[192:195], a[96:99], 0
    ds_read_b64_tr_b16 a[224:225], v5 offset:8192
    v_add_f32 v22, v22, v44
    v_mfma_f32_16x16x32_bf16 v[32:35], a[196:199], a[100:103], v[32:35]
    v_exp_f32 v45, v45
    v_mfma_f32_16x16x32_bf16 v[32:35], a[200:203], a[104:107], v[32:35]
    v_cvt_pk_bf16_f32 v42, v44, v45
    v_add_f32 v22, v22, v45
    v_mfma_f32_16x16x32_bf16 v[32:35], a[204:207], a[108:111], v[32:35]
    s_waitcnt lgkmcnt(1)
    v_exp_f32 v46, v46
    v_mfma_f32_16x16x32_bf16 v[36:39], a[208:211], a[96:99], 0
    ds_read_b64_tr_b16 a[226:227], v5 offset:12288
    v_add_f32 v22, v22, v46
    v_mfma_f32_16x16x32_bf16 v[36:39], a[212:215], a[100:103], v[36:39]
    v_exp_f32 v47, v47
    v_mfma_f32_16x16x32_bf16 v[36:39], a[216:219], a[104:107], v[36:39]
    v_cvt_pk_bf16_f32 v43, v46, v47
    v_add_f32 v22, v22, v47
    v_mfma_f32_16x16x32_bf16 v[36:39], a[220:223], a[108:111], v[36:39]
    v_exp_f32 v32, v32
    v_mfma_f32_16x16x32_bf16 v[96:99], v[48:51], v[40:43], v[96:99]
    ds_read_b64_tr_b16 a[228:229], v6 offset:8192
    v_add_f32 v21, v21, v32
    v_mfma_f32_16x16x32_bf16 v[100:103], v[52:55], v[40:43], v[100:103]
    v_exp_f32 v33, v33
    v_mfma_f32_16x16x32_bf16 v[104:107], v[56:59], v[40:43], v[104:107]
    v_cvt_pk_bf16_f32 v32, v32, v33
    v_add_f32 v21, v21, v33
    v_mfma_f32_16x16x32_bf16 v[108:111], v[60:63], v[40:43], v[108:111]
    v_exp_f32 v34, v34
    v_mfma_f32_16x16x32_bf16 v[112:115], a[240:243], v[40:43], v[112:115]
    ds_read_b64_tr_b16 a[230:231], v6 offset:12288
    ds_read_b64_tr_b16 a[242:243], v9 offset:12288
    v_add_f32 v21, v21, v34
    v_mfma_f32_16x16x32_bf16 v[116:119], a[244:247], v[40:43], v[116:119]
    ds_read_b64_tr_b16 a[244:245], v10 offset:8192
    v_exp_f32 v35, v35
    v_mfma_f32_16x16x32_bf16 v[120:123], a[248:251], v[40:43], v[120:123]
    ds_read_b64_tr_b16 a[246:247], v10 offset:12288
    v_cvt_pk_bf16_f32 v33, v34, v35
    v_add_f32 v21, v21, v35
    v_mfma_f32_16x16x32_bf16 v[124:127], a[252:255], v[40:43], v[124:127]
    ds_read_b64_tr_b16 a[248:249], v11 offset:8192
    v_exp_f32 v36, v36
    v_mfma_f32_16x16x32_bf16 v[40:43], a[192:195], a[112:115], 0
    ds_read_b64_tr_b16 a[232:233], v7 offset:8192
    ds_read_b64_tr_b16 a[250:251], v11 offset:12288
    v_add_f32 v21, v21, v36
    v_mfma_f32_16x16x32_bf16 v[40:43], a[196:199], a[116:119], v[40:43]
    ds_read_b64_tr_b16 a[252:253], v12 offset:8192
    v_exp_f32 v37, v37
    v_mfma_f32_16x16x32_bf16 v[40:43], a[200:203], a[120:123], v[40:43]
    ds_read_b64_tr_b16 a[254:255], v12 offset:12288
    v_cvt_pk_bf16_f32 v34, v36, v37
    v_add_f32 v21, v21, v37
    v_mfma_f32_16x16x32_bf16 v[40:43], a[204:207], a[124:127], v[40:43]
    ds_read_b128 a[196:199], v2 offset:0
    v_exp_f32 v38, v38
    v_mfma_f32_16x16x32_bf16 v[44:47], a[208:211], a[112:115], 0
    ds_read_b64_tr_b16 a[240:241], v9 offset:8192
    ds_read_b128 a[200:203], v3 offset:0
    v_add_f32 v21, v21, v38
    v_mfma_f32_16x16x32_bf16 v[44:47], a[212:215], a[116:119], v[44:47]
    ds_read_b128 a[204:207], v4 offset:0
    v_exp_f32 v39, v39
    v_mfma_f32_16x16x32_bf16 v[44:47], a[216:219], a[120:123], v[44:47]
    ds_read_b128 a[212:215], v2 offset:4096
    v_cvt_pk_bf16_f32 v35, v38, v39
    v_add_f32 v21, v21, v39
    v_mfma_f32_16x16x32_bf16 v[44:47], a[220:223], a[124:127], v[44:47]
    s_waitcnt lgkmcnt(8)
    v_exp_f32 v40, v40
    v_mfma_f32_16x16x32_bf16 v[64:67], a[224:227], v[32:35], v[64:67]
    ds_read_b128 a[192:195], v1 offset:0
    ds_read_b128 a[216:219], v3 offset:4096
    v_add_f32 v22, v22, v40
    v_mfma_f32_16x16x32_bf16 v[68:71], a[228:231], v[32:35], v[68:71]
    ds_read_b128 a[220:223], v4 offset:4096
    v_exp_f32 v41, v41
    v_mfma_f32_16x16x32_bf16 v[72:75], a[232:235], v[32:35], v[72:75]
    v_cvt_pk_bf16_f32 v40, v40, v41
    v_add_f32 v22, v22, v41
    v_mfma_f32_16x16x32_bf16 v[76:79], a[236:239], v[32:35], v[76:79]
    s_waitcnt lgkmcnt(6)
    v_exp_f32 v42, v42
    v_mfma_f32_16x16x32_bf16 v[80:83], a[240:243], v[32:35], v[80:83]
    ds_read_b128 a[208:211], v1 offset:4096
    v_add_f32 v22, v22, v42
    v_mfma_f32_16x16x32_bf16 v[84:87], a[244:247], v[32:35], v[84:87]
    v_exp_f32 v43, v43
    v_mfma_f32_16x16x32_bf16 v[88:91], a[248:251], v[32:35], v[88:91]
    v_cvt_pk_bf16_f32 v41, v42, v43
    v_add_f32 v22, v22, v43
    v_mfma_f32_16x16x32_bf16 v[92:95], a[252:255], v[32:35], v[92:95]
    s_waitcnt lgkmcnt(3)
    v_exp_f32 v44, v44
    v_mfma_f32_16x16x32_bf16 v[32:35], a[192:195], a[128:131], 0
    v_add_f32 v22, v22, v44
    v_mfma_f32_16x16x32_bf16 v[32:35], a[196:199], a[132:135], v[32:35]
    v_exp_f32 v45, v45
    v_mfma_f32_16x16x32_bf16 v[32:35], a[200:203], a[136:139], v[32:35]
    v_cvt_pk_bf16_f32 v42, v44, v45
    v_add_f32 v22, v22, v45
    v_mfma_f32_16x16x32_bf16 v[32:35], a[204:207], a[140:143], v[32:35]
    s_waitcnt lgkmcnt(0)
    v_exp_f32 v46, v46
    v_mfma_f32_16x16x32_bf16 v[36:39], a[208:211], a[128:131], 0
    s_waitcnt vmcnt(8)
    v_add_f32 v22, v22, v46
    v_mov_b32 v29, v21
    s_nop 1
    v_permlane16_swap_b32 v21, v29
    v_add_f32 v21, v21, v29
    v_mov_b32 v29, v21
    s_nop 1
    v_permlane32_swap_b32 v21, v29
    v_add_f32 v21, v21, v29
    v_rcp_f32 v30, v21
    v_cmp_ngt_f32 vcc, s29, v21
    v_mfma_f32_16x16x32_bf16 v[36:39], a[212:215], a[132:135], v[36:39]
    s_nop 0
    s_or_b64 s[44:45], s[44:45], vcc
    v_exp_f32 v47, v47
    v_cmp_nle_f32 vcc, s36, v21
    v_mfma_f32_16x16x32_bf16 v[36:39], a[216:219], a[136:139], v[36:39]
    s_nop 0
    s_or_b64 s[44:45], s[44:45], vcc
    v_cvt_pk_bf16_f32 v43, v46, v47
    v_add_f32 v22, v22, v47
    v_mul_f32 v64, v64, v30
    v_mul_f32 v65, v65, v30
    v_mul_f32 v66, v66, v30
    v_mul_f32 v67, v67, v30
    v_mul_f32 v68, v68, v30
    v_mul_f32 v69, v69, v30
    v_mul_f32 v70, v70, v30
    v_mul_f32 v71, v71, v30
    v_cvt_pk_bf16_f32 v64, v64, v65
    v_cvt_pk_bf16_f32 v65, v66, v67
    v_cvt_pk_bf16_f32 v66, v68, v69
    v_mfma_f32_16x16x32_bf16 v[36:39], a[220:223], a[140:143], v[36:39]
    v_exp_f32 v32, v32
    v_cvt_pk_bf16_f32 v67, v70, v71
    v_mfma_f32_16x16x32_bf16 v[96:99], a[224:227], v[40:43], v[96:99]
    ds_write_b64 v20, v[64:65] offset:0
    ds_write_b64 v20, v[66:67] offset:32
    v_add_f32 v23, v23, v32
    v_mfma_f32_16x16x32_bf16 a[0:3], v[64:67], v[64:67], 0
    v_mul_f32 v72, v72, v30
    v_mul_f32 v73, v73, v30
    v_mul_f32 v74, v74, v30
    v_mul_f32 v75, v75, v30
    v_mul_f32 v76, v76, v30
    v_mul_f32 v77, v77, v30
    v_mul_f32 v78, v78, v30
    v_mul_f32 v79, v79, v30
    v_mfma_f32_16x16x32_bf16 v[100:103], a[228:231], v[40:43], v[100:103]
    v_exp_f32 v33, v33
    v_cvt_pk_bf16_f32 v72, v72, v73
    v_cvt_pk_bf16_f32 v73, v74, v75
    v_cvt_pk_bf16_f32 v74, v76, v77
    v_cvt_pk_bf16_f32 v75, v78, v79
    v_mfma_f32_16x16x32_bf16 v[104:107], a[232:235], v[40:43], v[104:107]
    ds_write_b64 v20, v[72:73] offset:64
    ds_write_b64 v20, v[74:75] offset:96
    v_cvt_pk_bf16_f32 v32, v32, v33
    v_add_f32 v23, v23, v33
    v_mfma_f32_16x16x32_bf16 a[0:3], v[72:75], v[72:75], a[0:3]
    v_mul_f32 v80, v80, v30
    v_mul_f32 v81, v81, v30
    v_mul_f32 v82, v82, v30
    v_mul_f32 v83, v83, v30
    v_mfma_f32_16x16x32_bf16 v[108:111], a[236:239], v[40:43], v[108:111]
    v_exp_f32 v34, v34
    v_mul_f32 v84, v84, v30
    v_mul_f32 v85, v85, v30
    v_mul_f32 v86, v86, v30
    v_mul_f32 v87, v87, v30
    v_cvt_pk_bf16_f32 v80, v80, v81
    v_cvt_pk_bf16_f32 v81, v82, v83
    v_mfma_f32_16x16x32_bf16 v[112:115], a[240:243], v[40:43], v[112:115]
    ds_read_b64_tr_b16 a[242:243], v9 offset:4096
    v_add_f32 v23, v23, v34
    v_cvt_pk_bf16_f32 v82, v84, v85
    v_cvt_pk_bf16_f32 v83, v86, v87
    v_mfma_f32_16x16x32_bf16 v[116:119], a[244:247], v[40:43], v[116:119]
    ds_write_b64 v20, v[80:81] offset:128
    ds_write_b64 v20, v[82:83] offset:160
    v_exp_f32 v35, v35
    v_mfma_f32_16x16x32_bf16 a[0:3], v[80:83], v[80:83], a[0:3]
    v_mul_f32 v88, v88, v30
    v_mul_f32 v89, v89, v30
    v_mul_f32 v90, v90, v30
    v_mul_f32 v91, v91, v30
    v_mul_f32 v92, v92, v30
    v_mul_f32 v93, v93, v30
    v_mfma_f32_16x16x32_bf16 v[120:123], a[248:251], v[40:43], v[120:123]
    v_cvt_pk_bf16_f32 v33, v34, v35
    v_add_f32 v23, v23, v35
    v_mul_f32 v94, v94, v30
    v_mul_f32 v95, v95, v30
    v_cvt_pk_bf16_f32 v88, v88, v89
    v_cvt_pk_bf16_f32 v89, v90, v91
    v_cvt_pk_bf16_f32 v90, v92, v93
    v_cvt_pk_bf16_f32 v91, v94, v95
    v_mfma_f32_16x16x32_bf16 v[124:127], a[252:255], v[40:43], v[124:127]
    ds_read_b64_tr_b16 a[240:241], v9 offset:0
    ds_read_b64_tr_b16 a[246:247], v10 offset:4096
    ds_read_b64_tr_b16 a[252:253], v12 offset:0
    v_exp_f32 v36, v36
    v_mfma_f32_16x16x32_bf16 v[40:43], a[192:195], a[144:147], 0
    ds_write_b64 v20, v[88:89] offset:192
    ds_write_b64 v20, v[90:91] offset:224
    v_add_f32 v23, v23, v36
    v_mfma_f32_16x16x32_bf16 a[0:3], v[88:91], v[88:91], a[0:3]
    v_mfma_f32_16x16x32_bf16 v[40:43], a[196:199], a[148:151], v[40:43]
    ds_read_b128 v[68:71], v19 offset:0
    ds_read_b128 v[76:79], v19 offset:1088
    ds_read_b128 v[84:87], v19 offset:2176
    ds_read_b128 v[92:95], v19 offset:3264
    v_exp_f32 v37, v37
    s_nop 1
    v_accvgpr_read_b32 v29, a0
    v_sub_f32 v29, v29, v29
    v_accvgpr_read_b32 v31, a1
    v_fma_f32 v29, v31, 0, v29
    v_accvgpr_read_b32 v31, a2
    v_fma_f32 v29, v31, 0, v29
    v_accvgpr_read_b32 v31, a3
    v_fma_f32 v29, v31, 0, v29
    v_cmp_u_f32 vcc, v29, v29
    v_mfma_f32_16x16x32_bf16 v[40:43], a[200:203], a[152:155], v[40:43]
    s_nop 0
    s_or_b64 s[44:45], s[44:45], vcc
    s_add_u32 s54, s47, 0x18000
    s_waitcnt lgkmcnt(3)
    buffer_store_dwordx4 v[68:71], v27, s[20:23], s54 offen offset:0 sc1
    s_waitcnt lgkmcnt(2)
    buffer_store_dwordx4 v[76:79], v27, s[20:23], s54 offen offset:1024 sc1
    s_waitcnt lgkmcnt(1)
    buffer_store_dwordx4 v[84:87], v27, s[20:23], s54 offen offset:2048 sc1
    s_waitcnt lgkmcnt(0)
    buffer_store_dwordx4 v[92:95], v27, s[20:23], s54 offen offset:3072 sc1
    v_cvt_pk_bf16_f32 v34, v36, v37
    v_add_f32 v23, v23, v37
    v_mfma_f32_16x16x32_bf16 v[40:43], a[204:207], a[156:159], v[40:43]
    v_exp_f32 v38, v38
    v_mov_b32 v29, v22
    s_nop 1
    v_permlane16_swap_b32 v22, v29
    v_add_f32 v22, v22, v29
    v_mov_b32 v29, v22
    v_mfma_f32_16x16x32_bf16 v[44:47], a[208:211], a[144:147], 0
    v_add_f32 v23, v23, v38
    v_permlane32_swap_b32 v22, v29
    v_add_f32 v22, v22, v29
    v_rcp_f32 v30, v22
    v_cmp_ngt_f32 vcc, s29, v22
    v_mfma_f32_16x16x32_bf16 v[44:47], a[212:215], a[148:151], v[44:47]
    ds_read_b64_tr_b16 a[244:245], v10 offset:0
    ds_read_b64_tr_b16 a[248:249], v11 offset:0
    ds_read_b64_tr_b16 a[254:255], v12 offset:4096
    ds_read_b128 a[208:211], v1 offset:12288
    v_exp_f32 v39, v39
    v_mfma_f32_16x16x32_bf16 v[44:47], a[216:219], a[152:155], v[44:47]
    ds_read_b64_tr_b16 a[250:251], v11 offset:4096
    ds_read_b128 a[192:195], v1 offset:8192
    s_or_b64 s[44:45], s[44:45], vcc
    v_cvt_pk_bf16_f32 v35, v38, v39
    v_add_f32 v23, v23, v39
    v_cmp_nle_f32 vcc, s36, v22
    v_mfma_f32_16x16x32_bf16 v[44:47], a[220:223], a[156:159], v[44:47]
    s_nop 0
    s_or_b64 s[44:45], s[44:45], vcc
    v_exp_f32 v40, v40
    v_mul_f32 v96, v96, v30
    v_mul_f32 v97, v97, v30
    v_mul_f32 v98, v98, v30
    v_mul_f32 v99, v99, v30
    v_mul_f32 v100, v100, v30
    v_mul_f32 v101, v101, v30
    v_mul_f32 v102, v102, v30
    v_mul_f32 v103, v103, v30
    v_mfma_f32_16x16x32_bf16 v[128:131], v[48:51], v[32:35], v[128:131]
    v_add_f32 v24, v24, v40
    v_cvt_pk_bf16_f32 v96, v96, v97
    v_cvt_pk_bf16_f32 v97, v98, v99
    v_cvt_pk_bf16_f32 v98, v100, v101
    v_cvt_pk_bf16_f32 v99, v102, v103
    v_mfma_f32_16x16x32_bf16 v[132:135], v[52:55], v[32:35], v[132:135]
    ds_read_b128 a[196:199], v2 offset:8192
    ds_read_b128 a[200:203], v3 offset:8192
    ds_read_b128 a[204:207], v4 offset:8192
    v_exp_f32 v41, v41
    v_mfma_f32_16x16x32_bf16 v[136:139], v[56:59], v[32:35], v[136:139]
    ds_write_b64 v20, v[96:97] offset:0
    ds_write_b64 v20, v[98:99] offset:32
    v_cvt_pk_bf16_f32 v40, v40, v41
    v_add_f32 v24, v24, v41
    v_mfma_f32_16x16x32_bf16 a[16:19], v[96:99], v[96:99], 0
    v_mul_f32 v104, v104, v30
    v_mul_f32 v105, v105, v30
    v_mul_f32 v106, v106, v30
    v_mul_f32 v107, v107, v30
    v_mfma_f32_16x16x32_bf16 v[140:143], v[60:63], v[32:35], v[140:143]
    s_waitcnt lgkmcnt(6)
    v_exp_f32 v42, v42
    v_mul_f32 v108, v108, v30
    v_mul_f32 v109, v109, v30
    v_mul_f32 v110, v110, v30
    v_mul_f32 v111, v111, v30
    v_mfma_f32_16x16x32_bf16 v[144:147], a[240:243], v[32:35], v[144:147]
    v_add_f32 v24, v24, v42
    v_cvt_pk_bf16_f32 v104, v104, v105
    v_cvt_pk_bf16_f32 v105, v106, v107
    v_cvt_pk_bf16_f32 v106, v108, v109
    v_cvt_pk_bf16_f32 v107, v110, v111
    v_mfma_f32_16x16x32_bf16 v[148:151], a[244:247], v[32:35], v[148:151]
    ds_read_b128 a[212:215], v2 offset:12288
    ds_read_b128 a[216:219], v3 offset:12288
    ds_read_b128 a[220:223], v4 offset:12288
    v_exp_f32 v43, v43
    v_mfma_f32_16x16x32_bf16 v[152:155], a[248:251], v[32:35], v[152:155]
    ds_write_b64 v20, v[104:105] offset:64
    ds_write_b64 v20, v[106:107] offset:96
    v_cvt_pk_bf16_f32 v41, v42, v43
    v_add_f32 v24, v24, v43
    v_mfma_f32_16x16x32_bf16 a[16:19], v[104:107], v[104:107], a[16:19]
    v_mul_f32 v112, v112, v30
    v_mul_f32 v113, v113, v30
    v_mul_f32 v114, v114, v30
    v_mul_f32 v115, v115, v30
    v_mfma_f32_16x16x32_bf16 v[156:159], a[252:255], v[32:35], v[156:159]
    s_waitcnt lgkmcnt(7)
    v_exp_f32 v44, v44
    v_mul_f32 v116, v116, v30
    v_mul_f32 v117, v117, v30
    v_mul_f32 v118, v118, v30
    v_mul_f32 v119, v119, v30
    v_mfma_f32_16x16x32_bf16 v[32:35], a[192:195], a[128:131], 0
    v_add_f32 v24, v24, v44
    v_cvt_pk_bf16_f32 v112, v112, v113
    v_cvt_pk_bf16_f32 v113, v114, v115
    v_cvt_pk_bf16_f32 v114, v116, v117
    v_cvt_pk_bf16_f32 v115, v118, v119
    v_mfma_f32_16x16x32_bf16 v[32:35], a[196:199], a[132:135], v[32:35]
    v_exp_f32 v45, v45
    v_mfma_f32_16x16x32_bf16 v[32:35], a[200:203], a[136:139], v[32:35]
    ds_write_b64 v20, v[112:113] offset:128
    ds_write_b64 v20, v[114:115] offset:160
    v_cvt_pk_bf16_f32 v42, v44, v45
    v_add_f32 v24, v24, v45
    v_mfma_f32_16x16x32_bf16 a[16:19], v[112:115], v[112:115], a[16:19]
    v_mul_f32 v120, v120, v30
    v_mul_f32 v121, v121, v30
    v_mul_f32 v122, v122, v30
    v_mul_f32 v123, v123, v30
    v_mfma_f32_16x16x32_bf16 v[32:35], a[204:207], a[140:143], v[32:35]
    s_waitcnt lgkmcnt(4)
    v_exp_f32 v46, v46
    v_mul_f32 v124, v124, v30
    v_mul_f32 v125, v125, v30
    v_mul_f32 v126, v126, v30
    v_mul_f32 v127, v127, v30
    v_mfma_f32_16x16x32_bf16 v[36:39], a[208:211], a[128:131], 0
    v_add_f32 v24, v24, v46
    v_cvt_pk_bf16_f32 v120, v120, v121
    v_cvt_pk_bf16_f32 v121, v122, v123
    v_cvt_pk_bf16_f32 v122, v124, v125
    v_cvt_pk_bf16_f32 v123, v126, v127
    v_mfma_f32_16x16x32_bf16 v[36:39], a[212:215], a[132:135], v[36:39]
    v_exp_f32 v47, v47
    v_mfma_f32_16x16x32_bf16 v[36:39], a[216:219], a[136:139], v[36:39]
    ds_write_b64 v20, v[120:121] offset:192
    ds_write_b64 v20, v[122:123] offset:224
    v_cvt_pk_bf16_f32 v43, v46, v47
    v_add_f32 v24, v24, v47
    v_mfma_f32_16x16x32_bf16 a[16:19], v[120:123], v[120:123], a[16:19]
    v_mfma_f32_16x16x32_bf16 v[36:39], a[220:223], a[140:143], v[36:39]
    ds_read_b128 v[100:103], v19 offset:0
    ds_read_b128 v[108:111], v19 offset:1088
    ds_read_b128 v[116:119], v19 offset:2176
    ds_read_b128 v[124:127], v19 offset:3264
    v_exp_f32 v32, v32
    s_nop 1
    v_accvgpr_read_b32 v29, a16
    v_sub_f32 v29, v29, v29
    v_accvgpr_read_b32 v31, a17
    v_fma_f32 v29, v31, 0, v29
    v_mfma_f32_16x16x32_bf16 v[160:163], v[48:51], v[40:43], v[160:163]
    v_add_f32 v23, v23, v32
    v_accvgpr_read_b32 v31, a18
    v_fma_f32 v29, v31, 0, v29
    v_accvgpr_read_b32 v31, a19
    v_fma_f32 v29, v31, 0, v29
    v_mfma_f32_16x16x32_bf16 v[164:167], v[52:55], v[40:43], v[164:167]
    v_exp_f32 v33, v33
    v_cmp_u_f32 vcc, v29, v29
    v_mfma_f32_16x16x32_bf16 v[168:171], v[56:59], v[40:43], v[168:171]
    s_nop 0
    s_or_b64 s[44:45], s[44:45], vcc
    s_add_u32 s54, s47, 0x19000
    s_waitcnt lgkmcnt(3)
    buffer_store_dwordx4 v[100:103], v27, s[20:23], s54 offen offset:0 sc1
    s_waitcnt lgkmcnt(2)
    buffer_store_dwordx4 v[108:111], v27, s[20:23], s54 offen offset:1024 sc1
    s_waitcnt lgkmcnt(1)
    buffer_store_dwordx4 v[116:119], v27, s[20:23], s54 offen offset:2048 sc1
    s_waitcnt lgkmcnt(0)
    buffer_store_dwordx4 v[124:127], v27, s[20:23], s54 offen offset:3072 sc1
    v_cvt_pk_bf16_f32 v32, v32, v33
    v_add_f32 v23, v23, v33
    v_mfma_f32_16x16x32_bf16 v[172:175], v[60:63], v[40:43], v[172:175]
    v_exp_f32 v34, v34
    v_mfma_f32_16x16x32_bf16 v[176:179], a[240:243], v[40:43], v[176:179]
    ds_read_b64_tr_b16 a[240:241], v9 offset:8192
    v_add_f32 v23, v23, v34
    v_mfma_f32_16x16x32_bf16 v[180:183], a[244:247], v[40:43], v[180:183]
    ds_read_b64_tr_b16 a[246:247], v10 offset:12288
    v_exp_f32 v35, v35
    v_mfma_f32_16x16x32_bf16 v[184:187], a[248:251], v[40:43], v[184:187]
    ds_read_b64_tr_b16 a[248:249], v11 offset:8192
    v_cvt_pk_bf16_f32 v33, v34, v35
    v_add_f32 v23, v23, v35
    v_mfma_f32_16x16x32_bf16 v[188:191], a[252:255], v[40:43], v[188:191]
    ds_read_b64_tr_b16 a[250:251], v11 offset:12288
    v_exp_f32 v36, v36
    v_mfma_f32_16x16x32_bf16 v[40:43], a[192:195], a[144:147], 0
    ds_read_b64_tr_b16 a[242:243], v9 offset:12288
    ds_read_b64_tr_b16 a[252:253], v12 offset:8192
    v_add_f32 v23, v23, v36
    v_mfma_f32_16x16x32_bf16 v[40:43], a[196:199], a[148:151], v[40:43]
    ds_read_b64_tr_b16 a[254:255], v12 offset:12288
    v_exp_f32 v37, v37
    v_mfma_f32_16x16x32_bf16 v[40:43], a[200:203], a[152:155], v[40:43]
    ds_read_b128 a[196:199], v2 offset:0
    v_cvt_pk_bf16_f32 v34, v36, v37
    v_add_f32 v23, v23, v37
    v_mfma_f32_16x16x32_bf16 v[40:43], a[204:207], a[156:159], v[40:43]
    ds_read_b128 a[200:203], v3 offset:0
    v_exp_f32 v38, v38
    v_mfma_f32_16x16x32_bf16 v[44:47], a[208:211], a[144:147], 0
    ds_read_b64_tr_b16 a[244:245], v10 offset:8192
    ds_read_b128 a[204:207], v4 offset:0
    v_add_f32 v23, v23, v38
    v_mfma_f32_16x16x32_bf16 v[44:47], a[212:215], a[148:151], v[44:47]
    ds_read_b128 a[212:215], v2 offset:4096
    v_exp_f32 v39, v39
    v_mfma_f32_16x16x32_bf16 v[44:47], a[216:219], a[152:155], v[44:47]
    ds_read_b128 a[216:219], v3 offset:4096
    v_cvt_pk_bf16_f32 v35, v38, v39
    v_add_f32 v23, v23, v39
    v_mfma_f32_16x16x32_bf16 v[44:47], a[220:223], a[156:159], v[44:47]
    v_exp_f32 v40, v40
    v_mfma_f32_16x16x32_bf16 v[128:131], a[224:227], v[32:35], v[128:131]
    ds_read_b128 a[192:195], v1 offset:0
    ds_read_b128 a[220:223], v4 offset:4096
    v_add_f32 v24, v24, v40
    v_mfma_f32_16x16x32_bf16 v[132:135], a[228:231], v[32:35], v[132:135]
    v_exp_f32 v41, v41
    v_mfma_f32_16x16x32_bf16 v[136:139], a[232:235], v[32:35], v[136:139]
    v_cvt_pk_bf16_f32 v40, v40, v41
    v_add_f32 v24, v24, v41
    v_mfma_f32_16x16x32_bf16 v[140:143], a[236:239], v[32:35], v[140:143]
    s_waitcnt lgkmcnt(5)
    v_exp_f32 v42, v42
    v_mfma_f32_16x16x32_bf16 v[144:147], a[240:243], v[32:35], v[144:147]
    ds_read_b128 a[208:211], v1 offset:4096
    v_add_f32 v24, v24, v42
    v_mfma_f32_16x16x32_bf16 v[148:151], a[244:247], v[32:35], v[148:151]
    v_exp_f32 v43, v43
    v_mfma_f32_16x16x32_bf16 v[152:155], a[248:251], v[32:35], v[152:155]
    v_cvt_pk_bf16_f32 v41, v42, v43
    v_add_f32 v24, v24, v43
    v_mfma_f32_16x16x32_bf16 v[156:159], a[252:255], v[32:35], v[156:159]
    s_waitcnt lgkmcnt(2)
    v_exp_f32 v44, v44
    v_mfma_f32_16x16x32_bf16 v[32:35], a[192:195], a[160:163], 0
    v_add_f32 v24, v24, v44
    v_mfma_f32_16x16x32_bf16 v[32:35], a[196:199], a[164:167], v[32:35]
    v_exp_f32 v45, v45
    v_mfma_f32_16x16x32_bf16 v[32:35], a[200:203], a[168:171], v[32:35]
    v_cvt_pk_bf16_f32 v42, v44, v45
    v_add_f32 v24, v24, v45
    v_mfma_f32_16x16x32_bf16 v[32:35], a[204:207], a[172:175], v[32:35]
    s_waitcnt lgkmcnt(0)
    v_exp_f32 v46, v46
    v_mov_b32 v29, v23
    s_nop 1
    v_permlane16_swap_b32 v23, v29
    v_add_f32 v23, v23, v29
    v_mov_b32 v29, v23
    s_nop 1
    v_permlane32_swap_b32 v23, v29
    v_add_f32 v23, v23, v29
    v_mfma_f32_16x16x32_bf16 v[36:39], a[208:211], a[160:163], 0
    v_add_f32 v24, v24, v46
    v_rcp_f32 v30, v23
    v_cmp_ngt_f32 vcc, s29, v23
    v_mfma_f32_16x16x32_bf16 v[36:39], a[212:215], a[164:167], v[36:39]
    s_nop 0
    s_or_b64 s[44:45], s[44:45], vcc
    v_exp_f32 v47, v47
    v_cmp_nle_f32 vcc, s36, v23
    v_mfma_f32_16x16x32_bf16 v[36:39], a[216:219], a[168:171], v[36:39]
    s_nop 0
    s_or_b64 s[44:45], s[44:45], vcc
    v_cvt_pk_bf16_f32 v43, v46, v47
    v_add_f32 v24, v24, v47
    v_mul_f32 v128, v128, v30
    v_mul_f32 v129, v129, v30
    v_mul_f32 v130, v130, v30
    v_mul_f32 v131, v131, v30
    v_mul_f32 v132, v132, v30
    v_mul_f32 v133, v133, v30
    v_mul_f32 v134, v134, v30
    v_mul_f32 v135, v135, v30
    v_cvt_pk_bf16_f32 v128, v128, v129
    v_cvt_pk_bf16_f32 v129, v130, v131
    v_cvt_pk_bf16_f32 v130, v132, v133
    v_cvt_pk_bf16_f32 v131, v134, v135
    v_mfma_f32_16x16x32_bf16 v[36:39], a[220:223], a[172:175], v[36:39]
    v_exp_f32 v32, v32
    v_mfma_f32_16x16x32_bf16 v[160:163], a[224:227], v[40:43], v[160:163]
    ds_write_b64 v20, v[128:129] offset:0
    ds_write_b64 v20, v[130:131] offset:32
    v_add_f32 v25, v25, v32
    v_mfma_f32_16x16x32_bf16 a[32:35], v[128:131], v[128:131], 0
    v_mul_f32 v136, v136, v30
    v_mul_f32 v137, v137, v30
    v_mul_f32 v138, v138, v30
    v_mul_f32 v139, v139, v30
    v_mul_f32 v140, v140, v30
    v_mul_f32 v141, v141, v30
    v_mul_f32 v142, v142, v30
    v_mul_f32 v143, v143, v30
    v_mfma_f32_16x16x32_bf16 v[164:167], a[228:231], v[40:43], v[164:167]
    v_exp_f32 v33, v33
    v_cvt_pk_bf16_f32 v136, v136, v137
    v_cvt_pk_bf16_f32 v137, v138, v139
    v_cvt_pk_bf16_f32 v138, v140, v141
    v_cvt_pk_bf16_f32 v139, v142, v143
    v_mfma_f32_16x16x32_bf16 v[168:171], a[232:235], v[40:43], v[168:171]
    ds_write_b64 v20, v[136:137] offset:64
    ds_write_b64 v20, v[138:139] offset:96
    v_cvt_pk_bf16_f32 v32, v32, v33
    v_add_f32 v25, v25, v33
    v_mfma_f32_16x16x32_bf16 a[32:35], v[136:139], v[136:139], a[32:35]
    v_mul_f32 v144, v144, v30
    v_mul_f32 v145, v145, v30
    v_mul_f32 v146, v146, v30
    v_mul_f32 v147, v147, v30
    v_mfma_f32_16x16x32_bf16 v[172:175], a[236:239], v[40:43], v[172:175]
    v_exp_f32 v34, v34
    v_mul_f32 v148, v148, v30
    v_mul_f32 v149, v149, v30
    v_mul_f32 v150, v150, v30
    v_mul_f32 v151, v151, v30
    v_cvt_pk_bf16_f32 v144, v144, v145
    v_cvt_pk_bf16_f32 v145, v146, v147
    v_mfma_f32_16x16x32_bf16 v[176:179], a[240:243], v[40:43], v[176:179]
    ds_read_b64_tr_b16 a[242:243], v9 offset:4096
    v_add_f32 v25, v25, v34
    v_cvt_pk_bf16_f32 v146, v148, v149
    v_cvt_pk_bf16_f32 v147, v150, v151
    v_mfma_f32_16x16x32_bf16 v[180:183], a[244:247], v[40:43], v[180:183]
    ds_write_b64 v20, v[144:145] offset:128
    ds_write_b64 v20, v[146:147] offset:160
    v_exp_f32 v35, v35
    v_mfma_f32_16x16x32_bf16 a[32:35], v[144:147], v[144:147], a[32:35]
    v_mul_f32 v152, v152, v30
    v_mul_f32 v153, v153, v30
    v_mul_f32 v154, v154, v30
    v_mul_f32 v155, v155, v30
    v_mul_f32 v156, v156, v30
    v_mul_f32 v157, v157, v30
    v_mfma_f32_16x16x32_bf16 v[184:187], a[248:251], v[40:43], v[184:187]
    v_cvt_pk_bf16_f32 v33, v34, v35
    v_add_f32 v25, v25, v35
    v_mul_f32 v158, v158, v30
    v_mul_f32 v159, v159, v30
    v_cvt_pk_bf16_f32 v152, v152, v153
    v_cvt_pk_bf16_f32 v153, v154, v155
    v_cvt_pk_bf16_f32 v154, v156, v157
    v_cvt_pk_bf16_f32 v155, v158, v159
    v_mfma_f32_16x16x32_bf16 v[188:191], a[252:255], v[40:43], v[188:191]
    ds_read_b64_tr_b16 a[240:241], v9 offset:0
    ds_read_b64_tr_b16 a[246:247], v10 offset:4096
    ds_read_b64_tr_b16 a[252:253], v12 offset:0
    v_exp_f32 v36, v36
    v_mfma_f32_16x16x32_bf16 v[40:43], a[192:195], a[176:179], 0
    ds_write_b64 v20, v[152:153] offset:192
    ds_write_b64 v20, v[154:155] offset:224
    v_add_f32 v25, v25, v36
    v_mfma_f32_16x16x32_bf16 a[32:35], v[152:155], v[152:155], a[32:35]
    v_mfma_f32_16x16x32_bf16 v[40:43], a[196:199], a[180:183], v[40:43]
    ds_read_b128 v[132:135], v19 offset:0
    ds_read_b128 v[140:143], v19 offset:1088
    ds_read_b128 v[148:151], v19 offset:2176
    ds_read_b128 v[156:159], v19 offset:3264
    v_exp_f32 v37, v37
    s_nop 1
    v_accvgpr_read_b32 v29, a32
    v_sub_f32 v29, v29, v29
    v_accvgpr_read_b32 v31, a33
    v_fma_f32 v29, v31, 0, v29
    v_accvgpr_read_b32 v31, a34
    v_fma_f32 v29, v31, 0, v29
    v_accvgpr_read_b32 v31, a35
    v_fma_f32 v29, v31, 0, v29
    v_cmp_u_f32 vcc, v29, v29
    v_mfma_f32_16x16x32_bf16 v[40:43], a[200:203], a[184:187], v[40:43]
    s_nop 0
    s_or_b64 s[44:45], s[44:45], vcc
    s_add_u32 s54, s47, 0x1a000
    s_waitcnt lgkmcnt(3)
    buffer_store_dwordx4 v[132:135], v27, s[20:23], s54 offen offset:0 sc1
    s_waitcnt lgkmcnt(2)
    buffer_store_dwordx4 v[140:143], v27, s[20:23], s54 offen offset:1024 sc1
    s_waitcnt lgkmcnt(1)
    buffer_store_dwordx4 v[148:151], v27, s[20:23], s54 offen offset:2048 sc1
    s_waitcnt lgkmcnt(0)
    buffer_store_dwordx4 v[156:159], v27, s[20:23], s54 offen offset:3072 sc1
    v_cvt_pk_bf16_f32 v34, v36, v37
    v_add_f32 v25, v25, v37
    v_mfma_f32_16x16x32_bf16 v[40:43], a[204:207], a[188:191], v[40:43]
    v_exp_f32 v38, v38
    v_mov_b32 v29, v24
    s_nop 1
    v_permlane16_swap_b32 v24, v29
    v_add_f32 v24, v24, v29
    v_mov_b32 v29, v24
    v_mfma_f32_16x16x32_bf16 v[44:47], a[208:211], a[176:179], 0
    v_add_f32 v25, v25, v38
    v_permlane32_swap_b32 v24, v29
    v_add_f32 v24, v24, v29
    v_rcp_f32 v30, v24
    v_cmp_ngt_f32 vcc, s29, v24
    v_mfma_f32_16x16x32_bf16 v[44:47], a[212:215], a[180:183], v[44:47]
    ds_read_b64_tr_b16 a[244:245], v10 offset:0
    ds_read_b64_tr_b16 a[248:249], v11 offset:0
    ds_read_b64_tr_b16 a[254:255], v12 offset:4096
    ds_read_b128 a[208:211], v1 offset:12288
    v_exp_f32 v39, v39
    v_mfma_f32_16x16x32_bf16 v[44:47], a[216:219], a[184:187], v[44:47]
    ds_read_b64_tr_b16 a[250:251], v11 offset:4096
    ds_read_b128 a[192:195], v1 offset:8192
    s_or_b64 s[44:45], s[44:45], vcc
    v_cvt_pk_bf16_f32 v35, v38, v39
    v_add_f32 v25, v25, v39
    v_cmp_nle_f32 vcc, s36, v24
    v_mfma_f32_16x16x32_bf16 v[44:47], a[220:223], a[188:191], v[44:47]
    s_nop 0
    s_or_b64 s[44:45], s[44:45], vcc
    v_exp_f32 v40, v40
    v_mul_f32 v160, v160, v30
    v_mul_f32 v161, v161, v30
    v_mul_f32 v162, v162, v30
    v_mul_f32 v163, v163, v30
    v_mul_f32 v164, v164, v30
    v_mul_f32 v165, v165, v30
    v_mul_f32 v166, v166, v30
    v_mul_f32 v167, v167, v30
    v_mfma_f32_16x16x32_bf16 v[192:195], v[48:51], v[32:35], v[192:195]
    v_add_f32 v26, v26, v40
    v_cvt_pk_bf16_f32 v160, v160, v161
    v_cvt_pk_bf16_f32 v161, v162, v163
    v_cvt_pk_bf16_f32 v162, v164, v165
    v_cvt_pk_bf16_f32 v163, v166, v167
    v_mfma_f32_16x16x32_bf16 v[196:199], v[52:55], v[32:35], v[196:199]
    ds_read_b128 a[196:199], v2 offset:8192
    ds_read_b128 a[200:203], v3 offset:8192
    ds_read_b128 a[204:207], v4 offset:8192
    v_exp_f32 v41, v41
    v_mfma_f32_16x16x32_bf16 v[200:203], v[56:59], v[32:35], v[200:203]
    ds_write_b64 v20, v[160:161] offset:0
    ds_write_b64 v20, v[162:163] offset:32
    v_cvt_pk_bf16_f32 v40, v40, v41
    v_add_f32 v26, v26, v41
    v_mfma_f32_16x16x32_bf16 a[48:51], v[160:163], v[160:163], 0
    v_mul_f32 v168, v168, v30
    v_mul_f32 v169, v169, v30
    v_mul_f32 v170, v170, v30
    v_mul_f32 v171, v171, v30
    v_mfma_f32_16x16x32_bf16 v[204:207], v[60:63], v[32:35], v[204:207]
    s_waitcnt lgkmcnt(6)
    v_exp_f32 v42, v42
    v_mul_f32 v172, v172, v30
    v_mul_f32 v173, v173, v30
    v_mul_f32 v174, v174, v30
    v_mul_f32 v175, v175, v30
    v_mfma_f32_16x16x32_bf16 v[208:211], a[240:243], v[32:35], v[208:211]
    v_add_f32 v26, v26, v42
    v_cvt_pk_bf16_f32 v168, v168, v169
    v_cvt_pk_bf16_f32 v169, v170, v171
    v_cvt_pk_bf16_f32 v170, v172, v173
    v_cvt_pk_bf16_f32 v171, v174, v175
    v_mfma_f32_16x16x32_bf16 v[212:215], a[244:247], v[32:35], v[212:215]
    ds_read_b128 a[212:215], v2 offset:12288
    ds_read_b128 a[216:219], v3 offset:12288
    ds_read_b128 a[220:223], v4 offset:12288
    v_exp_f32 v43, v43
    v_mfma_f32_16x16x32_bf16 v[216:219], a[248:251], v[32:35], v[216:219]
    ds_write_b64 v20, v[168:169] offset:64
    ds_write_b64 v20, v[170:171] offset:96
    v_cvt_pk_bf16_f32 v41, v42, v43
    v_add_f32 v26, v26, v43
    v_mfma_f32_16x16x32_bf16 a[48:51], v[168:171], v[168:171], a[48:51]
    v_mul_f32 v176, v176, v30
    v_mul_f32 v177, v177, v30
    v_mul_f32 v178, v178, v30
    v_mul_f32 v179, v179, v30
    v_mfma_f32_16x16x32_bf16 v[220:223], a[252:255], v[32:35], v[220:223]
    s_waitcnt lgkmcnt(7)
    v_exp_f32 v44, v44
    v_mul_f32 v180, v180, v30
    v_mul_f32 v181, v181, v30
    v_mul_f32 v182, v182, v30
    v_mul_f32 v183, v183, v30
    v_mfma_f32_16x16x32_bf16 v[32:35], a[192:195], a[160:163], 0
    v_add_f32 v26, v26, v44
    v_cvt_pk_bf16_f32 v176, v176, v177
    v_cvt_pk_bf16_f32 v177, v178, v179
    v_cvt_pk_bf16_f32 v178, v180, v181
    v_cvt_pk_bf16_f32 v179, v182, v183
    v_mfma_f32_16x16x32_bf16 v[32:35], a[196:199], a[164:167], v[32:35]
    v_exp_f32 v45, v45
    v_mfma_f32_16x16x32_bf16 v[32:35], a[200:203], a[168:171], v[32:35]
    ds_write_b64 v20, v[176:177] offset:128
    ds_write_b64 v20, v[178:179] offset:160
    v_cvt_pk_bf16_f32 v42, v44, v45
    v_add_f32 v26, v26, v45
    v_mfma_f32_16x16x32_bf16 a[48:51], v[176:179], v[176:179], a[48:51]
    v_mul_f32 v184, v184, v30
    v_mul_f32 v185, v185, v30
    v_mul_f32 v186, v186, v30
    v_mul_f32 v187, v187, v30
    v_mfma_f32_16x16x32_bf16 v[32:35], a[204:207], a[172:175], v[32:35]
    s_waitcnt lgkmcnt(4)
    v_exp_f32 v46, v46
    v_mul_f32 v188, v188, v30
    v_mul_f32 v189, v189, v30
    v_mul_f32 v190, v190, v30
    v_mul_f32 v191, v191, v30
    v_mfma_f32_16x16x32_bf16 v[36:39], a[208:211], a[160:163], 0
    v_add_f32 v26, v26, v46
    v_cvt_pk_bf16_f32 v184, v184, v185
    v_cvt_pk_bf16_f32 v185, v186, v187
    v_cvt_pk_bf16_f32 v186, v188, v189
    v_cvt_pk_bf16_f32 v187, v190, v191
    v_mfma_f32_16x16x32_bf16 v[36:39], a[212:215], a[164:167], v[36:39]
    v_exp_f32 v47, v47
    v_mfma_f32_16x16x32_bf16 v[36:39], a[216:219], a[168:171], v[36:39]
    ds_write_b64 v20, v[184:185] offset:192
    ds_write_b64 v20, v[186:187] offset:224
    v_cvt_pk_bf16_f32 v43, v46, v47
    v_add_f32 v26, v26, v47
    v_mfma_f32_16x16x32_bf16 a[48:51], v[184:187], v[184:187], a[48:51]
    v_mfma_f32_16x16x32_bf16 v[36:39], a[220:223], a[172:175], v[36:39]
    ds_read_b128 v[164:167], v19 offset:0
    ds_read_b128 v[172:175], v19 offset:1088
    ds_read_b128 v[180:183], v19 offset:2176
    ds_read_b128 v[188:191], v19 offset:3264
    v_exp_f32 v32, v32
    s_nop 1
    v_accvgpr_read_b32 v29, a48
    v_sub_f32 v29, v29, v29
    v_accvgpr_read_b32 v31, a49
    v_fma_f32 v29, v31, 0, v29
    v_mfma_f32_16x16x32_bf16 v[224:227], v[48:51], v[40:43], v[224:227]
    v_add_f32 v25, v25, v32
    v_accvgpr_read_b32 v31, a50
    v_fma_f32 v29, v31, 0, v29
    v_accvgpr_read_b32 v31, a51
    v_fma_f32 v29, v31, 0, v29
    v_mfma_f32_16x16x32_bf16 v[228:231], v[52:55], v[40:43], v[228:231]
    v_exp_f32 v33, v33
    v_cmp_u_f32 vcc, v29, v29
    v_mfma_f32_16x16x32_bf16 v[232:235], v[56:59], v[40:43], v[232:235]
    s_nop 0
    s_or_b64 s[44:45], s[44:45], vcc
    s_add_u32 s54, s47, 0x1b000
    s_waitcnt lgkmcnt(3)
    buffer_store_dwordx4 v[164:167], v27, s[20:23], s54 offen offset:0 sc1
    s_waitcnt lgkmcnt(2)
    buffer_store_dwordx4 v[172:175], v27, s[20:23], s54 offen offset:1024 sc1
    s_waitcnt lgkmcnt(1)
    buffer_store_dwordx4 v[180:183], v27, s[20:23], s54 offen offset:2048 sc1
    s_waitcnt lgkmcnt(0)
    buffer_store_dwordx4 v[188:191], v27, s[20:23], s54 offen offset:3072 sc1
    v_cvt_pk_bf16_f32 v32, v32, v33
    v_add_f32 v25, v25, v33
    v_mfma_f32_16x16x32_bf16 v[236:239], v[60:63], v[40:43], v[236:239]
    v_exp_f32 v34, v34
    v_mfma_f32_16x16x32_bf16 v[240:243], a[240:243], v[40:43], v[240:243]
    ds_read_b64_tr_b16 a[240:241], v9 offset:8192
    v_add_f32 v25, v25, v34
    v_mfma_f32_16x16x32_bf16 v[244:247], a[244:247], v[40:43], v[244:247]
    ds_read_b64_tr_b16 a[246:247], v10 offset:12288
    v_exp_f32 v35, v35
    v_mfma_f32_16x16x32_bf16 v[248:251], a[248:251], v[40:43], v[248:251]
    ds_read_b64_tr_b16 a[248:249], v11 offset:8192
    v_cvt_pk_bf16_f32 v33, v34, v35
    v_add_f32 v25, v25, v35
    v_mfma_f32_16x16x32_bf16 v[252:255], a[252:255], v[40:43], v[252:255]
    ds_read_b64_tr_b16 a[250:251], v11 offset:12288
    v_exp_f32 v36, v36
    v_mfma_f32_16x16x32_bf16 v[40:43], a[192:195], a[176:179], 0
    ds_read_b64_tr_b16 a[242:243], v9 offset:12288
    ds_read_b64_tr_b16 a[252:253], v12 offset:8192
    v_add_f32 v25, v25, v36
    v_mfma_f32_16x16x32_bf16 v[40:43], a[196:199], a[180:183], v[40:43]
    ds_read_b64_tr_b16 a[254:255], v12 offset:12288
    v_exp_f32 v37, v37
    v_mfma_f32_16x16x32_bf16 v[40:43], a[200:203], a[184:187], v[40:43]
    v_cvt_pk_bf16_f32 v34, v36, v37
    v_add_f32 v25, v25, v37
    v_mfma_f32_16x16x32_bf16 v[40:43], a[204:207], a[188:191], v[40:43]
    v_exp_f32 v38, v38
    v_mfma_f32_16x16x32_bf16 v[44:47], a[208:211], a[176:179], 0
    ds_read_b64_tr_b16 a[244:245], v10 offset:8192
    v_add_f32 v25, v25, v38
    v_mfma_f32_16x16x32_bf16 v[44:47], a[212:215], a[180:183], v[44:47]
    v_exp_f32 v39, v39
    v_mfma_f32_16x16x32_bf16 v[44:47], a[216:219], a[184:187], v[44:47]
    v_cvt_pk_bf16_f32 v35, v38, v39
    v_add_f32 v25, v25, v39
    v_mfma_f32_16x16x32_bf16 v[44:47], a[220:223], a[188:191], v[44:47]
    v_exp_f32 v40, v40
    v_mfma_f32_16x16x32_bf16 v[192:195], a[224:227], v[32:35], v[192:195]
    v_exp_f32 v41, v41
    v_add_f32 v26, v26, v40
    v_mfma_f32_16x16x32_bf16 v[196:199], a[228:231], v[32:35], v[196:199]
    v_cvt_pk_bf16_f32 v40, v40, v41
    v_exp_f32 v42, v42
    v_add_f32 v26, v26, v41
    v_mfma_f32_16x16x32_bf16 v[200:203], a[232:235], v[32:35], v[200:203]
    v_exp_f32 v43, v43
    v_add_f32 v26, v26, v42
    v_mfma_f32_16x16x32_bf16 v[204:207], a[236:239], v[32:35], v[204:207]
    s_waitcnt lgkmcnt(0)
    v_cvt_pk_bf16_f32 v41, v42, v43
    v_exp_f32 v44, v44
    v_add_f32 v26, v26, v43
    v_mfma_f32_16x16x32_bf16 v[208:211], a[240:243], v[32:35], v[208:211]
    v_exp_f32 v45, v45
    v_add_f32 v26, v26, v44
    v_mfma_f32_16x16x32_bf16 v[212:215], a[244:247], v[32:35], v[212:215]
    v_cvt_pk_bf16_f32 v42, v44, v45
    v_exp_f32 v46, v46
    v_add_f32 v26, v26, v45
    v_mfma_f32_16x16x32_bf16 v[216:219], a[248:251], v[32:35], v[216:219]
    v_exp_f32 v47, v47
    v_add_f32 v26, v26, v46
    v_mfma_f32_16x16x32_bf16 v[220:223], a[252:255], v[32:35], v[220:223]
    v_cvt_pk_bf16_f32 v43, v46, v47
    v_add_f32 v26, v26, v47
    v_mov_b32 v29, v25
    s_nop 1
    v_permlane16_swap_b32 v25, v29
    v_add_f32 v25, v25, v29
    v_mov_b32 v29, v25
    s_nop 1
    v_permlane32_swap_b32 v25, v29
    v_add_f32 v25, v25, v29
    v_rcp_f32 v30, v25
    v_cmp_ngt_f32 vcc, s29, v25
    s_nop 1
    s_or_b64 s[44:45], s[44:45], vcc
    v_cmp_nle_f32 vcc, s36, v25
    s_nop 1
    s_or_b64 s[44:45], s[44:45], vcc
    v_pk_mul_f32 v[192:193], v[192:193], v[30:31] op_sel_hi:[1,0]
    v_pk_mul_f32 v[194:195], v[194:195], v[30:31] op_sel_hi:[1,0]
    v_pk_mul_f32 v[196:197], v[196:197], v[30:31] op_sel_hi:[1,0]
    v_pk_mul_f32 v[198:199], v[198:199], v[30:31] op_sel_hi:[1,0]
    v_cvt_pk_bf16_f32 v192, v192, v193
    v_cvt_pk_bf16_f32 v193, v194, v195
    v_cvt_pk_bf16_f32 v194, v196, v197
    v_cvt_pk_bf16_f32 v195, v198, v199
    v_mfma_f32_16x16x32_bf16 v[224:227], a[224:227], v[40:43], v[224:227]
    ds_write_b64 v20, v[192:193] offset:0
    ds_write_b64 v20, v[194:195] offset:32
    v_mfma_f32_16x16x32_bf16 a[64:67], v[192:195], v[192:195], 0
    v_pk_mul_f32 v[200:201], v[200:201], v[30:31] op_sel_hi:[1,0]
    v_pk_mul_f32 v[202:203], v[202:203], v[30:31] op_sel_hi:[1,0]
    v_pk_mul_f32 v[204:205], v[204:205], v[30:31] op_sel_hi:[1,0]
    v_pk_mul_f32 v[206:207], v[206:207], v[30:31] op_sel_hi:[1,0]
    v_cvt_pk_bf16_f32 v200, v200, v201
    v_cvt_pk_bf16_f32 v201, v202, v203
    v_mfma_f32_16x16x32_bf16 v[228:231], a[228:231], v[40:43], v[228:231]
    v_cvt_pk_bf16_f32 v202, v204, v205
    v_cvt_pk_bf16_f32 v203, v206, v207
    v_mfma_f32_16x16x32_bf16 v[232:235], a[232:235], v[40:43], v[232:235]
    ds_write_b64 v20, v[200:201] offset:64
    ds_write_b64 v20, v[202:203] offset:96
    v_mfma_f32_16x16x32_bf16 a[64:67], v[200:203], v[200:203], a[64:67]
    v_pk_mul_f32 v[208:209], v[208:209], v[30:31] op_sel_hi:[1,0]
    v_pk_mul_f32 v[210:211], v[210:211], v[30:31] op_sel_hi:[1,0]
    v_pk_mul_f32 v[212:213], v[212:213], v[30:31] op_sel_hi:[1,0]
    v_pk_mul_f32 v[214:215], v[214:215], v[30:31] op_sel_hi:[1,0]
    v_mfma_f32_16x16x32_bf16 v[236:239], a[236:239], v[40:43], v[236:239]
    v_cvt_pk_bf16_f32 v208, v208, v209
    v_cvt_pk_bf16_f32 v209, v210, v211
    v_cvt_pk_bf16_f32 v210, v212, v213
    v_cvt_pk_bf16_f32 v211, v214, v215
    v_mfma_f32_16x16x32_bf16 v[240:243], a[240:243], v[40:43], v[240:243]
    ds_write_b64 v20, v[208:209] offset:128
    ds_write_b64 v20, v[210:211] offset:160
    v_mfma_f32_16x16x32_bf16 a[64:67], v[208:211], v[208:211], a[64:67]
    v_pk_mul_f32 v[216:217], v[216:217], v[30:31] op_sel_hi:[1,0]
    v_pk_mul_f32 v[218:219], v[218:219], v[30:31] op_sel_hi:[1,0]
    v_pk_mul_f32 v[220:221], v[220:221], v[30:31] op_sel_hi:[1,0]
    v_mfma_f32_16x16x32_bf16 v[244:247], a[244:247], v[40:43], v[244:247]
    v_pk_mul_f32 v[222:223], v[222:223], v[30:31] op_sel_hi:[1,0]
    v_cvt_pk_bf16_f32 v216, v216, v217
    v_cvt_pk_bf16_f32 v217, v218, v219
    v_cvt_pk_bf16_f32 v218, v220, v221
    v_mfma_f32_16x16x32_bf16 v[248:251], a[248:251], v[40:43], v[248:251]
    v_cvt_pk_bf16_f32 v219, v222, v223
    v_mfma_f32_16x16x32_bf16 v[252:255], a[252:255], v[40:43], v[252:255]
    ds_write_b64 v20, v[216:217] offset:192
    ds_write_b64 v20, v[218:219] offset:224
    v_mfma_f32_16x16x32_bf16 a[64:67], v[216:219], v[216:219], a[64:67]
    ds_read_b128 v[196:199], v19 offset:0
    ds_read_b128 v[204:207], v19 offset:1088
    ds_read_b128 v[212:215], v19 offset:2176
    ds_read_b128 v[220:223], v19 offset:3264
    s_nop 3
    v_accvgpr_read_b32 v29, a64
    v_sub_f32 v29, v29, v29
    v_accvgpr_read_b32 v31, a65
    v_fma_f32 v29, v31, 0, v29
    v_accvgpr_read_b32 v31, a66
    v_fma_f32 v29, v31, 0, v29
    v_accvgpr_read_b32 v31, a67
    v_fma_f32 v29, v31, 0, v29
    v_cmp_u_f32 vcc, v29, v29
    s_nop 1
    s_or_b64 s[44:45], s[44:45], vcc
    s_add_u32 s54, s47, 0x1c000
    s_waitcnt lgkmcnt(3)
    buffer_store_dwordx4 v[196:199], v27, s[20:23], s54 offen offset:0 sc1
    s_waitcnt lgkmcnt(2)
    buffer_store_dwordx4 v[204:207], v27, s[20:23], s54 offen offset:1024 sc1
    s_waitcnt lgkmcnt(1)
    buffer_store_dwordx4 v[212:215], v27, s[20:23], s54 offen offset:2048 sc1
    s_waitcnt lgkmcnt(0)
    buffer_store_dwordx4 v[220:223], v27, s[20:23], s54 offen offset:3072 sc1
    v_mov_b32 v29, v26
    s_nop 1
    v_permlane16_swap_b32 v26, v29
    v_add_f32 v26, v26, v29
    v_mov_b32 v29, v26
    s_nop 1
    v_permlane32_swap_b32 v26, v29
    v_add_f32 v26, v26, v29
    v_rcp_f32 v30, v26
    v_cmp_ngt_f32 vcc, s29, v26
    s_nop 1
    s_or_b64 s[44:45], s[44:45], vcc
    v_cmp_nle_f32 vcc, s36, v26
    s_nop 1
    s_or_b64 s[44:45], s[44:45], vcc
    v_pk_mul_f32 v[224:225], v[224:225], v[30:31] op_sel_hi:[1,0]
    v_pk_mul_f32 v[226:227], v[226:227], v[30:31] op_sel_hi:[1,0]
    v_pk_mul_f32 v[228:229], v[228:229], v[30:31] op_sel_hi:[1,0]
    v_pk_mul_f32 v[230:231], v[230:231], v[30:31] op_sel_hi:[1,0]
    v_cvt_pk_bf16_f32 v224, v224, v225
    v_cvt_pk_bf16_f32 v225, v226, v227
    v_cvt_pk_bf16_f32 v226, v228, v229
    v_cvt_pk_bf16_f32 v227, v230, v231
    ds_write_b64 v20, v[224:225] offset:0
    ds_write_b64 v20, v[226:227] offset:32
    v_mfma_f32_16x16x32_bf16 a[80:83], v[224:227], v[224:227], 0
    v_pk_mul_f32 v[232:233], v[232:233], v[30:31] op_sel_hi:[1,0]
    v_pk_mul_f32 v[234:235], v[234:235], v[30:31] op_sel_hi:[1,0]
    v_pk_mul_f32 v[236:237], v[236:237], v[30:31] op_sel_hi:[1,0]
    v_pk_mul_f32 v[238:239], v[238:239], v[30:31] op_sel_hi:[1,0]
    v_cvt_pk_bf16_f32 v232, v232, v233
    v_cvt_pk_bf16_f32 v233, v234, v235
    v_cvt_pk_bf16_f32 v234, v236, v237
    v_cvt_pk_bf16_f32 v235, v238, v239
    ds_write_b64 v20, v[232:233] offset:64
    ds_write_b64 v20, v[234:235] offset:96
    v_mfma_f32_16x16x32_bf16 a[80:83], v[232:235], v[232:235], a[80:83]
    v_pk_mul_f32 v[240:241], v[240:241], v[30:31] op_sel_hi:[1,0]
    v_pk_mul_f32 v[242:243], v[242:243], v[30:31] op_sel_hi:[1,0]
    v_pk_mul_f32 v[244:245], v[244:245], v[30:31] op_sel_hi:[1,0]
    v_pk_mul_f32 v[246:247], v[246:247], v[30:31] op_sel_hi:[1,0]
    v_cvt_pk_bf16_f32 v240, v240, v241
    v_cvt_pk_bf16_f32 v241, v242, v243
    v_cvt_pk_bf16_f32 v242, v244, v245
    v_cvt_pk_bf16_f32 v243, v246, v247
    ds_write_b64 v20, v[240:241] offset:128
    ds_write_b64 v20, v[242:243] offset:160
    v_mfma_f32_16x16x32_bf16 a[80:83], v[240:243], v[240:243], a[80:83]
    v_pk_mul_f32 v[248:249], v[248:249], v[30:31] op_sel_hi:[1,0]
    v_pk_mul_f32 v[250:251], v[250:251], v[30:31] op_sel_hi:[1,0]
    v_pk_mul_f32 v[252:253], v[252:253], v[30:31] op_sel_hi:[1,0]
    v_pk_mul_f32 v[254:255], v[254:255], v[30:31] op_sel_hi:[1,0]
    v_cvt_pk_bf16_f32 v248, v248, v249
    v_cvt_pk_bf16_f32 v249, v250, v251
    v_cvt_pk_bf16_f32 v250, v252, v253
    v_cvt_pk_bf16_f32 v251, v254, v255
    ds_write_b64 v20, v[248:249] offset:192
    ds_write_b64 v20, v[250:251] offset:224
    v_mfma_f32_16x16x32_bf16 a[80:83], v[248:251], v[248:251], a[80:83]
    ds_read_b128 v[228:231], v19 offset:0
    ds_read_b128 v[236:239], v19 offset:1088
    ds_read_b128 v[244:247], v19 offset:2176
    ds_read_b128 v[252:255], v19 offset:3264
    s_nop 3
    v_accvgpr_read_b32 v29, a80
    v_sub_f32 v29, v29, v29
    v_accvgpr_read_b32 v31, a81
    v_fma_f32 v29, v31, 0, v29
    v_accvgpr_read_b32 v31, a82
    v_fma_f32 v29, v31, 0, v29
    v_accvgpr_read_b32 v31, a83
    v_fma_f32 v29, v31, 0, v29
    v_cmp_u_f32 vcc, v29, v29
    s_nop 1
    s_or_b64 s[44:45], s[44:45], vcc
    s_add_u32 s54, s47, 0x1d000
    s_waitcnt lgkmcnt(3)
    buffer_store_dwordx4 v[228:231], v27, s[20:23], s54 offen offset:0 sc1
    s_waitcnt lgkmcnt(2)
    buffer_store_dwordx4 v[236:239], v27, s[20:23], s54 offen offset:1024 sc1
    s_waitcnt lgkmcnt(1)
    buffer_store_dwordx4 v[244:247], v27, s[20:23], s54 offen offset:2048 sc1
    s_waitcnt lgkmcnt(0)
    buffer_store_dwordx4 v[252:255], v27, s[20:23], s54 offen offset:3072 sc1
    s_cmp_lg_u64 s[42:43], 0
    s_cselect_b32 s60, 1, 0
    s_cmp_lg_u64 s[44:45], 0
    s_cselect_b32 s61, 2, 0
    s_or_b32 s60, s60, s61
    v_mov_b32 v32, s60
    v_mov_b32 v33, s48
    ds_write_b32 v33, v32
    v_mov_b32 v33, 0x20000
    s_waitcnt lgkmcnt(0)
    s_barrier
    ds_read_b32 v36, v33 offset:0
    ds_read_b32 v37, v33 offset:8192
    ds_read_b32 v38, v33 offset:16384
    ds_read_b32 v39, v33 offset:24576
    s_waitcnt lgkmcnt(0)
    v_or_b32 v36, v36, v37
    v_or_b32 v38, v38, v39
    v_or_b32 v36, v36, v38
    s_nop 1
    v_readfirstlane_b32 s60, v36
    s_nop 3
    s_cmp_eq_u32 s60, 0
    s_cbranch_scc0 L_safe
L_end:
    s_endpgm
L_hookd0:
    s_add_u32 s80, s80, 1
    s_cmp_eq_u32 s80, 1
    s_cbranch_scc1 L_hook0_0
    s_cmp_eq_u32 s80, 2
    s_cbranch_scc1 L_hook0_1
    s_cmp_eq_u32 s80, 3
    s_cbranch_scc1 L_hook0_2
    s_cmp_eq_u32 s80, 4
    s_cbranch_scc1 L_hook0_3
    s_cmp_eq_u32 s80, 5
    s_cbranch_scc1 L_hook0_4
L_hook0_5:
    s_waitcnt vmcnt(18)
    v_mbcnt_lo_u32_b32 v60, -1, 0
    v_mbcnt_hi_u32_b32 v60, -1, v60
    v_lshrrev_b32 v61, 4, v60
    v_xor_b32 v61, v61, v60
    v_and_b32 v61, 7, v61
    v_and_b32 v60, 15, v60
    v_lshlrev_b32 v60, 8, v60
    v_lshl_add_u32 v60, v61, 4, v60
    v_add_u32 v60, s48, v60
    v_xor_b32 v48, 0, v60
    ds_read_b128 v[48:51], v48 offset:4096
    v_xor_b32 v52, 64, v60
    ds_read_b128 v[52:55], v52 offset:4096
    v_xor_b32 v56, 128, v60
    ds_read_b128 v[56:59], v56 offset:4096
    v_xor_b32 v60, 192, v60
    ds_read_b128 v[60:63], v60 offset:4096
    s_waitcnt lgkmcnt(3)
    v_lshlrev_b32 v28, 16, v48
    v_lshlrev_b32 v30, 16, v49
    v_and_b32 v29, s59, v48
    v_and_b32 v31, s59, v49
    v_pk_mul_f32 v[28:29], v[28:29], s[56:57]
    v_pk_mul_f32 v[30:31], v[30:31], s[56:57]
    v_cvt_pk_bf16_f32 v48, v28, v29
    v_cvt_pk_bf16_f32 v49, v30, v31
    v_accvgpr_write_b32 a176, v48
    v_accvgpr_write_b32 a177, v49
    v_lshlrev_b32 v28, 16, v50
    v_lshlrev_b32 v30, 16, v51
    v_and_b32 v29, s59, v50
    v_and_b32 v31, s59, v51
    v_pk_mul_f32 v[28:29], v[28:29], s[56:57]
    v_pk_mul_f32 v[30:31], v[30:31], s[56:57]
    v_cvt_pk_bf16_f32 v50, v28, v29
    v_cvt_pk_bf16_f32 v51, v30, v31
    v_accvgpr_write_b32 a178, v50
    v_accvgpr_write_b32 a179, v51
    s_waitcnt lgkmcnt(2)
    v_lshlrev_b32 v28, 16, v52
    v_lshlrev_b32 v30, 16, v53
    v_and_b32 v29, s59, v52
    v_and_b32 v31, s59, v53
    v_pk_mul_f32 v[28:29], v[28:29], s[56:57]
    v_pk_mul_f32 v[30:31], v[30:31], s[56:57]
    v_cvt_pk_bf16_f32 v52, v28, v29
    v_cvt_pk_bf16_f32 v53, v30, v31
    v_accvgpr_write_b32 a180, v52
    v_accvgpr_write_b32 a181, v53
    v_lshlrev_b32 v28, 16, v54
    v_lshlrev_b32 v30, 16, v55
    v_and_b32 v29, s59, v54
    v_and_b32 v31, s59, v55
    v_pk_mul_f32 v[28:29], v[28:29], s[56:57]
    v_pk_mul_f32 v[30:31], v[30:31], s[56:57]
    v_cvt_pk_bf16_f32 v54, v28, v29
    v_cvt_pk_bf16_f32 v55, v30, v31
    v_accvgpr_write_b32 a182, v54
    v_accvgpr_write_b32 a183, v55
    s_waitcnt lgkmcnt(1)
    v_lshlrev_b32 v28, 16, v56
    v_lshlrev_b32 v30, 16, v57
    v_and_b32 v29, s59, v56
    v_and_b32 v31, s59, v57
    v_pk_mul_f32 v[28:29], v[28:29], s[56:57]
    v_pk_mul_f32 v[30:31], v[30:31], s[56:57]
    v_cvt_pk_bf16_f32 v56, v28, v29
    v_cvt_pk_bf16_f32 v57, v30, v31
    v_accvgpr_write_b32 a184, v56
    v_accvgpr_write_b32 a185, v57
    v_lshlrev_b32 v28, 16, v58
    v_lshlrev_b32 v30, 16, v59
    v_and_b32 v29, s59, v58
    v_and_b32 v31, s59, v59
    v_pk_mul_f32 v[28:29], v[28:29], s[56:57]
    v_pk_mul_f32 v[30:31], v[30:31], s[56:57]
    v_cvt_pk_bf16_f32 v58, v28, v29
    v_cvt_pk_bf16_f32 v59, v30, v31
    v_accvgpr_write_b32 a186, v58
    v_accvgpr_write_b32 a187, v59
    s_waitcnt lgkmcnt(0)
    v_lshlrev_b32 v28, 16, v60
    v_lshlrev_b32 v30, 16, v61
    v_and_b32 v29, s59, v60
    v_and_b32 v31, s59, v61
    v_pk_mul_f32 v[28:29], v[28:29], s[56:57]
    v_pk_mul_f32 v[30:31], v[30:31], s[56:57]
    v_cvt_pk_bf16_f32 v60, v28, v29
    v_cvt_pk_bf16_f32 v61, v30, v31
    v_accvgpr_write_b32 a188, v60
    v_accvgpr_write_b32 a189, v61
    v_lshlrev_b32 v28, 16, v62
    v_lshlrev_b32 v30, 16, v63
    v_and_b32 v29, s59, v62
    v_and_b32 v31, s59, v63
    v_pk_mul_f32 v[28:29], v[28:29], s[56:57]
    v_pk_mul_f32 v[30:31], v[30:31], s[56:57]
    v_cvt_pk_bf16_f32 v62, v28, v29
    v_cvt_pk_bf16_f32 v63, v30, v31
    v_accvgpr_write_b32 a190, v62
    v_accvgpr_write_b32 a191, v63
    s_add_u32 m0, s48, 0
    s_add_u32 s49, s52, L_trans-standalone__mha_softmax__near_ridge_kernel+0
    buffer_load_dwordx4 v27, s[92:95], s49 offen offset:0 lds
    buffer_load_dwordx4 v27, s[92:95], s49 offen offset:1024 lds
    buffer_load_dwordx4 v27, s[92:95], s49 offen offset:2048 lds
    buffer_load_dwordx4 v27, s[92:95], s49 offen offset:3072 lds
    s_add_u32 m0, s48, 4096
    s_add_u32 s49, s52, L_trans-standalone__mha_softmax__near_ridge_kernel+16384
    buffer_load_dwordx4 v27, s[92:95], s49 offen offset:0 lds
    buffer_load_dwordx4 v27, s[92:95], s49 offen offset:1024 lds
    buffer_load_dwordx4 v27, s[92:95], s49 offen offset:2048 lds
    buffer_load_dwordx4 v27, s[92:95], s49 offen offset:3072 lds
    s_branch L_hookret0
L_hook0_0:
    s_waitcnt vmcnt(18)
    v_mbcnt_lo_u32_b32 v60, -1, 0
    v_mbcnt_hi_u32_b32 v60, -1, v60
    v_lshrrev_b32 v61, 4, v60
    v_xor_b32 v61, v61, v60
    v_and_b32 v61, 7, v61
    v_and_b32 v60, 15, v60
    v_lshlrev_b32 v60, 8, v60
    v_lshl_add_u32 v60, v61, 4, v60
    v_add_u32 v60, s48, v60
    v_xor_b32 v48, 0, v60
    ds_read_b128 v[48:51], v48 offset:0
    v_xor_b32 v52, 64, v60
    ds_read_b128 v[52:55], v52 offset:0
    v_xor_b32 v56, 128, v60
    ds_read_b128 v[56:59], v56 offset:0
    v_xor_b32 v60, 192, v60
    ds_read_b128 v[60:63], v60 offset:0
    s_waitcnt lgkmcnt(3)
    v_lshlrev_b32 v28, 16, v48
    v_lshlrev_b32 v30, 16, v49
    v_and_b32 v29, s59, v48
    v_and_b32 v31, s59, v49
    v_pk_mul_f32 v[28:29], v[28:29], s[56:57]
    v_pk_mul_f32 v[30:31], v[30:31], s[56:57]
    v_cvt_pk_bf16_f32 v48, v28, v29
    v_cvt_pk_bf16_f32 v49, v30, v31
    v_accvgpr_write_b32 a96, v48
    v_accvgpr_write_b32 a97, v49
    v_lshlrev_b32 v28, 16, v50
    v_lshlrev_b32 v30, 16, v51
    v_and_b32 v29, s59, v50
    v_and_b32 v31, s59, v51
    v_pk_mul_f32 v[28:29], v[28:29], s[56:57]
    v_pk_mul_f32 v[30:31], v[30:31], s[56:57]
    v_cvt_pk_bf16_f32 v50, v28, v29
    v_cvt_pk_bf16_f32 v51, v30, v31
    v_accvgpr_write_b32 a98, v50
    v_accvgpr_write_b32 a99, v51
    s_waitcnt lgkmcnt(2)
    v_lshlrev_b32 v28, 16, v52
    v_lshlrev_b32 v30, 16, v53
    v_and_b32 v29, s59, v52
    v_and_b32 v31, s59, v53
    v_pk_mul_f32 v[28:29], v[28:29], s[56:57]
    v_pk_mul_f32 v[30:31], v[30:31], s[56:57]
    v_cvt_pk_bf16_f32 v52, v28, v29
    v_cvt_pk_bf16_f32 v53, v30, v31
    v_accvgpr_write_b32 a100, v52
    v_accvgpr_write_b32 a101, v53
    v_lshlrev_b32 v28, 16, v54
    v_lshlrev_b32 v30, 16, v55
    v_and_b32 v29, s59, v54
    v_and_b32 v31, s59, v55
    v_pk_mul_f32 v[28:29], v[28:29], s[56:57]
    v_pk_mul_f32 v[30:31], v[30:31], s[56:57]
    v_cvt_pk_bf16_f32 v54, v28, v29
    v_cvt_pk_bf16_f32 v55, v30, v31
    v_accvgpr_write_b32 a102, v54
    v_accvgpr_write_b32 a103, v55
    s_waitcnt lgkmcnt(1)
    v_lshlrev_b32 v28, 16, v56
    v_lshlrev_b32 v30, 16, v57
    v_and_b32 v29, s59, v56
    v_and_b32 v31, s59, v57
    v_pk_mul_f32 v[28:29], v[28:29], s[56:57]
    v_pk_mul_f32 v[30:31], v[30:31], s[56:57]
    v_cvt_pk_bf16_f32 v56, v28, v29
    v_cvt_pk_bf16_f32 v57, v30, v31
    v_accvgpr_write_b32 a104, v56
    v_accvgpr_write_b32 a105, v57
    v_lshlrev_b32 v28, 16, v58
    v_lshlrev_b32 v30, 16, v59
    v_and_b32 v29, s59, v58
    v_and_b32 v31, s59, v59
    v_pk_mul_f32 v[28:29], v[28:29], s[56:57]
    v_pk_mul_f32 v[30:31], v[30:31], s[56:57]
    v_cvt_pk_bf16_f32 v58, v28, v29
    v_cvt_pk_bf16_f32 v59, v30, v31
    v_accvgpr_write_b32 a106, v58
    v_accvgpr_write_b32 a107, v59
    s_waitcnt lgkmcnt(0)
    v_lshlrev_b32 v28, 16, v60
    v_lshlrev_b32 v30, 16, v61
    v_and_b32 v29, s59, v60
    v_and_b32 v31, s59, v61
    v_pk_mul_f32 v[28:29], v[28:29], s[56:57]
    v_pk_mul_f32 v[30:31], v[30:31], s[56:57]
    v_cvt_pk_bf16_f32 v60, v28, v29
    v_cvt_pk_bf16_f32 v61, v30, v31
    v_accvgpr_write_b32 a108, v60
    v_accvgpr_write_b32 a109, v61
    v_lshlrev_b32 v28, 16, v62
    v_lshlrev_b32 v30, 16, v63
    v_and_b32 v29, s59, v62
    v_and_b32 v31, s59, v63
    v_pk_mul_f32 v[28:29], v[28:29], s[56:57]
    v_pk_mul_f32 v[30:31], v[30:31], s[56:57]
    v_cvt_pk_bf16_f32 v62, v28, v29
    v_cvt_pk_bf16_f32 v63, v30, v31
    v_accvgpr_write_b32 a110, v62
    v_accvgpr_write_b32 a111, v63
    s_branch L_hookret0
L_hook0_1:
    s_waitcnt vmcnt(18)
    v_mbcnt_lo_u32_b32 v60, -1, 0
    v_mbcnt_hi_u32_b32 v60, -1, v60
    v_lshrrev_b32 v61, 4, v60
    v_xor_b32 v61, v61, v60
    v_and_b32 v61, 7, v61
    v_and_b32 v60, 15, v60
    v_lshlrev_b32 v60, 8, v60
    v_lshl_add_u32 v60, v61, 4, v60
    v_add_u32 v60, s48, v60
    v_xor_b32 v48, 0, v60
    ds_read_b128 v[48:51], v48 offset:4096
    v_xor_b32 v52, 64, v60
    ds_read_b128 v[52:55], v52 offset:4096
    v_xor_b32 v56, 128, v60
    ds_read_b128 v[56:59], v56 offset:4096
    v_xor_b32 v60, 192, v60
    ds_read_b128 v[60:63], v60 offset:4096
    s_waitcnt lgkmcnt(3)
    v_lshlrev_b32 v28, 16, v48
    v_lshlrev_b32 v30, 16, v49
    v_and_b32 v29, s59, v48
    v_and_b32 v31, s59, v49
    v_pk_mul_f32 v[28:29], v[28:29], s[56:57]
    v_pk_mul_f32 v[30:31], v[30:31], s[56:57]
    v_cvt_pk_bf16_f32 v48, v28, v29
    v_cvt_pk_bf16_f32 v49, v30, v31
    v_accvgpr_write_b32 a112, v48
    v_accvgpr_write_b32 a113, v49
    v_lshlrev_b32 v28, 16, v50
    v_lshlrev_b32 v30, 16, v51
    v_and_b32 v29, s59, v50
    v_and_b32 v31, s59, v51
    v_pk_mul_f32 v[28:29], v[28:29], s[56:57]
    v_pk_mul_f32 v[30:31], v[30:31], s[56:57]
    v_cvt_pk_bf16_f32 v50, v28, v29
    v_cvt_pk_bf16_f32 v51, v30, v31
    v_accvgpr_write_b32 a114, v50
    v_accvgpr_write_b32 a115, v51
    s_waitcnt lgkmcnt(2)
    v_lshlrev_b32 v28, 16, v52
    v_lshlrev_b32 v30, 16, v53
    v_and_b32 v29, s59, v52
    v_and_b32 v31, s59, v53
    v_pk_mul_f32 v[28:29], v[28:29], s[56:57]
    v_pk_mul_f32 v[30:31], v[30:31], s[56:57]
    v_cvt_pk_bf16_f32 v52, v28, v29
    v_cvt_pk_bf16_f32 v53, v30, v31
    v_accvgpr_write_b32 a116, v52
    v_accvgpr_write_b32 a117, v53
    v_lshlrev_b32 v28, 16, v54
    v_lshlrev_b32 v30, 16, v55
    v_and_b32 v29, s59, v54
    v_and_b32 v31, s59, v55
    v_pk_mul_f32 v[28:29], v[28:29], s[56:57]
    v_pk_mul_f32 v[30:31], v[30:31], s[56:57]
    v_cvt_pk_bf16_f32 v54, v28, v29
    v_cvt_pk_bf16_f32 v55, v30, v31
    v_accvgpr_write_b32 a118, v54
    v_accvgpr_write_b32 a119, v55
    s_waitcnt lgkmcnt(1)
    v_lshlrev_b32 v28, 16, v56
    v_lshlrev_b32 v30, 16, v57
    v_and_b32 v29, s59, v56
    v_and_b32 v31, s59, v57
    v_pk_mul_f32 v[28:29], v[28:29], s[56:57]
    v_pk_mul_f32 v[30:31], v[30:31], s[56:57]
    v_cvt_pk_bf16_f32 v56, v28, v29
    v_cvt_pk_bf16_f32 v57, v30, v31
    v_accvgpr_write_b32 a120, v56
    v_accvgpr_write_b32 a121, v57
    v_lshlrev_b32 v28, 16, v58
    v_lshlrev_b32 v30, 16, v59
    v_and_b32 v29, s59, v58
    v_and_b32 v31, s59, v59
    v_pk_mul_f32 v[28:29], v[28:29], s[56:57]
    v_pk_mul_f32 v[30:31], v[30:31], s[56:57]
    v_cvt_pk_bf16_f32 v58, v28, v29
    v_cvt_pk_bf16_f32 v59, v30, v31
    v_accvgpr_write_b32 a122, v58
    v_accvgpr_write_b32 a123, v59
    s_waitcnt lgkmcnt(0)
    v_lshlrev_b32 v28, 16, v60
    v_lshlrev_b32 v30, 16, v61
    v_and_b32 v29, s59, v60
    v_and_b32 v31, s59, v61
    v_pk_mul_f32 v[28:29], v[28:29], s[56:57]
    v_pk_mul_f32 v[30:31], v[30:31], s[56:57]
    v_cvt_pk_bf16_f32 v60, v28, v29
    v_cvt_pk_bf16_f32 v61, v30, v31
    v_accvgpr_write_b32 a124, v60
    v_accvgpr_write_b32 a125, v61
    v_lshlrev_b32 v28, 16, v62
    v_lshlrev_b32 v30, 16, v63
    v_and_b32 v29, s59, v62
    v_and_b32 v31, s59, v63
    v_pk_mul_f32 v[28:29], v[28:29], s[56:57]
    v_pk_mul_f32 v[30:31], v[30:31], s[56:57]
    v_cvt_pk_bf16_f32 v62, v28, v29
    v_cvt_pk_bf16_f32 v63, v30, v31
    v_accvgpr_write_b32 a126, v62
    v_accvgpr_write_b32 a127, v63
    s_branch L_hookret0
L_hook0_2:
    s_waitcnt vmcnt(18)
    v_mbcnt_lo_u32_b32 v60, -1, 0
    v_mbcnt_hi_u32_b32 v60, -1, v60
    v_lshrrev_b32 v61, 4, v60
    v_xor_b32 v61, v61, v60
    v_and_b32 v61, 7, v61
    v_and_b32 v60, 15, v60
    v_lshlrev_b32 v60, 8, v60
    v_lshl_add_u32 v60, v61, 4, v60
    v_add_u32 v60, s48, v60
    v_xor_b32 v48, 0, v60
    ds_read_b128 v[48:51], v48 offset:0
    v_xor_b32 v52, 64, v60
    ds_read_b128 v[52:55], v52 offset:0
    v_xor_b32 v56, 128, v60
    ds_read_b128 v[56:59], v56 offset:0
    v_xor_b32 v60, 192, v60
    ds_read_b128 v[60:63], v60 offset:0
    s_waitcnt lgkmcnt(3)
    v_lshlrev_b32 v28, 16, v48
    v_lshlrev_b32 v30, 16, v49
    v_and_b32 v29, s59, v48
    v_and_b32 v31, s59, v49
    v_pk_mul_f32 v[28:29], v[28:29], s[56:57]
    v_pk_mul_f32 v[30:31], v[30:31], s[56:57]
    v_cvt_pk_bf16_f32 v48, v28, v29
    v_cvt_pk_bf16_f32 v49, v30, v31
    v_accvgpr_write_b32 a128, v48
    v_accvgpr_write_b32 a129, v49
    v_lshlrev_b32 v28, 16, v50
    v_lshlrev_b32 v30, 16, v51
    v_and_b32 v29, s59, v50
    v_and_b32 v31, s59, v51
    v_pk_mul_f32 v[28:29], v[28:29], s[56:57]
    v_pk_mul_f32 v[30:31], v[30:31], s[56:57]
    v_cvt_pk_bf16_f32 v50, v28, v29
    v_cvt_pk_bf16_f32 v51, v30, v31
    v_accvgpr_write_b32 a130, v50
    v_accvgpr_write_b32 a131, v51
    s_waitcnt lgkmcnt(2)
    v_lshlrev_b32 v28, 16, v52
    v_lshlrev_b32 v30, 16, v53
    v_and_b32 v29, s59, v52
    v_and_b32 v31, s59, v53
    v_pk_mul_f32 v[28:29], v[28:29], s[56:57]
    v_pk_mul_f32 v[30:31], v[30:31], s[56:57]
    v_cvt_pk_bf16_f32 v52, v28, v29
    v_cvt_pk_bf16_f32 v53, v30, v31
    v_accvgpr_write_b32 a132, v52
    v_accvgpr_write_b32 a133, v53
    v_lshlrev_b32 v28, 16, v54
    v_lshlrev_b32 v30, 16, v55
    v_and_b32 v29, s59, v54
    v_and_b32 v31, s59, v55
    v_pk_mul_f32 v[28:29], v[28:29], s[56:57]
    v_pk_mul_f32 v[30:31], v[30:31], s[56:57]
    v_cvt_pk_bf16_f32 v54, v28, v29
    v_cvt_pk_bf16_f32 v55, v30, v31
    v_accvgpr_write_b32 a134, v54
    v_accvgpr_write_b32 a135, v55
    s_waitcnt lgkmcnt(1)
    v_lshlrev_b32 v28, 16, v56
    v_lshlrev_b32 v30, 16, v57
    v_and_b32 v29, s59, v56
    v_and_b32 v31, s59, v57
    v_pk_mul_f32 v[28:29], v[28:29], s[56:57]
    v_pk_mul_f32 v[30:31], v[30:31], s[56:57]
    v_cvt_pk_bf16_f32 v56, v28, v29
    v_cvt_pk_bf16_f32 v57, v30, v31
    v_accvgpr_write_b32 a136, v56
    v_accvgpr_write_b32 a137, v57
    v_lshlrev_b32 v28, 16, v58
    v_lshlrev_b32 v30, 16, v59
    v_and_b32 v29, s59, v58
    v_and_b32 v31, s59, v59
    v_pk_mul_f32 v[28:29], v[28:29], s[56:57]
    v_pk_mul_f32 v[30:31], v[30:31], s[56:57]
    v_cvt_pk_bf16_f32 v58, v28, v29
    v_cvt_pk_bf16_f32 v59, v30, v31
    v_accvgpr_write_b32 a138, v58
    v_accvgpr_write_b32 a139, v59
    s_waitcnt lgkmcnt(0)
    v_lshlrev_b32 v28, 16, v60
    v_lshlrev_b32 v30, 16, v61
    v_and_b32 v29, s59, v60
    v_and_b32 v31, s59, v61
    v_pk_mul_f32 v[28:29], v[28:29], s[56:57]
    v_pk_mul_f32 v[30:31], v[30:31], s[56:57]
    v_cvt_pk_bf16_f32 v60, v28, v29
    v_cvt_pk_bf16_f32 v61, v30, v31
    v_accvgpr_write_b32 a140, v60
    v_accvgpr_write_b32 a141, v61
    v_lshlrev_b32 v28, 16, v62
    v_lshlrev_b32 v30, 16, v63
    v_and_b32 v29, s59, v62
    v_and_b32 v31, s59, v63
    v_pk_mul_f32 v[28:29], v[28:29], s[56:57]
    v_pk_mul_f32 v[30:31], v[30:31], s[56:57]
    v_cvt_pk_bf16_f32 v62, v28, v29
    v_cvt_pk_bf16_f32 v63, v30, v31
    v_accvgpr_write_b32 a142, v62
    v_accvgpr_write_b32 a143, v63
    s_branch L_hookret0
L_hook0_3:
    s_waitcnt vmcnt(18)
    v_mbcnt_lo_u32_b32 v60, -1, 0
    v_mbcnt_hi_u32_b32 v60, -1, v60
    v_lshrrev_b32 v61, 4, v60
    v_xor_b32 v61, v61, v60
    v_and_b32 v61, 7, v61
    v_and_b32 v60, 15, v60
    v_lshlrev_b32 v60, 8, v60
    v_lshl_add_u32 v60, v61, 4, v60
    v_add_u32 v60, s48, v60
    v_xor_b32 v48, 0, v60
    ds_read_b128 v[48:51], v48 offset:4096
    v_xor_b32 v52, 64, v60
    ds_read_b128 v[52:55], v52 offset:4096
    v_xor_b32 v56, 128, v60
    ds_read_b128 v[56:59], v56 offset:4096
    v_xor_b32 v60, 192, v60
    ds_read_b128 v[60:63], v60 offset:4096
    s_waitcnt lgkmcnt(3)
    v_lshlrev_b32 v28, 16, v48
    v_lshlrev_b32 v30, 16, v49
    v_and_b32 v29, s59, v48
    v_and_b32 v31, s59, v49
    v_pk_mul_f32 v[28:29], v[28:29], s[56:57]
    v_pk_mul_f32 v[30:31], v[30:31], s[56:57]
    v_cvt_pk_bf16_f32 v48, v28, v29
    v_cvt_pk_bf16_f32 v49, v30, v31
    v_accvgpr_write_b32 a144, v48
    v_accvgpr_write_b32 a145, v49
    v_lshlrev_b32 v28, 16, v50
    v_lshlrev_b32 v30, 16, v51
    v_and_b32 v29, s59, v50
    v_and_b32 v31, s59, v51
    v_pk_mul_f32 v[28:29], v[28:29], s[56:57]
    v_pk_mul_f32 v[30:31], v[30:31], s[56:57]
    v_cvt_pk_bf16_f32 v50, v28, v29
    v_cvt_pk_bf16_f32 v51, v30, v31
    v_accvgpr_write_b32 a146, v50
    v_accvgpr_write_b32 a147, v51
    s_waitcnt lgkmcnt(2)
    v_lshlrev_b32 v28, 16, v52
    v_lshlrev_b32 v30, 16, v53
    v_and_b32 v29, s59, v52
    v_and_b32 v31, s59, v53
    v_pk_mul_f32 v[28:29], v[28:29], s[56:57]
    v_pk_mul_f32 v[30:31], v[30:31], s[56:57]
    v_cvt_pk_bf16_f32 v52, v28, v29
    v_cvt_pk_bf16_f32 v53, v30, v31
    v_accvgpr_write_b32 a148, v52
    v_accvgpr_write_b32 a149, v53
    v_lshlrev_b32 v28, 16, v54
    v_lshlrev_b32 v30, 16, v55
    v_and_b32 v29, s59, v54
    v_and_b32 v31, s59, v55
    v_pk_mul_f32 v[28:29], v[28:29], s[56:57]
    v_pk_mul_f32 v[30:31], v[30:31], s[56:57]
    v_cvt_pk_bf16_f32 v54, v28, v29
    v_cvt_pk_bf16_f32 v55, v30, v31
    v_accvgpr_write_b32 a150, v54
    v_accvgpr_write_b32 a151, v55
    s_waitcnt lgkmcnt(1)
    v_lshlrev_b32 v28, 16, v56
    v_lshlrev_b32 v30, 16, v57
    v_and_b32 v29, s59, v56
    v_and_b32 v31, s59, v57
    v_pk_mul_f32 v[28:29], v[28:29], s[56:57]
    v_pk_mul_f32 v[30:31], v[30:31], s[56:57]
    v_cvt_pk_bf16_f32 v56, v28, v29
    v_cvt_pk_bf16_f32 v57, v30, v31
    v_accvgpr_write_b32 a152, v56
    v_accvgpr_write_b32 a153, v57
    v_lshlrev_b32 v28, 16, v58
    v_lshlrev_b32 v30, 16, v59
    v_and_b32 v29, s59, v58
    v_and_b32 v31, s59, v59
    v_pk_mul_f32 v[28:29], v[28:29], s[56:57]
    v_pk_mul_f32 v[30:31], v[30:31], s[56:57]
    v_cvt_pk_bf16_f32 v58, v28, v29
    v_cvt_pk_bf16_f32 v59, v30, v31
    v_accvgpr_write_b32 a154, v58
    v_accvgpr_write_b32 a155, v59
    s_waitcnt lgkmcnt(0)
    v_lshlrev_b32 v28, 16, v60
    v_lshlrev_b32 v30, 16, v61
    v_and_b32 v29, s59, v60
    v_and_b32 v31, s59, v61
    v_pk_mul_f32 v[28:29], v[28:29], s[56:57]
    v_pk_mul_f32 v[30:31], v[30:31], s[56:57]
    v_cvt_pk_bf16_f32 v60, v28, v29
    v_cvt_pk_bf16_f32 v61, v30, v31
    v_accvgpr_write_b32 a156, v60
    v_accvgpr_write_b32 a157, v61
    v_lshlrev_b32 v28, 16, v62
    v_lshlrev_b32 v30, 16, v63
    v_and_b32 v29, s59, v62
    v_and_b32 v31, s59, v63
    v_pk_mul_f32 v[28:29], v[28:29], s[56:57]
    v_pk_mul_f32 v[30:31], v[30:31], s[56:57]
    v_cvt_pk_bf16_f32 v62, v28, v29
    v_cvt_pk_bf16_f32 v63, v30, v31
    v_accvgpr_write_b32 a158, v62
    v_accvgpr_write_b32 a159, v63
    s_branch L_hookret0
L_hook0_4:
    s_waitcnt vmcnt(18)
    v_mbcnt_lo_u32_b32 v60, -1, 0
    v_mbcnt_hi_u32_b32 v60, -1, v60
    v_lshrrev_b32 v61, 4, v60
    v_xor_b32 v61, v61, v60
    v_and_b32 v61, 7, v61
    v_and_b32 v60, 15, v60
    v_lshlrev_b32 v60, 8, v60
    v_lshl_add_u32 v60, v61, 4, v60
    v_add_u32 v60, s48, v60
    v_xor_b32 v48, 0, v60
    ds_read_b128 v[48:51], v48 offset:0
    v_xor_b32 v52, 64, v60
    ds_read_b128 v[52:55], v52 offset:0
    v_xor_b32 v56, 128, v60
    ds_read_b128 v[56:59], v56 offset:0
    v_xor_b32 v60, 192, v60
    ds_read_b128 v[60:63], v60 offset:0
    s_waitcnt lgkmcnt(3)
    v_lshlrev_b32 v28, 16, v48
    v_lshlrev_b32 v30, 16, v49
    v_and_b32 v29, s59, v48
    v_and_b32 v31, s59, v49
    v_pk_mul_f32 v[28:29], v[28:29], s[56:57]
    v_pk_mul_f32 v[30:31], v[30:31], s[56:57]
    v_cvt_pk_bf16_f32 v48, v28, v29
    v_cvt_pk_bf16_f32 v49, v30, v31
    v_accvgpr_write_b32 a160, v48
    v_accvgpr_write_b32 a161, v49
    v_lshlrev_b32 v28, 16, v50
    v_lshlrev_b32 v30, 16, v51
    v_and_b32 v29, s59, v50
    v_and_b32 v31, s59, v51
    v_pk_mul_f32 v[28:29], v[28:29], s[56:57]
    v_pk_mul_f32 v[30:31], v[30:31], s[56:57]
    v_cvt_pk_bf16_f32 v50, v28, v29
    v_cvt_pk_bf16_f32 v51, v30, v31
    v_accvgpr_write_b32 a162, v50
    v_accvgpr_write_b32 a163, v51
    s_waitcnt lgkmcnt(2)
    v_lshlrev_b32 v28, 16, v52
    v_lshlrev_b32 v30, 16, v53
    v_and_b32 v29, s59, v52
    v_and_b32 v31, s59, v53
    v_pk_mul_f32 v[28:29], v[28:29], s[56:57]
    v_pk_mul_f32 v[30:31], v[30:31], s[56:57]
    v_cvt_pk_bf16_f32 v52, v28, v29
    v_cvt_pk_bf16_f32 v53, v30, v31
    v_accvgpr_write_b32 a164, v52
    v_accvgpr_write_b32 a165, v53
    v_lshlrev_b32 v28, 16, v54
    v_lshlrev_b32 v30, 16, v55
    v_and_b32 v29, s59, v54
    v_and_b32 v31, s59, v55
    v_pk_mul_f32 v[28:29], v[28:29], s[56:57]
    v_pk_mul_f32 v[30:31], v[30:31], s[56:57]
    v_cvt_pk_bf16_f32 v54, v28, v29
    v_cvt_pk_bf16_f32 v55, v30, v31
    v_accvgpr_write_b32 a166, v54
    v_accvgpr_write_b32 a167, v55
    s_waitcnt lgkmcnt(1)
    v_lshlrev_b32 v28, 16, v56
    v_lshlrev_b32 v30, 16, v57
    v_and_b32 v29, s59, v56
    v_and_b32 v31, s59, v57
    v_pk_mul_f32 v[28:29], v[28:29], s[56:57]
    v_pk_mul_f32 v[30:31], v[30:31], s[56:57]
    v_cvt_pk_bf16_f32 v56, v28, v29
    v_cvt_pk_bf16_f32 v57, v30, v31
    v_accvgpr_write_b32 a168, v56
    v_accvgpr_write_b32 a169, v57
    v_lshlrev_b32 v28, 16, v58
    v_lshlrev_b32 v30, 16, v59
    v_and_b32 v29, s59, v58
    v_and_b32 v31, s59, v59
    v_pk_mul_f32 v[28:29], v[28:29], s[56:57]
    v_pk_mul_f32 v[30:31], v[30:31], s[56:57]
    v_cvt_pk_bf16_f32 v58, v28, v29
    v_cvt_pk_bf16_f32 v59, v30, v31
    v_accvgpr_write_b32 a170, v58
    v_accvgpr_write_b32 a171, v59
    s_waitcnt lgkmcnt(0)
    v_lshlrev_b32 v28, 16, v60
    v_lshlrev_b32 v30, 16, v61
    v_and_b32 v29, s59, v60
    v_and_b32 v31, s59, v61
    v_pk_mul_f32 v[28:29], v[28:29], s[56:57]
    v_pk_mul_f32 v[30:31], v[30:31], s[56:57]
    v_cvt_pk_bf16_f32 v60, v28, v29
    v_cvt_pk_bf16_f32 v61, v30, v31
    v_accvgpr_write_b32 a172, v60
    v_accvgpr_write_b32 a173, v61
    v_lshlrev_b32 v28, 16, v62
    v_lshlrev_b32 v30, 16, v63
    v_and_b32 v29, s59, v62
    v_and_b32 v31, s59, v63
    v_pk_mul_f32 v[28:29], v[28:29], s[56:57]
    v_pk_mul_f32 v[30:31], v[30:31], s[56:57]
    v_cvt_pk_bf16_f32 v62, v28, v29
    v_cvt_pk_bf16_f32 v63, v30, v31
    v_accvgpr_write_b32 a174, v62
    v_accvgpr_write_b32 a175, v63
    s_branch L_hookret0
L_hookd1:
    s_add_u32 s80, s80, 1
    s_cmp_eq_u32 s80, 1
    s_cbranch_scc1 L_hook1_0
    s_cmp_eq_u32 s80, 2
    s_cbranch_scc1 L_hook1_1
    s_cmp_eq_u32 s80, 3
    s_cbranch_scc1 L_hook1_2
    s_cmp_eq_u32 s80, 4
    s_cbranch_scc1 L_hook1_3
    s_cmp_eq_u32 s80, 5
    s_cbranch_scc1 L_hook1_4
    s_cmp_eq_u32 s80, 6
    s_cbranch_scc1 L_hook1_5
L_hook1_6:
    s_add_u32 m0, s48, 0
    s_add_u32 s49, s52, L_tail-standalone__mha_softmax__near_ridge_kernel+0
    buffer_load_dwordx4 v27, s[92:95], s49 offen offset:0 lds
    buffer_load_dwordx4 v27, s[92:95], s49 offen offset:1024 lds
    buffer_load_dwordx4 v27, s[92:95], s49 offen offset:2048 lds
    buffer_load_dwordx4 v27, s[92:95], s49 offen offset:3072 lds
    s_add_u32 m0, s48, 4096
    s_add_u32 s49, s52, L_tail-standalone__mha_softmax__near_ridge_kernel+16384
    buffer_load_dwordx4 v27, s[92:95], s49 offen offset:0 lds
    buffer_load_dwordx4 v27, s[92:95], s49 offen offset:1024 lds
    buffer_load_dwordx4 v27, s[92:95], s49 offen offset:2048 lds
    buffer_load_dwordx4 v27, s[92:95], s49 offen offset:3072 lds
    s_branch L_hookret1
L_hook1_0:
    s_add_u32 s54, s47, 0x0
    buffer_store_dwordx4 a[0:3], v27, s[20:23], s54 offen offset:0 sc1
    buffer_store_dwordx4 a[4:7], v27, s[20:23], s54 offen offset:1024 sc1
    buffer_store_dwordx4 a[8:11], v27, s[20:23], s54 offen offset:2048 sc1
    buffer_store_dwordx4 a[12:15], v27, s[20:23], s54 offen offset:3072 sc1
    s_branch L_hookret1
L_hook1_1:
    s_add_u32 s54, s47, 0x1000
    buffer_store_dwordx4 a[16:19], v27, s[20:23], s54 offen offset:0 sc1
    buffer_store_dwordx4 a[20:23], v27, s[20:23], s54 offen offset:1024 sc1
    buffer_store_dwordx4 a[24:27], v27, s[20:23], s54 offen offset:2048 sc1
    buffer_store_dwordx4 a[28:31], v27, s[20:23], s54 offen offset:3072 sc1
    s_branch L_hookret1
L_hook1_2:
    s_add_u32 s54, s47, 0x2000
    buffer_store_dwordx4 a[32:35], v27, s[20:23], s54 offen offset:0 sc1
    buffer_store_dwordx4 a[36:39], v27, s[20:23], s54 offen offset:1024 sc1
    buffer_store_dwordx4 a[40:43], v27, s[20:23], s54 offen offset:2048 sc1
    buffer_store_dwordx4 a[44:47], v27, s[20:23], s54 offen offset:3072 sc1
    s_branch L_hookret1
L_hook1_3:
    s_add_u32 s54, s47, 0x3000
    buffer_store_dwordx4 a[48:51], v27, s[20:23], s54 offen offset:0 sc1
    buffer_store_dwordx4 a[52:55], v27, s[20:23], s54 offen offset:1024 sc1
    buffer_store_dwordx4 a[56:59], v27, s[20:23], s54 offen offset:2048 sc1
    buffer_store_dwordx4 a[60:63], v27, s[20:23], s54 offen offset:3072 sc1
    s_branch L_hookret1
L_hook1_4:
    s_add_u32 s54, s47, 0x4000
    buffer_store_dwordx4 a[64:67], v27, s[20:23], s54 offen offset:0 sc1
    buffer_store_dwordx4 a[68:71], v27, s[20:23], s54 offen offset:1024 sc1
    buffer_store_dwordx4 a[72:75], v27, s[20:23], s54 offen offset:2048 sc1
    buffer_store_dwordx4 a[76:79], v27, s[20:23], s54 offen offset:3072 sc1
    s_branch L_hookret1
L_hook1_5:
    s_add_u32 s54, s47, 0x5000
    buffer_store_dwordx4 a[80:83], v27, s[20:23], s54 offen offset:0 sc1
    buffer_store_dwordx4 a[84:87], v27, s[20:23], s54 offen offset:1024 sc1
    buffer_store_dwordx4 a[88:91], v27, s[20:23], s54 offen offset:2048 sc1
    buffer_store_dwordx4 a[92:95], v27, s[20:23], s54 offen offset:3072 sc1
    s_branch L_hookret1
L_fast_end:
L_safe:
    s_waitcnt vmcnt(0)
    v_and_b32 v32, 63, v0
    v_lshrrev_b32 v33, 6, v0
    v_and_b32 v34, 31, v32
    v_lshrrev_b32 v35, 5, v32
    v_and_b32 v36, 15, v32
    v_lshrrev_b32 v37, 4, v32
    v_lshlrev_b32 v38, 8, v34
    v_add_u32 v39, 0, v35
    v_xor_b32 v39, v39, v36
    v_lshl_add_u32 v1, v39, 4, v38
    v_add_u32 v39, 2, v35
    v_xor_b32 v39, v39, v36
    v_lshl_add_u32 v2, v39, 4, v38
    v_add_u32 v39, 4, v35
    v_xor_b32 v39, v39, v36
    v_lshl_add_u32 v3, v39, 4, v38
    v_add_u32 v39, 6, v35
    v_xor_b32 v39, v39, v36
    v_lshl_add_u32 v4, v39, 4, v38
    v_add_u32 v39, 8, v35
    v_xor_b32 v39, v39, v36
    v_lshl_add_u32 v5, v39, 4, v38
    v_add_u32 v39, 10, v35
    v_xor_b32 v39, v39, v36
    v_lshl_add_u32 v6, v39, 4, v38
    v_add_u32 v39, 12, v35
    v_xor_b32 v39, v39, v36
    v_lshl_add_u32 v7, v39, 4, v38
    v_add_u32 v39, 14, v35
    v_xor_b32 v39, v39, v36
    v_lshl_add_u32 v8, v39, 4, v38
    v_lshrrev_b32 v40, 2, v36
    v_and_b32 v41, 3, v36
    v_and_b32 v42, 1, v41
    v_lshlrev_b32 v42, 1, v42
    v_lshrrev_b32 v43, 1, v41
    v_or_b32 v42, v42, v43
    v_lshlrev_b32 v42, 3, v42
    v_and_b32 v43, 1, v37
    v_lshl_add_u32 v42, v43, 5, v42
    v_lshl_add_u32 v43, v35, 2, v40
    v_lshl_add_u32 v42, v43, 8, v42
    v_add_u32 v42, 0x10000, v42
    v_xor_b32 v43, 0, v40
    v_lshl_add_u32 v9, v43, 6, v42
    v_xor_b32 v43, 1, v40
    v_lshl_add_u32 v10, v43, 6, v42
    v_xor_b32 v43, 2, v40
    v_lshl_add_u32 v11, v43, 6, v42
    v_xor_b32 v43, 3, v40
    v_lshl_add_u32 v12, v43, 6, v42
    v_lshlrev_b32 v44, 8, v37
    v_xor_b32 v45, v36, v37
    v_xor_b32 v46, 0, v45
    v_lshl_add_u32 v13, v46, 4, v44
    v_xor_b32 v46, 4, v45
    v_lshl_add_u32 v14, v46, 4, v44
    v_xor_b32 v46, 8, v45
    v_lshl_add_u32 v15, v46, 4, v44
    v_xor_b32 v46, 12, v45
    v_lshl_add_u32 v16, v46, 4, v44
    v_lshlrev_b32 v46, 2, v37
    v_xor_b32 v46, v46, v36
    v_lshl_add_u32 v17, v46, 4, v44
    v_mul_u32_u24 v46, 96, v33
    v_add_u32 v46, v46, v34
    v_lshlrev_b32 v46, 8, v46
    v_lshl_add_u32 v18, v35, 4, v46
    s_mov_b32 s62, 0
L_safe_head:
    s_lshr_b32 s61, s60, s62
    s_and_b32 s61, s61, 1
    s_cmp_eq_u32 s61, 0
    s_cbranch_scc1 L_safe_next
    s_mul_i32 s63, s62, 0x18000
    s_add_u32 s64, s63, 0x2000
    s_add_u32 s65, s63, 0x4000
    buffer_load_dwordx4 a[0:3], v18, s[16:19], s63 offen offset:0
    buffer_load_dwordx4 a[4:7], v18, s[16:19], s63 offen offset:32
    buffer_load_dwordx4 a[8:11], v18, s[16:19], s63 offen offset:64
    buffer_load_dwordx4 a[12:15], v18, s[16:19], s63 offen offset:96
    buffer_load_dwordx4 a[16:19], v18, s[16:19], s63 offen offset:128
    buffer_load_dwordx4 a[20:23], v18, s[16:19], s63 offen offset:160
    buffer_load_dwordx4 a[24:27], v18, s[16:19], s63 offen offset:192
    buffer_load_dwordx4 a[28:31], v18, s[16:19], s63 offen offset:224
    buffer_load_dwordx4 a[32:35], v18, s[16:19], s64 offen offset:0
    buffer_load_dwordx4 a[36:39], v18, s[16:19], s64 offen offset:32
    buffer_load_dwordx4 a[40:43], v18, s[16:19], s64 offen offset:64
    buffer_load_dwordx4 a[44:47], v18, s[16:19], s64 offen offset:96
    buffer_load_dwordx4 a[48:51], v18, s[16:19], s64 offen offset:128
    buffer_load_dwordx4 a[52:55], v18, s[16:19], s64 offen offset:160
    buffer_load_dwordx4 a[56:59], v18, s[16:19], s64 offen offset:192
    buffer_load_dwordx4 a[60:63], v18, s[16:19], s64 offen offset:224
    buffer_load_dwordx4 a[64:67], v18, s[16:19], s65 offen offset:0
    buffer_load_dwordx4 a[68:71], v18, s[16:19], s65 offen offset:32
    buffer_load_dwordx4 a[72:75], v18, s[16:19], s65 offen offset:64
    buffer_load_dwordx4 a[76:79], v18, s[16:19], s65 offen offset:96
    buffer_load_dwordx4 a[80:83], v18, s[16:19], s65 offen offset:128
    buffer_load_dwordx4 a[84:87], v18, s[16:19], s65 offen offset:160
    buffer_load_dwordx4 a[88:91], v18, s[16:19], s65 offen offset:192
    buffer_load_dwordx4 a[92:95], v18, s[16:19], s65 offen offset:224
    v_mov_b32 v19, 0
    v_mov_b32 v22, 0xff800000
    v_mov_b32 v20, 0
    v_mov_b32 v23, 0xff800000
    v_mov_b32 v21, 0
    v_mov_b32 v24, 0xff800000
    s_mov_b32 s69, 0
L_safe_zero:
    v_mov_b32 v64, 0
    v_mov_b32 v65, 0
    v_mov_b32 v66, 0
    v_mov_b32 v67, 0
    v_mov_b32 v68, 0
    v_mov_b32 v69, 0
    v_mov_b32 v70, 0
    v_mov_b32 v71, 0
    v_mov_b32 v72, 0
    v_mov_b32 v73, 0
    v_mov_b32 v74, 0
    v_mov_b32 v75, 0
    v_mov_b32 v76, 0
    v_mov_b32 v77, 0
    v_mov_b32 v78, 0
    v_mov_b32 v79, 0
    v_mov_b32 v80, 0
    v_mov_b32 v81, 0
    v_mov_b32 v82, 0
    v_mov_b32 v83, 0
    v_mov_b32 v84, 0
    v_mov_b32 v85, 0
    v_mov_b32 v86, 0
    v_mov_b32 v87, 0
    v_mov_b32 v88, 0
    v_mov_b32 v89, 0
    v_mov_b32 v90, 0
    v_mov_b32 v91, 0
    v_mov_b32 v92, 0
    v_mov_b32 v93, 0
    v_mov_b32 v94, 0
    v_mov_b32 v95, 0
    v_mov_b32 v96, 0
    v_mov_b32 v97, 0
    v_mov_b32 v98, 0
    v_mov_b32 v99, 0
    v_mov_b32 v100, 0
    v_mov_b32 v101, 0
    v_mov_b32 v102, 0
    v_mov_b32 v103, 0
    v_mov_b32 v104, 0
    v_mov_b32 v105, 0
    v_mov_b32 v106, 0
    v_mov_b32 v107, 0
    v_mov_b32 v108, 0
    v_mov_b32 v109, 0
    v_mov_b32 v110, 0
    v_mov_b32 v111, 0
    v_mov_b32 v112, 0
    v_mov_b32 v113, 0
    v_mov_b32 v114, 0
    v_mov_b32 v115, 0
    v_mov_b32 v116, 0
    v_mov_b32 v117, 0
    v_mov_b32 v118, 0
    v_mov_b32 v119, 0
    v_mov_b32 v120, 0
    v_mov_b32 v121, 0
    v_mov_b32 v122, 0
    v_mov_b32 v123, 0
    v_mov_b32 v124, 0
    v_mov_b32 v125, 0
    v_mov_b32 v126, 0
    v_mov_b32 v127, 0
    v_mov_b32 v128, 0
    v_mov_b32 v129, 0
    v_mov_b32 v130, 0
    v_mov_b32 v131, 0
    v_mov_b32 v132, 0
    v_mov_b32 v133, 0
    v_mov_b32 v134, 0
    v_mov_b32 v135, 0
    v_mov_b32 v136, 0
    v_mov_b32 v137, 0
    v_mov_b32 v138, 0
    v_mov_b32 v139, 0
    v_mov_b32 v140, 0
    v_mov_b32 v141, 0
    v_mov_b32 v142, 0
    v_mov_b32 v143, 0
    v_mov_b32 v144, 0
    v_mov_b32 v145, 0
    v_mov_b32 v146, 0
    v_mov_b32 v147, 0
    v_mov_b32 v148, 0
    v_mov_b32 v149, 0
    v_mov_b32 v150, 0
    v_mov_b32 v151, 0
    v_mov_b32 v152, 0
    v_mov_b32 v153, 0
    v_mov_b32 v154, 0
    v_mov_b32 v155, 0
    v_mov_b32 v156, 0
    v_mov_b32 v157, 0
    v_mov_b32 v158, 0
    v_mov_b32 v159, 0
    v_mov_b32 v160, 0
    v_mov_b32 v161, 0
    v_mov_b32 v162, 0
    v_mov_b32 v163, 0
    v_mov_b32 v164, 0
    v_mov_b32 v165, 0
    v_mov_b32 v166, 0
    v_mov_b32 v167, 0
    v_mov_b32 v168, 0
    v_mov_b32 v169, 0
    v_mov_b32 v170, 0
    v_mov_b32 v171, 0
    v_mov_b32 v172, 0
    v_mov_b32 v173, 0
    v_mov_b32 v174, 0
    v_mov_b32 v175, 0
    v_mov_b32 v176, 0
    v_mov_b32 v177, 0
    v_mov_b32 v178, 0
    v_mov_b32 v179, 0
    v_mov_b32 v180, 0
    v_mov_b32 v181, 0
    v_mov_b32 v182, 0
    v_mov_b32 v183, 0
    v_mov_b32 v184, 0
    v_mov_b32 v185, 0
    v_mov_b32 v186, 0
    v_mov_b32 v187, 0
    v_mov_b32 v188, 0
    v_mov_b32 v189, 0
    v_mov_b32 v190, 0
    v_mov_b32 v191, 0
    v_mov_b32 v192, 0
    v_mov_b32 v193, 0
    v_mov_b32 v194, 0
    v_mov_b32 v195, 0
    v_mov_b32 v196, 0
    v_mov_b32 v197, 0
    v_mov_b32 v198, 0
    v_mov_b32 v199, 0
    v_mov_b32 v200, 0
    v_mov_b32 v201, 0
    v_mov_b32 v202, 0
    v_mov_b32 v203, 0
    v_mov_b32 v204, 0
    v_mov_b32 v205, 0
    v_mov_b32 v206, 0
    v_mov_b32 v207, 0
    v_mov_b32 v208, 0
    v_mov_b32 v209, 0
    v_mov_b32 v210, 0
    v_mov_b32 v211, 0
    v_mov_b32 v212, 0
    v_mov_b32 v213, 0
    v_mov_b32 v214, 0
    v_mov_b32 v215, 0
    v_mov_b32 v216, 0
    v_mov_b32 v217, 0
    v_mov_b32 v218, 0
    v_mov_b32 v219, 0
    v_mov_b32 v220, 0
    v_mov_b32 v221, 0
    v_mov_b32 v222, 0
    v_mov_b32 v223, 0
    v_mov_b32 v224, 0
    v_mov_b32 v225, 0
    v_mov_b32 v226, 0
    v_mov_b32 v227, 0
    v_mov_b32 v228, 0
    v_mov_b32 v229, 0
    v_mov_b32 v230, 0
    v_mov_b32 v231, 0
    v_mov_b32 v232, 0
    v_mov_b32 v233, 0
    v_mov_b32 v234, 0
    v_mov_b32 v235, 0
    v_mov_b32 v236, 0
    v_mov_b32 v237, 0
    v_mov_b32 v238, 0
    v_mov_b32 v239, 0
    v_mov_b32 v240, 0
    v_mov_b32 v241, 0
    v_mov_b32 v242, 0
    v_mov_b32 v243, 0
    v_mov_b32 v244, 0
    v_mov_b32 v245, 0
    v_mov_b32 v246, 0
    v_mov_b32 v247, 0
    v_mov_b32 v248, 0
    v_mov_b32 v249, 0
    v_mov_b32 v250, 0
    v_mov_b32 v251, 0
    v_mov_b32 v252, 0
    v_mov_b32 v253, 0
    v_mov_b32 v254, 0
    v_mov_b32 v255, 0
    s_lshl_b32 s66, s62, 18
    s_lshl_b32 s67, s46, 12
    s_add_u32 s66, s66, s67
    s_mov_b32 s68, 0
L_safe_stage:
    s_barrier
    s_mov_b32 m0, s67
    s_nop 0
    buffer_load_dwordx4 v13, s[8:11], s66 offen offset:0 lds
    buffer_load_dwordx4 v14, s[8:11], s66 offen offset:1024 lds
    buffer_load_dwordx4 v15, s[8:11], s66 offen offset:2048 lds
    buffer_load_dwordx4 v16, s[8:11], s66 offen offset:3072 lds
    s_add_u32 m0, s67, 0x10000
    s_nop 0
    buffer_load_dwordx4 v17, s[12:15], s66 offen offset:0 lds
    buffer_load_dwordx4 v17, s[12:15], s66 offen offset:1024 lds
    buffer_load_dwordx4 v17, s[12:15], s66 offen offset:2048 lds
    buffer_load_dwordx4 v17, s[12:15], s66 offen offset:3072 lds
    s_add_u32 s66, s66, 0x4000
    s_waitcnt vmcnt(0)
    s_barrier
    s_mov_b32 s69, 0
L_safe_tile:
    ds_read_b128 a[192:195], v1
    ds_read_b128 a[196:199], v2
    ds_read_b128 a[200:203], v3
    ds_read_b128 a[204:207], v4
    ds_read_b128 a[208:211], v5
    ds_read_b128 a[212:215], v6
    ds_read_b128 a[216:219], v7
    ds_read_b128 a[220:223], v8
    ds_read_b64_tr_b16 a[224:225], v9 offset:0
    ds_read_b64_tr_b16 a[226:227], v9 offset:2048
    ds_read_b64_tr_b16 a[228:229], v10 offset:0
    ds_read_b64_tr_b16 a[230:231], v10 offset:2048
    ds_read_b64_tr_b16 a[232:233], v11 offset:0
    ds_read_b64_tr_b16 a[234:235], v11 offset:2048
    ds_read_b64_tr_b16 a[236:237], v12 offset:0
    ds_read_b64_tr_b16 a[238:239], v12 offset:2048
    ds_read_b64_tr_b16 a[240:241], v9 offset:4096
    ds_read_b64_tr_b16 a[242:243], v9 offset:6144
    ds_read_b64_tr_b16 a[244:245], v10 offset:4096
    ds_read_b64_tr_b16 a[246:247], v10 offset:6144
    ds_read_b64_tr_b16 a[248:249], v11 offset:4096
    ds_read_b64_tr_b16 a[250:251], v11 offset:6144
    ds_read_b64_tr_b16 a[252:253], v12 offset:4096
    ds_read_b64_tr_b16 a[254:255], v12 offset:6144
    v_xor_b32 v1, 0x2000, v1
    v_xor_b32 v2, 0x2000, v2
    v_xor_b32 v3, 0x2000, v3
    v_xor_b32 v4, 0x2000, v4
    v_xor_b32 v5, 0x2000, v5
    v_xor_b32 v6, 0x2000, v6
    v_xor_b32 v7, 0x2000, v7
    v_xor_b32 v8, 0x2000, v8
    v_xor_b32 v9, 0x2000, v9
    v_xor_b32 v10, 0x2000, v10
    v_xor_b32 v11, 0x2000, v11
    v_xor_b32 v12, 0x2000, v12
    s_waitcnt lgkmcnt(0)
    v_mfma_f32_32x32x16_bf16 v[32:47], a[192:195], a[0:3], 0
    v_mfma_f32_32x32x16_bf16 v[32:47], a[196:199], a[4:7], v[32:47]
    v_mfma_f32_32x32x16_bf16 v[32:47], a[200:203], a[8:11], v[32:47]
    v_mfma_f32_32x32x16_bf16 v[32:47], a[204:207], a[12:15], v[32:47]
    v_mfma_f32_32x32x16_bf16 v[32:47], a[208:211], a[16:19], v[32:47]
    v_mfma_f32_32x32x16_bf16 v[32:47], a[212:215], a[20:23], v[32:47]
    v_mfma_f32_32x32x16_bf16 v[32:47], a[216:219], a[24:27], v[32:47]
    v_mfma_f32_32x32x16_bf16 v[32:47], a[220:223], a[28:31], v[32:47]
    s_nop 15
    v_max3_f32 v48, v32, v33, v34
    v_max3_f32 v48, v48, v35, v36
    v_max3_f32 v48, v48, v37, v38
    v_max3_f32 v48, v48, v39, v40
    v_max3_f32 v48, v48, v41, v42
    v_max3_f32 v48, v48, v43, v44
    v_max3_f32 v48, v48, v45, v46
    v_max3_f32 v48, v48, v47, v22
    v_mov_b32 v49, v48
    s_nop 1
    v_permlane32_swap_b32 v48, v49
    s_nop 1
    v_max_f32 v48, v48, v49
    v_sub_f32 v49, v22, v48
    v_mul_f32 v49, s28, v49
    v_exp_f32 v49, v49
    v_mov_b32 v22, v48
    v_mul_f32 v50, s28, v48
    v_sub_f32 v50, 0, v50
    v_mul_f32 v19, v19, v49
    v_mul_f32 v64, v64, v49
    v_mul_f32 v65, v65, v49
    v_mul_f32 v66, v66, v49
    v_mul_f32 v67, v67, v49
    v_mul_f32 v68, v68, v49
    v_mul_f32 v69, v69, v49
    v_mul_f32 v70, v70, v49
    v_mul_f32 v71, v71, v49
    v_mul_f32 v72, v72, v49
    v_mul_f32 v73, v73, v49
    v_mul_f32 v74, v74, v49
    v_mul_f32 v75, v75, v49
    v_mul_f32 v76, v76, v49
    v_mul_f32 v77, v77, v49
    v_mul_f32 v78, v78, v49
    v_mul_f32 v79, v79, v49
    v_mul_f32 v80, v80, v49
    v_mul_f32 v81, v81, v49
    v_mul_f32 v82, v82, v49
    v_mul_f32 v83, v83, v49
    v_mul_f32 v84, v84, v49
    v_mul_f32 v85, v85, v49
    v_mul_f32 v86, v86, v49
    v_mul_f32 v87, v87, v49
    v_mul_f32 v88, v88, v49
    v_mul_f32 v89, v89, v49
    v_mul_f32 v90, v90, v49
    v_mul_f32 v91, v91, v49
    v_mul_f32 v92, v92, v49
    v_mul_f32 v93, v93, v49
    v_mul_f32 v94, v94, v49
    v_mul_f32 v95, v95, v49
    v_mul_f32 v96, v96, v49
    v_mul_f32 v97, v97, v49
    v_mul_f32 v98, v98, v49
    v_mul_f32 v99, v99, v49
    v_mul_f32 v100, v100, v49
    v_mul_f32 v101, v101, v49
    v_mul_f32 v102, v102, v49
    v_mul_f32 v103, v103, v49
    v_mul_f32 v104, v104, v49
    v_mul_f32 v105, v105, v49
    v_mul_f32 v106, v106, v49
    v_mul_f32 v107, v107, v49
    v_mul_f32 v108, v108, v49
    v_mul_f32 v109, v109, v49
    v_mul_f32 v110, v110, v49
    v_mul_f32 v111, v111, v49
    v_mul_f32 v112, v112, v49
    v_mul_f32 v113, v113, v49
    v_mul_f32 v114, v114, v49
    v_mul_f32 v115, v115, v49
    v_mul_f32 v116, v116, v49
    v_mul_f32 v117, v117, v49
    v_mul_f32 v118, v118, v49
    v_mul_f32 v119, v119, v49
    v_mul_f32 v120, v120, v49
    v_mul_f32 v121, v121, v49
    v_mul_f32 v122, v122, v49
    v_mul_f32 v123, v123, v49
    v_mul_f32 v124, v124, v49
    v_mul_f32 v125, v125, v49
    v_mul_f32 v126, v126, v49
    v_mul_f32 v127, v127, v49
    v_fma_f32 v32, v32, s28, v50
    v_fma_f32 v33, v33, s28, v50
    v_fma_f32 v34, v34, s28, v50
    v_fma_f32 v35, v35, s28, v50
    v_fma_f32 v36, v36, s28, v50
    v_fma_f32 v37, v37, s28, v50
    v_fma_f32 v38, v38, s28, v50
    v_fma_f32 v39, v39, s28, v50
    v_fma_f32 v40, v40, s28, v50
    v_fma_f32 v41, v41, s28, v50
    v_fma_f32 v42, v42, s28, v50
    v_fma_f32 v43, v43, s28, v50
    v_fma_f32 v44, v44, s28, v50
    v_fma_f32 v45, v45, s28, v50
    v_fma_f32 v46, v46, s28, v50
    v_fma_f32 v47, v47, s28, v50
    v_exp_f32 v32, v32
    v_exp_f32 v33, v33
    v_exp_f32 v34, v34
    v_exp_f32 v35, v35
    v_exp_f32 v36, v36
    v_exp_f32 v37, v37
    v_exp_f32 v38, v38
    v_exp_f32 v39, v39
    v_exp_f32 v40, v40
    v_exp_f32 v41, v41
    v_exp_f32 v42, v42
    v_exp_f32 v43, v43
    v_exp_f32 v44, v44
    v_exp_f32 v45, v45
    v_exp_f32 v46, v46
    v_exp_f32 v47, v47
    s_nop 0
    v_add_f32 v19, v19, v32
    v_add_f32 v19, v19, v33
    v_add_f32 v19, v19, v34
    v_add_f32 v19, v19, v35
    v_add_f32 v19, v19, v36
    v_add_f32 v19, v19, v37
    v_add_f32 v19, v19, v38
    v_add_f32 v19, v19, v39
    v_add_f32 v19, v19, v40
    v_add_f32 v19, v19, v41
    v_add_f32 v19, v19, v42
    v_add_f32 v19, v19, v43
    v_add_f32 v19, v19, v44
    v_add_f32 v19, v19, v45
    v_add_f32 v19, v19, v46
    v_add_f32 v19, v19, v47
    v_cvt_pk_bf16_f32 v32, v32, v33
    v_cvt_pk_bf16_f32 v33, v34, v35
    v_cvt_pk_bf16_f32 v34, v36, v37
    v_cvt_pk_bf16_f32 v35, v38, v39
    v_cvt_pk_bf16_f32 v40, v40, v41
    v_cvt_pk_bf16_f32 v41, v42, v43
    v_cvt_pk_bf16_f32 v42, v44, v45
    v_cvt_pk_bf16_f32 v43, v46, v47
    s_nop 1
    v_mfma_f32_32x32x16_bf16 v[64:79], a[224:227], v[32:35], v[64:79]
    v_mfma_f32_32x32x16_bf16 v[80:95], a[228:231], v[32:35], v[80:95]
    v_mfma_f32_32x32x16_bf16 v[96:111], a[232:235], v[32:35], v[96:111]
    v_mfma_f32_32x32x16_bf16 v[112:127], a[236:239], v[32:35], v[112:127]
    v_mfma_f32_32x32x16_bf16 v[64:79], a[240:243], v[40:43], v[64:79]
    v_mfma_f32_32x32x16_bf16 v[80:95], a[244:247], v[40:43], v[80:95]
    v_mfma_f32_32x32x16_bf16 v[96:111], a[248:251], v[40:43], v[96:111]
    v_mfma_f32_32x32x16_bf16 v[112:127], a[252:255], v[40:43], v[112:127]
    s_nop 15
    v_mfma_f32_32x32x16_bf16 v[32:47], a[192:195], a[32:35], 0
    v_mfma_f32_32x32x16_bf16 v[32:47], a[196:199], a[36:39], v[32:47]
    v_mfma_f32_32x32x16_bf16 v[32:47], a[200:203], a[40:43], v[32:47]
    v_mfma_f32_32x32x16_bf16 v[32:47], a[204:207], a[44:47], v[32:47]
    v_mfma_f32_32x32x16_bf16 v[32:47], a[208:211], a[48:51], v[32:47]
    v_mfma_f32_32x32x16_bf16 v[32:47], a[212:215], a[52:55], v[32:47]
    v_mfma_f32_32x32x16_bf16 v[32:47], a[216:219], a[56:59], v[32:47]
    v_mfma_f32_32x32x16_bf16 v[32:47], a[220:223], a[60:63], v[32:47]
    s_nop 15
    v_max3_f32 v48, v32, v33, v34
    v_max3_f32 v48, v48, v35, v36
    v_max3_f32 v48, v48, v37, v38
    v_max3_f32 v48, v48, v39, v40
    v_max3_f32 v48, v48, v41, v42
    v_max3_f32 v48, v48, v43, v44
    v_max3_f32 v48, v48, v45, v46
    v_max3_f32 v48, v48, v47, v23
    v_mov_b32 v49, v48
    s_nop 1
    v_permlane32_swap_b32 v48, v49
    s_nop 1
    v_max_f32 v48, v48, v49
    v_sub_f32 v49, v23, v48
    v_mul_f32 v49, s28, v49
    v_exp_f32 v49, v49
    v_mov_b32 v23, v48
    v_mul_f32 v50, s28, v48
    v_sub_f32 v50, 0, v50
    v_mul_f32 v20, v20, v49
    v_mul_f32 v128, v128, v49
    v_mul_f32 v129, v129, v49
    v_mul_f32 v130, v130, v49
    v_mul_f32 v131, v131, v49
    v_mul_f32 v132, v132, v49
    v_mul_f32 v133, v133, v49
    v_mul_f32 v134, v134, v49
    v_mul_f32 v135, v135, v49
    v_mul_f32 v136, v136, v49
    v_mul_f32 v137, v137, v49
    v_mul_f32 v138, v138, v49
    v_mul_f32 v139, v139, v49
    v_mul_f32 v140, v140, v49
    v_mul_f32 v141, v141, v49
    v_mul_f32 v142, v142, v49
    v_mul_f32 v143, v143, v49
    v_mul_f32 v144, v144, v49
    v_mul_f32 v145, v145, v49
    v_mul_f32 v146, v146, v49
    v_mul_f32 v147, v147, v49
    v_mul_f32 v148, v148, v49
    v_mul_f32 v149, v149, v49
    v_mul_f32 v150, v150, v49
    v_mul_f32 v151, v151, v49
    v_mul_f32 v152, v152, v49
    v_mul_f32 v153, v153, v49
    v_mul_f32 v154, v154, v49
    v_mul_f32 v155, v155, v49
    v_mul_f32 v156, v156, v49
    v_mul_f32 v157, v157, v49
    v_mul_f32 v158, v158, v49
    v_mul_f32 v159, v159, v49
    v_mul_f32 v160, v160, v49
    v_mul_f32 v161, v161, v49
    v_mul_f32 v162, v162, v49
    v_mul_f32 v163, v163, v49
    v_mul_f32 v164, v164, v49
    v_mul_f32 v165, v165, v49
    v_mul_f32 v166, v166, v49
    v_mul_f32 v167, v167, v49
    v_mul_f32 v168, v168, v49
    v_mul_f32 v169, v169, v49
    v_mul_f32 v170, v170, v49
    v_mul_f32 v171, v171, v49
    v_mul_f32 v172, v172, v49
    v_mul_f32 v173, v173, v49
    v_mul_f32 v174, v174, v49
    v_mul_f32 v175, v175, v49
    v_mul_f32 v176, v176, v49
    v_mul_f32 v177, v177, v49
    v_mul_f32 v178, v178, v49
    v_mul_f32 v179, v179, v49
    v_mul_f32 v180, v180, v49
    v_mul_f32 v181, v181, v49
    v_mul_f32 v182, v182, v49
    v_mul_f32 v183, v183, v49
    v_mul_f32 v184, v184, v49
    v_mul_f32 v185, v185, v49
    v_mul_f32 v186, v186, v49
    v_mul_f32 v187, v187, v49
    v_mul_f32 v188, v188, v49
    v_mul_f32 v189, v189, v49
    v_mul_f32 v190, v190, v49
    v_mul_f32 v191, v191, v49
    v_fma_f32 v32, v32, s28, v50
    v_fma_f32 v33, v33, s28, v50
    v_fma_f32 v34, v34, s28, v50
    v_fma_f32 v35, v35, s28, v50
    v_fma_f32 v36, v36, s28, v50
    v_fma_f32 v37, v37, s28, v50
    v_fma_f32 v38, v38, s28, v50
    v_fma_f32 v39, v39, s28, v50
    v_fma_f32 v40, v40, s28, v50
    v_fma_f32 v41, v41, s28, v50
    v_fma_f32 v42, v42, s28, v50
    v_fma_f32 v43, v43, s28, v50
    v_fma_f32 v44, v44, s28, v50
    v_fma_f32 v45, v45, s28, v50
    v_fma_f32 v46, v46, s28, v50
    v_fma_f32 v47, v47, s28, v50
    v_exp_f32 v32, v32
    v_exp_f32 v33, v33
    v_exp_f32 v34, v34
    v_exp_f32 v35, v35
    v_exp_f32 v36, v36
    v_exp_f32 v37, v37
    v_exp_f32 v38, v38
    v_exp_f32 v39, v39
    v_exp_f32 v40, v40
    v_exp_f32 v41, v41
    v_exp_f32 v42, v42
    v_exp_f32 v43, v43
    v_exp_f32 v44, v44
    v_exp_f32 v45, v45
    v_exp_f32 v46, v46
    v_exp_f32 v47, v47
    s_nop 0
    v_add_f32 v20, v20, v32
    v_add_f32 v20, v20, v33
    v_add_f32 v20, v20, v34
    v_add_f32 v20, v20, v35
    v_add_f32 v20, v20, v36
    v_add_f32 v20, v20, v37
    v_add_f32 v20, v20, v38
    v_add_f32 v20, v20, v39
    v_add_f32 v20, v20, v40
    v_add_f32 v20, v20, v41
    v_add_f32 v20, v20, v42
    v_add_f32 v20, v20, v43
    v_add_f32 v20, v20, v44
    v_add_f32 v20, v20, v45
    v_add_f32 v20, v20, v46
    v_add_f32 v20, v20, v47
    v_cvt_pk_bf16_f32 v32, v32, v33
    v_cvt_pk_bf16_f32 v33, v34, v35
    v_cvt_pk_bf16_f32 v34, v36, v37
    v_cvt_pk_bf16_f32 v35, v38, v39
    v_cvt_pk_bf16_f32 v40, v40, v41
    v_cvt_pk_bf16_f32 v41, v42, v43
    v_cvt_pk_bf16_f32 v42, v44, v45
    v_cvt_pk_bf16_f32 v43, v46, v47
    s_nop 1
    v_mfma_f32_32x32x16_bf16 v[128:143], a[224:227], v[32:35], v[128:143]
    v_mfma_f32_32x32x16_bf16 v[144:159], a[228:231], v[32:35], v[144:159]
    v_mfma_f32_32x32x16_bf16 v[160:175], a[232:235], v[32:35], v[160:175]
    v_mfma_f32_32x32x16_bf16 v[176:191], a[236:239], v[32:35], v[176:191]
    v_mfma_f32_32x32x16_bf16 v[128:143], a[240:243], v[40:43], v[128:143]
    v_mfma_f32_32x32x16_bf16 v[144:159], a[244:247], v[40:43], v[144:159]
    v_mfma_f32_32x32x16_bf16 v[160:175], a[248:251], v[40:43], v[160:175]
    v_mfma_f32_32x32x16_bf16 v[176:191], a[252:255], v[40:43], v[176:191]
    s_nop 15
    v_mfma_f32_32x32x16_bf16 v[32:47], a[192:195], a[64:67], 0
    v_mfma_f32_32x32x16_bf16 v[32:47], a[196:199], a[68:71], v[32:47]
    v_mfma_f32_32x32x16_bf16 v[32:47], a[200:203], a[72:75], v[32:47]
    v_mfma_f32_32x32x16_bf16 v[32:47], a[204:207], a[76:79], v[32:47]
    v_mfma_f32_32x32x16_bf16 v[32:47], a[208:211], a[80:83], v[32:47]
    v_mfma_f32_32x32x16_bf16 v[32:47], a[212:215], a[84:87], v[32:47]
    v_mfma_f32_32x32x16_bf16 v[32:47], a[216:219], a[88:91], v[32:47]
    v_mfma_f32_32x32x16_bf16 v[32:47], a[220:223], a[92:95], v[32:47]
    s_nop 15
    v_max3_f32 v48, v32, v33, v34
    v_max3_f32 v48, v48, v35, v36
    v_max3_f32 v48, v48, v37, v38
    v_max3_f32 v48, v48, v39, v40
    v_max3_f32 v48, v48, v41, v42
    v_max3_f32 v48, v48, v43, v44
    v_max3_f32 v48, v48, v45, v46
    v_max3_f32 v48, v48, v47, v24
    v_mov_b32 v49, v48
    s_nop 1
    v_permlane32_swap_b32 v48, v49
    s_nop 1
    v_max_f32 v48, v48, v49
    v_sub_f32 v49, v24, v48
    v_mul_f32 v49, s28, v49
    v_exp_f32 v49, v49
    v_mov_b32 v24, v48
    v_mul_f32 v50, s28, v48
    v_sub_f32 v50, 0, v50
    v_mul_f32 v21, v21, v49
    v_mul_f32 v192, v192, v49
    v_mul_f32 v193, v193, v49
    v_mul_f32 v194, v194, v49
    v_mul_f32 v195, v195, v49
    v_mul_f32 v196, v196, v49
    v_mul_f32 v197, v197, v49
    v_mul_f32 v198, v198, v49
    v_mul_f32 v199, v199, v49
    v_mul_f32 v200, v200, v49
    v_mul_f32 v201, v201, v49
    v_mul_f32 v202, v202, v49
    v_mul_f32 v203, v203, v49
    v_mul_f32 v204, v204, v49
    v_mul_f32 v205, v205, v49
    v_mul_f32 v206, v206, v49
    v_mul_f32 v207, v207, v49
    v_mul_f32 v208, v208, v49
    v_mul_f32 v209, v209, v49
    v_mul_f32 v210, v210, v49
    v_mul_f32 v211, v211, v49
    v_mul_f32 v212, v212, v49
    v_mul_f32 v213, v213, v49
    v_mul_f32 v214, v214, v49
    v_mul_f32 v215, v215, v49
    v_mul_f32 v216, v216, v49
    v_mul_f32 v217, v217, v49
    v_mul_f32 v218, v218, v49
    v_mul_f32 v219, v219, v49
    v_mul_f32 v220, v220, v49
    v_mul_f32 v221, v221, v49
    v_mul_f32 v222, v222, v49
    v_mul_f32 v223, v223, v49
    v_mul_f32 v224, v224, v49
    v_mul_f32 v225, v225, v49
    v_mul_f32 v226, v226, v49
    v_mul_f32 v227, v227, v49
    v_mul_f32 v228, v228, v49
    v_mul_f32 v229, v229, v49
    v_mul_f32 v230, v230, v49
    v_mul_f32 v231, v231, v49
    v_mul_f32 v232, v232, v49
    v_mul_f32 v233, v233, v49
    v_mul_f32 v234, v234, v49
    v_mul_f32 v235, v235, v49
    v_mul_f32 v236, v236, v49
    v_mul_f32 v237, v237, v49
    v_mul_f32 v238, v238, v49
    v_mul_f32 v239, v239, v49
    v_mul_f32 v240, v240, v49
    v_mul_f32 v241, v241, v49
    v_mul_f32 v242, v242, v49
    v_mul_f32 v243, v243, v49
    v_mul_f32 v244, v244, v49
    v_mul_f32 v245, v245, v49
    v_mul_f32 v246, v246, v49
    v_mul_f32 v247, v247, v49
    v_mul_f32 v248, v248, v49
    v_mul_f32 v249, v249, v49
    v_mul_f32 v250, v250, v49
    v_mul_f32 v251, v251, v49
    v_mul_f32 v252, v252, v49
    v_mul_f32 v253, v253, v49
    v_mul_f32 v254, v254, v49
    v_mul_f32 v255, v255, v49
    v_fma_f32 v32, v32, s28, v50
    v_fma_f32 v33, v33, s28, v50
    v_fma_f32 v34, v34, s28, v50
    v_fma_f32 v35, v35, s28, v50
    v_fma_f32 v36, v36, s28, v50
    v_fma_f32 v37, v37, s28, v50
    v_fma_f32 v38, v38, s28, v50
    v_fma_f32 v39, v39, s28, v50
    v_fma_f32 v40, v40, s28, v50
    v_fma_f32 v41, v41, s28, v50
    v_fma_f32 v42, v42, s28, v50
    v_fma_f32 v43, v43, s28, v50
    v_fma_f32 v44, v44, s28, v50
    v_fma_f32 v45, v45, s28, v50
    v_fma_f32 v46, v46, s28, v50
    v_fma_f32 v47, v47, s28, v50
    v_exp_f32 v32, v32
    v_exp_f32 v33, v33
    v_exp_f32 v34, v34
    v_exp_f32 v35, v35
    v_exp_f32 v36, v36
    v_exp_f32 v37, v37
    v_exp_f32 v38, v38
    v_exp_f32 v39, v39
    v_exp_f32 v40, v40
    v_exp_f32 v41, v41
    v_exp_f32 v42, v42
    v_exp_f32 v43, v43
    v_exp_f32 v44, v44
    v_exp_f32 v45, v45
    v_exp_f32 v46, v46
    v_exp_f32 v47, v47
    s_nop 0
    v_add_f32 v21, v21, v32
    v_add_f32 v21, v21, v33
    v_add_f32 v21, v21, v34
    v_add_f32 v21, v21, v35
    v_add_f32 v21, v21, v36
    v_add_f32 v21, v21, v37
    v_add_f32 v21, v21, v38
    v_add_f32 v21, v21, v39
    v_add_f32 v21, v21, v40
    v_add_f32 v21, v21, v41
    v_add_f32 v21, v21, v42
    v_add_f32 v21, v21, v43
    v_add_f32 v21, v21, v44
    v_add_f32 v21, v21, v45
    v_add_f32 v21, v21, v46
    v_add_f32 v21, v21, v47
    v_cvt_pk_bf16_f32 v32, v32, v33
    v_cvt_pk_bf16_f32 v33, v34, v35
    v_cvt_pk_bf16_f32 v34, v36, v37
    v_cvt_pk_bf16_f32 v35, v38, v39
    v_cvt_pk_bf16_f32 v40, v40, v41
    v_cvt_pk_bf16_f32 v41, v42, v43
    v_cvt_pk_bf16_f32 v42, v44, v45
    v_cvt_pk_bf16_f32 v43, v46, v47
    s_nop 1
    v_mfma_f32_32x32x16_bf16 v[192:207], a[224:227], v[32:35], v[192:207]
    v_mfma_f32_32x32x16_bf16 v[208:223], a[228:231], v[32:35], v[208:223]
    v_mfma_f32_32x32x16_bf16 v[224:239], a[232:235], v[32:35], v[224:239]
    v_mfma_f32_32x32x16_bf16 v[240:255], a[236:239], v[32:35], v[240:255]
    v_mfma_f32_32x32x16_bf16 v[192:207], a[240:243], v[40:43], v[192:207]
    v_mfma_f32_32x32x16_bf16 v[208:223], a[244:247], v[40:43], v[208:223]
    v_mfma_f32_32x32x16_bf16 v[224:239], a[248:251], v[40:43], v[224:239]
    v_mfma_f32_32x32x16_bf16 v[240:255], a[252:255], v[40:43], v[240:255]
    s_nop 15
    s_add_u32 s69, s69, 1
    s_cmp_lt_u32 s69, 2
    s_cbranch_scc1 L_safe_tile
    s_add_u32 s68, s68, 1
    s_cmp_lt_u32 s68, 16
    s_cbranch_scc1 L_safe_stage
    v_mov_b32 v48, v19
    s_nop 1
    v_permlane32_swap_b32 v19, v48
    s_nop 1
    v_add_f32 v19, v19, v48
    v_rcp_f32 v48, v19
    s_nop 0
    v_mul_f32 v64, v64, v48
    v_mul_f32 v65, v65, v48
    v_mul_f32 v66, v66, v48
    v_mul_f32 v67, v67, v48
    v_mul_f32 v68, v68, v48
    v_mul_f32 v69, v69, v48
    v_mul_f32 v70, v70, v48
    v_mul_f32 v71, v71, v48
    v_cvt_pk_bf16_f32 v64, v64, v65
    v_cvt_pk_bf16_f32 v65, v66, v67
    v_cvt_pk_bf16_f32 v66, v68, v69
    v_cvt_pk_bf16_f32 v67, v70, v71
    buffer_store_dwordx4 v[64:67], v18, s[20:23], s63 offen offset:0
    v_mul_f32 v72, v72, v48
    v_mul_f32 v73, v73, v48
    v_mul_f32 v74, v74, v48
    v_mul_f32 v75, v75, v48
    v_mul_f32 v76, v76, v48
    v_mul_f32 v77, v77, v48
    v_mul_f32 v78, v78, v48
    v_mul_f32 v79, v79, v48
    v_cvt_pk_bf16_f32 v72, v72, v73
    v_cvt_pk_bf16_f32 v73, v74, v75
    v_cvt_pk_bf16_f32 v74, v76, v77
    v_cvt_pk_bf16_f32 v75, v78, v79
    buffer_store_dwordx4 v[72:75], v18, s[20:23], s63 offen offset:32
    v_mul_f32 v80, v80, v48
    v_mul_f32 v81, v81, v48
    v_mul_f32 v82, v82, v48
    v_mul_f32 v83, v83, v48
    v_mul_f32 v84, v84, v48
    v_mul_f32 v85, v85, v48
    v_mul_f32 v86, v86, v48
    v_mul_f32 v87, v87, v48
    v_cvt_pk_bf16_f32 v80, v80, v81
    v_cvt_pk_bf16_f32 v81, v82, v83
    v_cvt_pk_bf16_f32 v82, v84, v85
    v_cvt_pk_bf16_f32 v83, v86, v87
    buffer_store_dwordx4 v[80:83], v18, s[20:23], s63 offen offset:64
    v_mul_f32 v88, v88, v48
    v_mul_f32 v89, v89, v48
    v_mul_f32 v90, v90, v48
    v_mul_f32 v91, v91, v48
    v_mul_f32 v92, v92, v48
    v_mul_f32 v93, v93, v48
    v_mul_f32 v94, v94, v48
    v_mul_f32 v95, v95, v48
    v_cvt_pk_bf16_f32 v88, v88, v89
    v_cvt_pk_bf16_f32 v89, v90, v91
    v_cvt_pk_bf16_f32 v90, v92, v93
    v_cvt_pk_bf16_f32 v91, v94, v95
    buffer_store_dwordx4 v[88:91], v18, s[20:23], s63 offen offset:96
    v_mul_f32 v96, v96, v48
    v_mul_f32 v97, v97, v48
    v_mul_f32 v98, v98, v48
    v_mul_f32 v99, v99, v48
    v_mul_f32 v100, v100, v48
    v_mul_f32 v101, v101, v48
    v_mul_f32 v102, v102, v48
    v_mul_f32 v103, v103, v48
    v_cvt_pk_bf16_f32 v96, v96, v97
    v_cvt_pk_bf16_f32 v97, v98, v99
    v_cvt_pk_bf16_f32 v98, v100, v101
    v_cvt_pk_bf16_f32 v99, v102, v103
    buffer_store_dwordx4 v[96:99], v18, s[20:23], s63 offen offset:128
    v_mul_f32 v104, v104, v48
    v_mul_f32 v105, v105, v48
    v_mul_f32 v106, v106, v48
    v_mul_f32 v107, v107, v48
    v_mul_f32 v108, v108, v48
    v_mul_f32 v109, v109, v48
    v_mul_f32 v110, v110, v48
    v_mul_f32 v111, v111, v48
    v_cvt_pk_bf16_f32 v104, v104, v105
    v_cvt_pk_bf16_f32 v105, v106, v107
    v_cvt_pk_bf16_f32 v106, v108, v109
    v_cvt_pk_bf16_f32 v107, v110, v111
    buffer_store_dwordx4 v[104:107], v18, s[20:23], s63 offen offset:160
    v_mul_f32 v112, v112, v48
    v_mul_f32 v113, v113, v48
    v_mul_f32 v114, v114, v48
    v_mul_f32 v115, v115, v48
    v_mul_f32 v116, v116, v48
    v_mul_f32 v117, v117, v48
    v_mul_f32 v118, v118, v48
    v_mul_f32 v119, v119, v48
    v_cvt_pk_bf16_f32 v112, v112, v113
    v_cvt_pk_bf16_f32 v113, v114, v115
    v_cvt_pk_bf16_f32 v114, v116, v117
    v_cvt_pk_bf16_f32 v115, v118, v119
    buffer_store_dwordx4 v[112:115], v18, s[20:23], s63 offen offset:192
    v_mul_f32 v120, v120, v48
    v_mul_f32 v121, v121, v48
    v_mul_f32 v122, v122, v48
    v_mul_f32 v123, v123, v48
    v_mul_f32 v124, v124, v48
    v_mul_f32 v125, v125, v48
    v_mul_f32 v126, v126, v48
    v_mul_f32 v127, v127, v48
    v_cvt_pk_bf16_f32 v120, v120, v121
    v_cvt_pk_bf16_f32 v121, v122, v123
    v_cvt_pk_bf16_f32 v122, v124, v125
    v_cvt_pk_bf16_f32 v123, v126, v127
    buffer_store_dwordx4 v[120:123], v18, s[20:23], s63 offen offset:224
    v_mov_b32 v48, v20
    s_nop 1
    v_permlane32_swap_b32 v20, v48
    s_nop 1
    v_add_f32 v20, v20, v48
    v_rcp_f32 v48, v20
    s_nop 0
    v_mul_f32 v128, v128, v48
    v_mul_f32 v129, v129, v48
    v_mul_f32 v130, v130, v48
    v_mul_f32 v131, v131, v48
    v_mul_f32 v132, v132, v48
    v_mul_f32 v133, v133, v48
    v_mul_f32 v134, v134, v48
    v_mul_f32 v135, v135, v48
    v_cvt_pk_bf16_f32 v128, v128, v129
    v_cvt_pk_bf16_f32 v129, v130, v131
    v_cvt_pk_bf16_f32 v130, v132, v133
    v_cvt_pk_bf16_f32 v131, v134, v135
    buffer_store_dwordx4 v[128:131], v18, s[20:23], s64 offen offset:0
    v_mul_f32 v136, v136, v48
    v_mul_f32 v137, v137, v48
    v_mul_f32 v138, v138, v48
    v_mul_f32 v139, v139, v48
    v_mul_f32 v140, v140, v48
    v_mul_f32 v141, v141, v48
    v_mul_f32 v142, v142, v48
    v_mul_f32 v143, v143, v48
    v_cvt_pk_bf16_f32 v136, v136, v137
    v_cvt_pk_bf16_f32 v137, v138, v139
    v_cvt_pk_bf16_f32 v138, v140, v141
    v_cvt_pk_bf16_f32 v139, v142, v143
    buffer_store_dwordx4 v[136:139], v18, s[20:23], s64 offen offset:32
    v_mul_f32 v144, v144, v48
    v_mul_f32 v145, v145, v48
    v_mul_f32 v146, v146, v48
    v_mul_f32 v147, v147, v48
    v_mul_f32 v148, v148, v48
    v_mul_f32 v149, v149, v48
    v_mul_f32 v150, v150, v48
    v_mul_f32 v151, v151, v48
    v_cvt_pk_bf16_f32 v144, v144, v145
    v_cvt_pk_bf16_f32 v145, v146, v147
    v_cvt_pk_bf16_f32 v146, v148, v149
    v_cvt_pk_bf16_f32 v147, v150, v151
    buffer_store_dwordx4 v[144:147], v18, s[20:23], s64 offen offset:64
    v_mul_f32 v152, v152, v48
    v_mul_f32 v153, v153, v48
    v_mul_f32 v154, v154, v48
    v_mul_f32 v155, v155, v48
    v_mul_f32 v156, v156, v48
    v_mul_f32 v157, v157, v48
    v_mul_f32 v158, v158, v48
    v_mul_f32 v159, v159, v48
    v_cvt_pk_bf16_f32 v152, v152, v153
    v_cvt_pk_bf16_f32 v153, v154, v155
    v_cvt_pk_bf16_f32 v154, v156, v157
    v_cvt_pk_bf16_f32 v155, v158, v159
    buffer_store_dwordx4 v[152:155], v18, s[20:23], s64 offen offset:96
    v_mul_f32 v160, v160, v48
    v_mul_f32 v161, v161, v48
    v_mul_f32 v162, v162, v48
    v_mul_f32 v163, v163, v48
    v_mul_f32 v164, v164, v48
    v_mul_f32 v165, v165, v48
    v_mul_f32 v166, v166, v48
    v_mul_f32 v167, v167, v48
    v_cvt_pk_bf16_f32 v160, v160, v161
    v_cvt_pk_bf16_f32 v161, v162, v163
    v_cvt_pk_bf16_f32 v162, v164, v165
    v_cvt_pk_bf16_f32 v163, v166, v167
    buffer_store_dwordx4 v[160:163], v18, s[20:23], s64 offen offset:128
    v_mul_f32 v168, v168, v48
    v_mul_f32 v169, v169, v48
    v_mul_f32 v170, v170, v48
    v_mul_f32 v171, v171, v48
    v_mul_f32 v172, v172, v48
    v_mul_f32 v173, v173, v48
    v_mul_f32 v174, v174, v48
    v_mul_f32 v175, v175, v48
    v_cvt_pk_bf16_f32 v168, v168, v169
    v_cvt_pk_bf16_f32 v169, v170, v171
    v_cvt_pk_bf16_f32 v170, v172, v173
    v_cvt_pk_bf16_f32 v171, v174, v175
    buffer_store_dwordx4 v[168:171], v18, s[20:23], s64 offen offset:160
    v_mul_f32 v176, v176, v48
    v_mul_f32 v177, v177, v48
    v_mul_f32 v178, v178, v48
    v_mul_f32 v179, v179, v48
    v_mul_f32 v180, v180, v48
    v_mul_f32 v181, v181, v48
    v_mul_f32 v182, v182, v48
    v_mul_f32 v183, v183, v48
    v_cvt_pk_bf16_f32 v176, v176, v177
    v_cvt_pk_bf16_f32 v177, v178, v179
    v_cvt_pk_bf16_f32 v178, v180, v181
    v_cvt_pk_bf16_f32 v179, v182, v183
    buffer_store_dwordx4 v[176:179], v18, s[20:23], s64 offen offset:192
    v_mul_f32 v184, v184, v48
    v_mul_f32 v185, v185, v48
    v_mul_f32 v186, v186, v48
    v_mul_f32 v187, v187, v48
    v_mul_f32 v188, v188, v48
    v_mul_f32 v189, v189, v48
    v_mul_f32 v190, v190, v48
    v_mul_f32 v191, v191, v48
    v_cvt_pk_bf16_f32 v184, v184, v185
    v_cvt_pk_bf16_f32 v185, v186, v187
    v_cvt_pk_bf16_f32 v186, v188, v189
    v_cvt_pk_bf16_f32 v187, v190, v191
    buffer_store_dwordx4 v[184:187], v18, s[20:23], s64 offen offset:224
    v_mov_b32 v48, v21
    s_nop 1
    v_permlane32_swap_b32 v21, v48
    s_nop 1
    v_add_f32 v21, v21, v48
    v_rcp_f32 v48, v21
    s_nop 0
    v_mul_f32 v192, v192, v48
    v_mul_f32 v193, v193, v48
    v_mul_f32 v194, v194, v48
    v_mul_f32 v195, v195, v48
    v_mul_f32 v196, v196, v48
    v_mul_f32 v197, v197, v48
    v_mul_f32 v198, v198, v48
    v_mul_f32 v199, v199, v48
    v_cvt_pk_bf16_f32 v192, v192, v193
    v_cvt_pk_bf16_f32 v193, v194, v195
    v_cvt_pk_bf16_f32 v194, v196, v197
    v_cvt_pk_bf16_f32 v195, v198, v199
    buffer_store_dwordx4 v[192:195], v18, s[20:23], s65 offen offset:0
    v_mul_f32 v200, v200, v48
    v_mul_f32 v201, v201, v48
    v_mul_f32 v202, v202, v48
    v_mul_f32 v203, v203, v48
    v_mul_f32 v204, v204, v48
    v_mul_f32 v205, v205, v48
    v_mul_f32 v206, v206, v48
    v_mul_f32 v207, v207, v48
    v_cvt_pk_bf16_f32 v200, v200, v201
    v_cvt_pk_bf16_f32 v201, v202, v203
    v_cvt_pk_bf16_f32 v202, v204, v205
    v_cvt_pk_bf16_f32 v203, v206, v207
    buffer_store_dwordx4 v[200:203], v18, s[20:23], s65 offen offset:32
    v_mul_f32 v208, v208, v48
    v_mul_f32 v209, v209, v48
    v_mul_f32 v210, v210, v48
    v_mul_f32 v211, v211, v48
    v_mul_f32 v212, v212, v48
    v_mul_f32 v213, v213, v48
    v_mul_f32 v214, v214, v48
    v_mul_f32 v215, v215, v48
    v_cvt_pk_bf16_f32 v208, v208, v209
    v_cvt_pk_bf16_f32 v209, v210, v211
    v_cvt_pk_bf16_f32 v210, v212, v213
    v_cvt_pk_bf16_f32 v211, v214, v215
    buffer_store_dwordx4 v[208:211], v18, s[20:23], s65 offen offset:64
    v_mul_f32 v216, v216, v48
    v_mul_f32 v217, v217, v48
    v_mul_f32 v218, v218, v48
    v_mul_f32 v219, v219, v48
    v_mul_f32 v220, v220, v48
    v_mul_f32 v221, v221, v48
    v_mul_f32 v222, v222, v48
    v_mul_f32 v223, v223, v48
    v_cvt_pk_bf16_f32 v216, v216, v217
    v_cvt_pk_bf16_f32 v217, v218, v219
    v_cvt_pk_bf16_f32 v218, v220, v221
    v_cvt_pk_bf16_f32 v219, v222, v223
    buffer_store_dwordx4 v[216:219], v18, s[20:23], s65 offen offset:96
    v_mul_f32 v224, v224, v48
    v_mul_f32 v225, v225, v48
    v_mul_f32 v226, v226, v48
    v_mul_f32 v227, v227, v48
    v_mul_f32 v228, v228, v48
    v_mul_f32 v229, v229, v48
    v_mul_f32 v230, v230, v48
    v_mul_f32 v231, v231, v48
    v_cvt_pk_bf16_f32 v224, v224, v225
    v_cvt_pk_bf16_f32 v225, v226, v227
    v_cvt_pk_bf16_f32 v226, v228, v229
    v_cvt_pk_bf16_f32 v227, v230, v231
    buffer_store_dwordx4 v[224:227], v18, s[20:23], s65 offen offset:128
    v_mul_f32 v232, v232, v48
    v_mul_f32 v233, v233, v48
    v_mul_f32 v234, v234, v48
    v_mul_f32 v235, v235, v48
    v_mul_f32 v236, v236, v48
    v_mul_f32 v237, v237, v48
    v_mul_f32 v238, v238, v48
    v_mul_f32 v239, v239, v48
    v_cvt_pk_bf16_f32 v232, v232, v233
    v_cvt_pk_bf16_f32 v233, v234, v235
    v_cvt_pk_bf16_f32 v234, v236, v237
    v_cvt_pk_bf16_f32 v235, v238, v239
    buffer_store_dwordx4 v[232:235], v18, s[20:23], s65 offen offset:160
    v_mul_f32 v240, v240, v48
    v_mul_f32 v241, v241, v48
    v_mul_f32 v242, v242, v48
    v_mul_f32 v243, v243, v48
    v_mul_f32 v244, v244, v48
    v_mul_f32 v245, v245, v48
    v_mul_f32 v246, v246, v48
    v_mul_f32 v247, v247, v48
    v_cvt_pk_bf16_f32 v240, v240, v241
    v_cvt_pk_bf16_f32 v241, v242, v243
    v_cvt_pk_bf16_f32 v242, v244, v245
    v_cvt_pk_bf16_f32 v243, v246, v247
    buffer_store_dwordx4 v[240:243], v18, s[20:23], s65 offen offset:192
    v_mul_f32 v248, v248, v48
    v_mul_f32 v249, v249, v48
    v_mul_f32 v250, v250, v48
    v_mul_f32 v251, v251, v48
    v_mul_f32 v252, v252, v48
    v_mul_f32 v253, v253, v48
    v_mul_f32 v254, v254, v48
    v_mul_f32 v255, v255, v48
    v_cvt_pk_bf16_f32 v248, v248, v249
    v_cvt_pk_bf16_f32 v249, v250, v251
    v_cvt_pk_bf16_f32 v250, v252, v253
    v_cvt_pk_bf16_f32 v251, v254, v255
    buffer_store_dwordx4 v[248:251], v18, s[20:23], s65 offen offset:224
    s_waitcnt vmcnt(0)
L_safe_next:
    s_add_u32 s62, s62, 1
    s_cmp_lt_u32 s62, 2
    s_cbranch_scc1 L_safe_head
    s_endpgm
.section .rodata,"a"
.p2align 6
.amdhsa_kernel standalone__mha_softmax__near_ridge_kernel
  .amdhsa_next_free_vgpr 512
  .amdhsa_next_free_sgpr 96
  .amdhsa_accum_offset 256
  .amdhsa_group_segment_fixed_size 0
  .amdhsa_kernarg_size 48
  .amdhsa_user_sgpr_count 2
  .amdhsa_user_sgpr_kernarg_segment_ptr 1
  .amdhsa_system_sgpr_workgroup_id_x 1
.end_amdhsa_kernel
```
